```python
import torch

def _softmax(x, axis=-1):
    return torch.softmax(x, dim=axis)
def _gelu(x):
    return torch.nn.functional.gelu(x, approximate="tanh")
def _silu(x):
    return torch.nn.functional.silu(x)
def _sigmoid(x):
    return torch.sigmoid(x)
def _layernorm(x, axis=-1, eps=1e-5):
    m = x.mean(dim=axis, keepdim=True)
    v = x.var(dim=axis, keepdim=True, unbiased=False)
    return (x - m) / torch.sqrt(v + eps)
def _scatter_add(tgt, idx, src, axis=0):
    return tgt.clone().index_add_(axis, idx, src)
def _segment_sum(src, seg, n):
    out = torch.zeros((n,) + src.shape[1:], dtype=src.dtype)
    return out.index_add_(0, seg, src)
def _pad(x, pw):
    flat = tuple(v for pair in reversed(pw) for v in pair)
    return torch.nn.functional.pad(x, flat)

kernel_name = 'concat_heads__gqa_block_cached__mha_block_cached__decode'

def setup_inputs():

    _w = (lambda a: (lambda t: t.to(torch.bfloat16) if t.is_floating_point() else t)(torch.as_tensor(a)))
    def _A_setup():
        B, Sq, D = 4, 1, 640
        Hq, Hkv, Sk, Dh = 32, 32, 4096, 192
        assert Hq % Hkv == 0, (Hq, Hkv)
        return {
            "x": _w((lambda *s: torch.randn(*s, dtype=torch.bfloat16) * 0.8)(B, Sq, D)),
            "k_cache": _w((lambda *s: torch.randn(*s, dtype=torch.bfloat16) * 0.8)(B, Hkv, Sk, Dh)),
            "v_cache": _w((lambda *s: torch.randn(*s, dtype=torch.bfloat16) * 0.05)(B, Hkv, Sk, Dh)),
            "wq": _w((lambda *s: torch.randn(*s, dtype=torch.bfloat16) * 0.8)(D, Hq * Dh) * (D ** -0.5)),
            "wo": _w((lambda *s: torch.randn(*s, dtype=torch.bfloat16) * 0.05)(Hq * Dh, D) * ((Hq * Dh) ** -0.5)),
        }
    _A_in = _A_setup()

    def _B_setup():
        B, Sq, D = 4, 1, 640
        H, Sk, Dh = 32, 4096, 192
        return {
            "x": _w((lambda *s: torch.randn(*s, dtype=torch.bfloat16) * 0.8)(B, Sq, D)),
            "k_cache": _w((lambda *s: torch.randn(*s, dtype=torch.bfloat16) * 0.8)(B, H, Sk, Dh)),
            "v_cache": _w((lambda *s: torch.randn(*s, dtype=torch.bfloat16) * 0.05)(B, H, Sk, Dh)),
            "wq": _w((lambda *s: torch.randn(*s, dtype=torch.bfloat16) * 0.8)(D, H * Dh) * (D ** -0.5)),
            "wo": _w((lambda *s: torch.randn(*s, dtype=torch.bfloat16) * 0.05)(H * Dh, D) * ((H * Dh) ** -0.5)),
        }
    _B_in = _B_setup()

    return {
        "A_x": _A_in["x"],
        "A_k_cache": _A_in["k_cache"],
        "A_v_cache": _A_in["v_cache"],
        "A_wq": _A_in["wq"],
        "A_wo": _A_in["wo"],
        "B_x": _B_in["x"],
        "B_k_cache": _B_in["k_cache"],
        "B_v_cache": _B_in["v_cache"],
        "B_wq": _B_in["wq"],
        "B_wo": _B_in["wo"],
    }

def reference(A_x, A_k_cache, A_v_cache, A_wq, A_wo, B_x, B_k_cache, B_v_cache, B_wq, B_wo):
    def _A_ref(x, k_cache, v_cache, wq, wo):
        B, Sq, D = x.shape
        Hq, Dh = 32, 192
        Hkv = k_cache.shape[1]
        rep = Hq // Hkv
        q = (lambda x, *d: x.permute(*d))((x @ wq).reshape(B, Sq, Hq, Dh), 0, 2, 1, 3)
        k = (lambda x, n, axis: torch.repeat_interleave(x, n, dim=axis))(k_cache, rep, axis=1)
        v = (lambda x, n, axis: torch.repeat_interleave(x, n, dim=axis))(v_cache, rep, axis=1)
        scores = torch.einsum("bhqd,bhkd->bhqk", q, k) * (Dh ** -0.5)
        p = _softmax(scores, axis=-1)
        o = torch.einsum("bhqk,bhkd->bhqd", p, v)
        return (lambda x, *d: x.permute(*d))(o, 0, 2, 1, 3).reshape(B, Sq, Hq * Dh) @ wo

    def _B_ref(x, k_cache, v_cache, wq, wo):
        B, Sq, D = x.shape
        H, Dh = 32, 192
        q = (lambda x, *d: x.permute(*d))((x @ wq).reshape(B, Sq, H, Dh), 0, 2, 1, 3)
        scores = torch.einsum("bhqd,bhkd->bhqk", q, k_cache) * (Dh ** -0.5)
        p = _softmax(scores, axis=-1)
        o = torch.einsum("bhqk,bhkd->bhqd", p, v_cache)
        return (lambda x, *d: x.permute(*d))(o, 0, 2, 1, 3).reshape(B, Sq, H * Dh) @ wo

    a = _A_ref(A_x, A_k_cache, A_v_cache, A_wq, A_wo)
    b = _B_ref(B_x, B_k_cache, B_v_cache, B_wq, B_wo)
    return torch.concatenate([a, b], axis=-1)
```

```asm
; @launch grid=(256,1,1) block=(256,1,1) lds=43392
.amdgcn_target "amdgcn-amd-amdhsa--gfx950"
.text
.globl concat_heads__gqa_block_cached__mha_block_cached__decode_kernel
.p2align 8
.type concat_heads__gqa_block_cached__mha_block_cached__decode_kernel,@function
concat_heads__gqa_block_cached__mha_block_cached__decode_kernel:
  s_cmp_ge_u32 s2, 256
  s_cbranch_scc1 L_end
  s_load_dwordx16 s[16:31], s[0:1], 0
  s_load_dwordx8 s[32:39], s[0:1], 64
  s_load_dwordx2 s[40:41], s[0:1], 96
  s_memrealtime s[92:93]
  v_lshrrev_b32 v1, 6, v0
  v_and_b32 v0, 63, v0
  v_lshrrev_b32 v2, 3, v0
  v_readfirstlane_b32 s3, v1
  v_and_b32 v3, 7, v0
  v_lshlrev_b32 v4, 4, v3
  v_mul_u32_u24 v5, 384, v2
  v_add_u32 v5, v5, v4
  v_mul_u32_u24 v7, 245760, v2
  v_add_u32 v7, v7, v4
  v_mul_u32_u24 v8, 1280, v2
  v_add_u32 v8, v8, v4
  v_lshlrev_b32 v6, 5, v3
  s_bfe_u32 s7, s2, 0x30003
  s_and_b32 s11, s2, 7
  s_lshl_b32 s11, s11, 2
  s_lshr_b32 s12, s2, 6
  s_add_u32 s5, s11, s12
  s_lshr_b32 s6, s7, 2
  s_and_b32 s4, s7, 3
  s_mul_i32 s12, s3, 320
  v_mul_u32_u24 v1, 40, v2
  v_add_u32 v1, s12, v1
  s_cmp_ge_u32 s7, 3
  s_cselect_b32 s13, 1, 0
  s_mul_i32 s14, s13, 3
  s_sub_u32 s14, s7, s14
  s_mul_i32 s11, s3, 1966080
  s_mul_i32 s12, s5, 384
  s_add_u32 s78, s11, s12
  s_lshl_b32 s11, s14, 7
  s_add_u32 s78, s78, s11
  s_lshl_b32 s11, s5, 3
  s_lshl_b32 s12, s13, 2
  s_add_u32 s11, s11, s12
  s_add_u32 s11, s11, s3
  s_mul_i32 s11, s11, 768
  s_lshl_b32 s12, s14, 8
  s_add_u32 s11, s11, s12
  s_add_u32 s100, s11, 1048576
  s_mul_i32 s42, s3, 3
  s_min_u32 s42, s42, 8
  s_lshl_b32 s79, s42, 7
  s_mov_b32 s94, 0
  s_mov_b32 s95, 0
  s_mov_b32 s9, 0
  s_mov_b32 s101, 0
  s_mov_b32 s54, 7864320
  s_mov_b32 s55, 0x20000
  s_mov_b32 s46, 201326592
  s_mov_b32 s47, 0x20000
  s_mov_b32 s62, 5120
  s_mov_b32 s63, 0x20000
  s_mov_b32 s50, 201326592
  s_mov_b32 s51, 0x20000
  s_cmp_lg_u32 s13, 0
  s_waitcnt lgkmcnt(0)
  s_cselect_b32 s60, s26, s16
  s_cselect_b32 s61, s27, s17
  s_cselect_b32 s52, s32, s22
  s_cselect_b32 s53, s33, s23
  s_lshr_b32 s12, s2, 6
  s_and_b32 s14, s2, 7
  s_mul_i32 s33, s12, 0
  s_mul_i32 s11, s14, 0
  s_add_u32 s33, s33, s11
  s_mul_i32 s11, s12, 40
  s_mul_i32 s12, s14, 0
  s_add_u32 s11, s11, s12
  s_add_u32 s12, s11, 120
  s_and_b32 s12, s12, 127
  s_mul_i32 s26, s12, 12288
  s_mul_i32 s12, s7, 5
  s_add_u32 s11, s11, s12
  s_and_b32 s11, s11, 127
  s_mul_i32 s16, s11, 12288
  s_mov_b32 s23, s92
  s_or_b32 s11, s2, s3
  s_cmp_lg_u32 s11, 0
  s_cbranch_scc1 L_nononce
  s_mov_b32 s64, s40
  s_mov_b32 s65, s41
  s_mov_b32 s66, 4194304
  s_mov_b32 s67, 0x20000
  s_mov_b32 s72, s38
  s_mov_b32 s73, s39
  s_mov_b32 s74, 256
  s_mov_b32 s75, 0x20000
  v_lshlrev_b32 v4, 4, v0
  s_mov_b32 s11, 2228224
  v_mov_b32 v64, 0
  v_mov_b32 v65, 0
  v_mov_b32 v66, 0
  v_mov_b32 v67, 0
  buffer_store_dwordx4 v[64:67], v4, s[64:67], s11 offen offset:0 sc1
  buffer_store_dwordx4 v[64:67], v4, s[64:67], s11 offen offset:1024 sc1
  buffer_store_dwordx4 v[64:67], v4, s[64:67], s11 offen offset:2048 sc1
  buffer_store_dwordx4 v[64:67], v4, s[64:67], s11 offen offset:3072 sc1
  s_add_u32 s11, s11, 4096
  buffer_store_dwordx4 v[64:67], v4, s[64:67], s11 offen offset:0 sc1
  buffer_store_dwordx4 v[64:67], v4, s[64:67], s11 offen offset:1024 sc1
  buffer_store_dwordx4 v[64:67], v4, s[64:67], s11 offen offset:2048 sc1
  buffer_store_dwordx4 v[64:67], v4, s[64:67], s11 offen offset:3072 sc1
  s_or_b32 s92, s92, 1
  v_mov_b32 v98, s92
  v_mov_b32 v99, s93
  v_mov_b32 v55, 128
  s_mov_b64 exec, 1
  s_waitcnt vmcnt(0)
  buffer_store_dwordx2 v[98:99], v55, s[72:75], 0 offen sc1
  s_mov_b64 exec, -1
L_nononce:
  s_cmp_ge_u32 s7, 6
  s_cbranch_scc1 L_noprod
  buffer_load_dwordx4 a[0:3], v7, s[52:55], s78 offen nt
  s_add_u32 s78, s78, 12288
  buffer_load_dwordx4 a[4:7], v7, s[52:55], s78 offen nt
  s_add_u32 s78, s78, 12288
  s_cmp_lg_u32 s6, 0
  s_cselect_b32 s56, s34, s24
  s_cselect_b32 s57, s35, s25
  s_mul_i32 s14, s5, 245760
  s_add_u32 s56, s56, s14
  s_addc_u32 s57, s57, 0
  s_mov_b32 s58, 245760
  s_mov_b32 s59, 0x20000
  s_mov_b32 s64, s40
  s_mov_b32 s65, s41
  s_mov_b32 s66, 4194304
  s_mov_b32 s67, 0x20000
  s_mov_b32 s68, s36
  s_mov_b32 s69, s37
  s_mov_b32 s70, 10240
  s_mov_b32 s71, 0x20000
  s_mov_b32 s72, s38
  s_mov_b32 s73, s39
  s_mov_b32 s74, 256
  s_mov_b32 s75, 0x20000
  s_mov_b32 s96, s56
  s_mov_b32 s97, s57
  s_mov_b32 s99, 0x20000
  s_cmp_lt_u32 s3, 2
  s_cselect_b32 s98, 245760, 0
  v_mov_b32 v55, 128
  buffer_load_dwordx4 v[184:187], v1, s[60:63], 0 offen offset:0
  buffer_load_dwordx4 v[188:191], v1, s[60:63], 0 offen offset:16
  buffer_load_dwordx2 v[192:193], v1, s[60:63], 0 offen offset:32
  buffer_load_dwordx4 v[194:197], v1, s[60:63], 0 offen offset:1280
  buffer_load_dwordx4 v[198:201], v1, s[60:63], 0 offen offset:1296
  buffer_load_dwordx2 v[202:203], v1, s[60:63], 0 offen offset:1312
  buffer_load_dwordx4 v[204:207], v1, s[60:63], 0 offen offset:2560
  buffer_load_dwordx4 v[208:211], v1, s[60:63], 0 offen offset:2576
  buffer_load_dwordx2 v[212:213], v1, s[60:63], 0 offen offset:2592
  buffer_load_dwordx4 v[214:217], v1, s[60:63], 0 offen offset:3840
  buffer_load_dwordx4 v[218:221], v1, s[60:63], 0 offen offset:3856
  buffer_load_dwordx2 v[222:223], v1, s[60:63], 0 offen offset:3872
  buffer_load_dwordx4 a[8:11], v7, s[52:55], s78 offen nt
  s_add_u32 s78, s78, 12288
  buffer_load_dwordx4 a[12:15], v7, s[52:55], s78 offen nt
  s_add_u32 s78, s78, 12288
  buffer_load_dwordx4 a[16:19], v7, s[52:55], s78 offen nt
  s_add_u32 s78, s78, 12288
  buffer_load_dwordx4 a[20:23], v7, s[52:55], s78 offen nt
  s_add_u32 s78, s78, 12288
  buffer_load_dwordx4 a[24:27], v7, s[52:55], s78 offen nt
  s_add_u32 s78, s78, 12288
  buffer_load_dwordx4 a[28:31], v7, s[52:55], s78 offen nt
  s_add_u32 s78, s78, 12288
  buffer_load_dwordx4 a[32:35], v7, s[52:55], s78 offen nt
  s_add_u32 s78, s78, 12288
  buffer_load_dwordx4 a[36:39], v7, s[52:55], s78 offen nt
  s_add_u32 s78, s78, 12288
  buffer_load_dwordx4 a[40:43], v7, s[52:55], s78 offen nt
  s_add_u32 s78, s78, 12288
  buffer_load_dwordx4 a[44:47], v7, s[52:55], s78 offen nt
  s_add_u32 s78, s78, 12288
  buffer_load_dwordx4 a[48:51], v7, s[52:55], s78 offen nt
  s_add_u32 s78, s78, 12288
  buffer_load_dwordx4 a[52:55], v7, s[52:55], s78 offen nt
  s_add_u32 s78, s78, 12288
  s_add_u32 s11, s94, s33
  s_and_b32 s11, s11, 7
  s_cmp_lt_u32 s94, 8
  s_cselect_b32 s11, s11, s7
  s_cselect_b32 s12, s16, s26
  s_cselect_b32 s17, 36, 1
  s_mul_i32 s17, s17, 12288
  s_cselect_b32 s27, 0, -1
  s_and_b32 s13, s11, 3
  s_lshl_b32 s13, s13, 5
  s_add_u32 s13, s13, s5
  s_mul_i32 s13, s13, 1572864
  s_mul_i32 s43, s3, 3072
  s_add_u32 s13, s13, s43
  s_add_u32 s43, s13, s12
  s_add_u32 s13, s13, 1572864
  s_or_b32 s27, s27, s13
  s_cmp_ge_u32 s11, 4
  s_cselect_b32 s44, s28, s18
  s_cselect_b32 s45, s29, s19
  s_cselect_b32 s48, s30, s20
  s_cselect_b32 s49, s31, s21
  s_mov_b32 s8, s43
  s_add_u32 s94, s94, 1
  s_mov_b32 s10, 0x3dd53b95
  s_mov_b32 s76, 0x01000100
  s_mov_b32 s77, 0x03020302
  v_and_b32 v4, 1, v0
  v_cmp_eq_u32 vcc, 1, v4
  v_mov_b32 v16, 0xffff
  v_mov_b32 v17, 0xffff0000
  v_cndmask_b32 v16, v16, v17, vcc
  v_lshrrev_b32 v4, 1, v3
  v_cmp_eq_u32 vcc, 0, v4
  s_nop 1
  v_cndmask_b32 v12, 0, v16, vcc
  v_cmp_eq_u32 vcc, 1, v4
  s_nop 1
  v_cndmask_b32 v13, 0, v16, vcc
  v_cmp_eq_u32 vcc, 2, v4
  s_nop 1
  v_cndmask_b32 v14, 0, v16, vcc
  v_cmp_eq_u32 vcc, 3, v4
  s_nop 1
  v_cndmask_b32 v15, 0, v16, vcc
  s_mul_i32 s12, s3, 4096
  v_lshlrev_b32 v97, 4, v0
  v_add_u32 v97, s12, v97
  v_lshrrev_b32 v96, 4, v0
  v_lshlrev_b32 v96, 10, v96
  v_and_b32 v4, 1, v0
  v_lshl_add_u32 v96, v4, 8, v96
  v_bfe_u32 v4, v0, 1, 3
  v_lshl_add_u32 v96, v4, 4, v96
  buffer_load_dwordx4 a[56:59], v7, s[52:55], s78 offen nt
  s_add_u32 s78, s78, 12288
  buffer_load_dwordx4 a[60:63], v7, s[52:55], s78 offen nt
  s_add_u32 s78, s78, 12288
  buffer_load_dwordx4 a[64:67], v7, s[52:55], s78 offen nt
  s_add_u32 s78, s78, 12288
  buffer_load_dwordx4 a[68:71], v7, s[52:55], s78 offen nt
  s_add_u32 s78, s78, 12288
  buffer_load_dwordx4 a[72:75], v7, s[52:55], s78 offen nt
  s_add_u32 s78, s78, 12288
  buffer_load_dwordx4 a[76:79], v7, s[52:55], s78 offen nt
  buffer_load_dwordx2 v[98:99], v55, s[72:75], 0 offen sc1
  s_waitcnt vmcnt(19)
  v_perm_b32 v59, v184, v184, s76
  v_and_b32 v56, v59, v12
  v_and_b32 v57, v59, v13
  v_and_b32 v58, v59, v14
  v_and_b32 v59, v59, v15
  s_nop 1
  v_mfma_f32_16x16x32_bf16 v[28:31], v[56:59], a[0:3], 0
  v_perm_b32 v63, v194, v194, s76
  v_and_b32 v60, v63, v12
  v_and_b32 v61, v63, v13
  v_and_b32 v62, v63, v14
  v_and_b32 v63, v63, v15
  s_nop 1
  v_mfma_f32_16x16x32_bf16 v[32:35], v[60:63], a[0:3], 0
  v_perm_b32 v59, v204, v204, s76
  v_and_b32 v56, v59, v12
  v_and_b32 v57, v59, v13
  v_and_b32 v58, v59, v14
  v_and_b32 v59, v59, v15
  s_nop 1
  v_mfma_f32_16x16x32_bf16 v[36:39], v[56:59], a[0:3], 0
  v_perm_b32 v63, v214, v214, s76
  v_and_b32 v60, v63, v12
  v_and_b32 v61, v63, v13
  v_and_b32 v62, v63, v14
  v_and_b32 v63, v63, v15
  s_nop 1
  v_mfma_f32_16x16x32_bf16 v[40:43], v[60:63], a[0:3], 0
  v_perm_b32 v59, v184, v184, s77
  v_and_b32 v56, v59, v12
  v_and_b32 v57, v59, v13
  v_and_b32 v58, v59, v14
  v_and_b32 v59, v59, v15
  s_nop 1
  v_mfma_f32_16x16x32_bf16 v[28:31], v[56:59], a[4:7], v[28:31]
  v_perm_b32 v63, v194, v194, s77
  v_and_b32 v60, v63, v12
  v_and_b32 v61, v63, v13
  v_and_b32 v62, v63, v14
  v_and_b32 v63, v63, v15
  s_nop 1
  v_mfma_f32_16x16x32_bf16 v[32:35], v[60:63], a[4:7], v[32:35]
  v_perm_b32 v59, v204, v204, s77
  v_and_b32 v56, v59, v12
  v_and_b32 v57, v59, v13
  v_and_b32 v58, v59, v14
  v_and_b32 v59, v59, v15
  s_nop 1
  v_mfma_f32_16x16x32_bf16 v[36:39], v[56:59], a[4:7], v[36:39]
  v_perm_b32 v63, v214, v214, s77
  v_and_b32 v60, v63, v12
  v_and_b32 v61, v63, v13
  v_and_b32 v62, v63, v14
  v_and_b32 v63, v63, v15
  s_nop 1
  v_mfma_f32_16x16x32_bf16 v[40:43], v[60:63], a[4:7], v[40:43]
  v_perm_b32 v59, v185, v185, s76
  v_and_b32 v56, v59, v12
  v_and_b32 v57, v59, v13
  v_and_b32 v58, v59, v14
  v_and_b32 v59, v59, v15
  s_waitcnt vmcnt(18)
  s_nop 1
  v_mfma_f32_16x16x32_bf16 v[28:31], v[56:59], a[8:11], v[28:31]
  v_perm_b32 v63, v195, v195, s76
  v_and_b32 v60, v63, v12
  v_and_b32 v61, v63, v13
  v_and_b32 v62, v63, v14
  v_and_b32 v63, v63, v15
  s_nop 1
  v_mfma_f32_16x16x32_bf16 v[32:35], v[60:63], a[8:11], v[32:35]
  v_perm_b32 v59, v205, v205, s76
  v_and_b32 v56, v59, v12
  v_and_b32 v57, v59, v13
  v_and_b32 v58, v59, v14
  v_and_b32 v59, v59, v15
  s_nop 1
  v_mfma_f32_16x16x32_bf16 v[36:39], v[56:59], a[8:11], v[36:39]
  v_perm_b32 v63, v215, v215, s76
  v_and_b32 v60, v63, v12
  v_and_b32 v61, v63, v13
  v_and_b32 v62, v63, v14
  v_and_b32 v63, v63, v15
  s_nop 1
  v_mfma_f32_16x16x32_bf16 v[40:43], v[60:63], a[8:11], v[40:43]
  v_perm_b32 v59, v185, v185, s77
  v_and_b32 v56, v59, v12
  v_and_b32 v57, v59, v13
  v_and_b32 v58, v59, v14
  v_and_b32 v59, v59, v15
  s_waitcnt vmcnt(17)
  s_nop 1
  v_mfma_f32_16x16x32_bf16 v[28:31], v[56:59], a[12:15], v[28:31]
  v_perm_b32 v63, v195, v195, s77
  v_and_b32 v60, v63, v12
  v_and_b32 v61, v63, v13
  v_and_b32 v62, v63, v14
  v_and_b32 v63, v63, v15
  s_nop 1
  v_mfma_f32_16x16x32_bf16 v[32:35], v[60:63], a[12:15], v[32:35]
  v_perm_b32 v59, v205, v205, s77
  v_and_b32 v56, v59, v12
  v_and_b32 v57, v59, v13
  v_and_b32 v58, v59, v14
  v_and_b32 v59, v59, v15
  s_nop 1
  v_mfma_f32_16x16x32_bf16 v[36:39], v[56:59], a[12:15], v[36:39]
  v_perm_b32 v63, v215, v215, s77
  v_and_b32 v60, v63, v12
  v_and_b32 v61, v63, v13
  v_and_b32 v62, v63, v14
  v_and_b32 v63, v63, v15
  s_nop 1
  v_mfma_f32_16x16x32_bf16 v[40:43], v[60:63], a[12:15], v[40:43]
  v_perm_b32 v59, v186, v186, s76
  v_and_b32 v56, v59, v12
  v_and_b32 v57, v59, v13
  v_and_b32 v58, v59, v14
  v_and_b32 v59, v59, v15
  s_waitcnt vmcnt(16)
  s_nop 1
  v_mfma_f32_16x16x32_bf16 v[28:31], v[56:59], a[16:19], v[28:31]
  v_perm_b32 v63, v196, v196, s76
  v_and_b32 v60, v63, v12
  v_and_b32 v61, v63, v13
  v_and_b32 v62, v63, v14
  v_and_b32 v63, v63, v15
  s_nop 1
  v_mfma_f32_16x16x32_bf16 v[32:35], v[60:63], a[16:19], v[32:35]
  v_perm_b32 v59, v206, v206, s76
  v_and_b32 v56, v59, v12
  v_and_b32 v57, v59, v13
  v_and_b32 v58, v59, v14
  v_and_b32 v59, v59, v15
  s_nop 1
  v_mfma_f32_16x16x32_bf16 v[36:39], v[56:59], a[16:19], v[36:39]
  v_perm_b32 v63, v216, v216, s76
  v_and_b32 v60, v63, v12
  v_and_b32 v61, v63, v13
  v_and_b32 v62, v63, v14
  v_and_b32 v63, v63, v15
  s_nop 1
  v_mfma_f32_16x16x32_bf16 v[40:43], v[60:63], a[16:19], v[40:43]
  buffer_load_dwordx4 v[104:107], v5, s[44:47], s8 offen offset:0 nt
  v_perm_b32 v59, v186, v186, s77
  v_and_b32 v56, v59, v12
  v_and_b32 v57, v59, v13
  v_and_b32 v58, v59, v14
  v_and_b32 v59, v59, v15
  s_waitcnt vmcnt(16)
  s_nop 1
  v_mfma_f32_16x16x32_bf16 v[28:31], v[56:59], a[20:23], v[28:31]
  v_perm_b32 v63, v196, v196, s77
  v_and_b32 v60, v63, v12
  v_and_b32 v61, v63, v13
  v_and_b32 v62, v63, v14
  v_and_b32 v63, v63, v15
  s_nop 1
  v_mfma_f32_16x16x32_bf16 v[32:35], v[60:63], a[20:23], v[32:35]
  v_perm_b32 v59, v206, v206, s77
  v_and_b32 v56, v59, v12
  v_and_b32 v57, v59, v13
  v_and_b32 v58, v59, v14
  v_and_b32 v59, v59, v15
  s_nop 1
  v_mfma_f32_16x16x32_bf16 v[36:39], v[56:59], a[20:23], v[36:39]
  v_perm_b32 v63, v216, v216, s77
  v_and_b32 v60, v63, v12
  v_and_b32 v61, v63, v13
  v_and_b32 v62, v63, v14
  v_and_b32 v63, v63, v15
  s_nop 1
  v_mfma_f32_16x16x32_bf16 v[40:43], v[60:63], a[20:23], v[40:43]
  buffer_load_dwordx4 v[108:111], v5, s[44:47], s8 offen offset:128 nt
  v_perm_b32 v59, v187, v187, s76
  v_and_b32 v56, v59, v12
  v_and_b32 v57, v59, v13
  v_and_b32 v58, v59, v14
  v_and_b32 v59, v59, v15
  s_waitcnt vmcnt(16)
  s_nop 1
  v_mfma_f32_16x16x32_bf16 v[28:31], v[56:59], a[24:27], v[28:31]
  v_perm_b32 v63, v197, v197, s76
  v_and_b32 v60, v63, v12
  v_and_b32 v61, v63, v13
  v_and_b32 v62, v63, v14
  v_and_b32 v63, v63, v15
  s_nop 1
  v_mfma_f32_16x16x32_bf16 v[32:35], v[60:63], a[24:27], v[32:35]
  v_perm_b32 v59, v207, v207, s76
  v_and_b32 v56, v59, v12
  v_and_b32 v57, v59, v13
  v_and_b32 v58, v59, v14
  v_and_b32 v59, v59, v15
  s_nop 1
  v_mfma_f32_16x16x32_bf16 v[36:39], v[56:59], a[24:27], v[36:39]
  v_perm_b32 v63, v217, v217, s76
  v_and_b32 v60, v63, v12
  v_and_b32 v61, v63, v13
  v_and_b32 v62, v63, v14
  v_and_b32 v63, v63, v15
  s_nop 1
  v_mfma_f32_16x16x32_bf16 v[40:43], v[60:63], a[24:27], v[40:43]
  buffer_load_dwordx4 v[112:115], v5, s[44:47], s8 offen offset:256 nt
  s_add_u32 s8, s8, 12288
  s_cmp_ge_u32 s8, s27
  s_cselect_b32 s11, 1572864, 0
  s_sub_u32 s8, s8, s11
  v_perm_b32 v59, v187, v187, s77
  v_and_b32 v56, v59, v12
  v_and_b32 v57, v59, v13
  v_and_b32 v58, v59, v14
  v_and_b32 v59, v59, v15
  s_waitcnt vmcnt(16)
  s_nop 1
  v_mfma_f32_16x16x32_bf16 v[28:31], v[56:59], a[28:31], v[28:31]
  v_perm_b32 v63, v197, v197, s77
  v_and_b32 v60, v63, v12
  v_and_b32 v61, v63, v13
  v_and_b32 v62, v63, v14
  v_and_b32 v63, v63, v15
  s_nop 1
  v_mfma_f32_16x16x32_bf16 v[32:35], v[60:63], a[28:31], v[32:35]
  v_perm_b32 v59, v207, v207, s77
  v_and_b32 v56, v59, v12
  v_and_b32 v57, v59, v13
  v_and_b32 v58, v59, v14
  v_and_b32 v59, v59, v15
  s_nop 1
  v_mfma_f32_16x16x32_bf16 v[36:39], v[56:59], a[28:31], v[36:39]
  v_perm_b32 v63, v217, v217, s77
  v_and_b32 v60, v63, v12
  v_and_b32 v61, v63, v13
  v_and_b32 v62, v63, v14
  v_and_b32 v63, v63, v15
  s_nop 1
  v_mfma_f32_16x16x32_bf16 v[40:43], v[60:63], a[28:31], v[40:43]
  buffer_load_dwordx4 v[116:119], v5, s[44:47], s8 offen offset:0 nt
  v_perm_b32 v59, v188, v188, s76
  v_and_b32 v56, v59, v12
  v_and_b32 v57, v59, v13
  v_and_b32 v58, v59, v14
  v_and_b32 v59, v59, v15
  s_waitcnt vmcnt(16)
  s_nop 1
  v_mfma_f32_16x16x32_bf16 v[28:31], v[56:59], a[32:35], v[28:31]
  v_perm_b32 v63, v198, v198, s76
  v_and_b32 v60, v63, v12
  v_and_b32 v61, v63, v13
  v_and_b32 v62, v63, v14
  v_and_b32 v63, v63, v15
  s_nop 1
  v_mfma_f32_16x16x32_bf16 v[32:35], v[60:63], a[32:35], v[32:35]
  v_perm_b32 v59, v208, v208, s76
  v_and_b32 v56, v59, v12
  v_and_b32 v57, v59, v13
  v_and_b32 v58, v59, v14
  v_and_b32 v59, v59, v15
  s_nop 1
  v_mfma_f32_16x16x32_bf16 v[36:39], v[56:59], a[32:35], v[36:39]
  v_perm_b32 v63, v218, v218, s76
  v_and_b32 v60, v63, v12
  v_and_b32 v61, v63, v13
  v_and_b32 v62, v63, v14
  v_and_b32 v63, v63, v15
  s_nop 1
  v_mfma_f32_16x16x32_bf16 v[40:43], v[60:63], a[32:35], v[40:43]
  buffer_load_dwordx4 v[120:123], v5, s[44:47], s8 offen offset:128 nt
  v_perm_b32 v59, v188, v188, s77
  v_and_b32 v56, v59, v12
  v_and_b32 v57, v59, v13
  v_and_b32 v58, v59, v14
  v_and_b32 v59, v59, v15
  s_waitcnt vmcnt(16)
  s_nop 1
  v_mfma_f32_16x16x32_bf16 v[28:31], v[56:59], a[36:39], v[28:31]
  v_perm_b32 v63, v198, v198, s77
  v_and_b32 v60, v63, v12
  v_and_b32 v61, v63, v13
  v_and_b32 v62, v63, v14
  v_and_b32 v63, v63, v15
  s_nop 1
  v_mfma_f32_16x16x32_bf16 v[32:35], v[60:63], a[36:39], v[32:35]
  v_perm_b32 v59, v208, v208, s77
  v_and_b32 v56, v59, v12
  v_and_b32 v57, v59, v13
  v_and_b32 v58, v59, v14
  v_and_b32 v59, v59, v15
  s_nop 1
  v_mfma_f32_16x16x32_bf16 v[36:39], v[56:59], a[36:39], v[36:39]
  v_perm_b32 v63, v218, v218, s77
  v_and_b32 v60, v63, v12
  v_and_b32 v61, v63, v13
  v_and_b32 v62, v63, v14
  v_and_b32 v63, v63, v15
  s_nop 1
  v_mfma_f32_16x16x32_bf16 v[40:43], v[60:63], a[36:39], v[40:43]
  buffer_load_dwordx4 v[124:127], v5, s[44:47], s8 offen offset:256 nt
  s_add_u32 s8, s8, 12288
  s_cmp_ge_u32 s8, s27
  s_cselect_b32 s11, 1572864, 0
  s_sub_u32 s8, s8, s11
  v_perm_b32 v59, v189, v189, s76
  v_and_b32 v56, v59, v12
  v_and_b32 v57, v59, v13
  v_and_b32 v58, v59, v14
  v_and_b32 v59, v59, v15
  s_waitcnt vmcnt(16)
  s_nop 1
  v_mfma_f32_16x16x32_bf16 v[28:31], v[56:59], a[40:43], v[28:31]
  v_perm_b32 v63, v199, v199, s76
  v_and_b32 v60, v63, v12
  v_and_b32 v61, v63, v13
  v_and_b32 v62, v63, v14
  v_and_b32 v63, v63, v15
  s_nop 1
  v_mfma_f32_16x16x32_bf16 v[32:35], v[60:63], a[40:43], v[32:35]
  v_perm_b32 v59, v209, v209, s76
  v_and_b32 v56, v59, v12
  v_and_b32 v57, v59, v13
  v_and_b32 v58, v59, v14
  v_and_b32 v59, v59, v15
  s_nop 1
  v_mfma_f32_16x16x32_bf16 v[36:39], v[56:59], a[40:43], v[36:39]
  v_perm_b32 v63, v219, v219, s76
  v_and_b32 v60, v63, v12
  v_and_b32 v61, v63, v13
  v_and_b32 v62, v63, v14
  v_and_b32 v63, v63, v15
  s_nop 1
  v_mfma_f32_16x16x32_bf16 v[40:43], v[60:63], a[40:43], v[40:43]
  buffer_load_dwordx4 v[128:131], v5, s[44:47], s8 offen offset:0 nt
  v_perm_b32 v59, v189, v189, s77
  v_and_b32 v56, v59, v12
  v_and_b32 v57, v59, v13
  v_and_b32 v58, v59, v14
  v_and_b32 v59, v59, v15
  s_waitcnt vmcnt(16)
  s_nop 1
  v_mfma_f32_16x16x32_bf16 v[28:31], v[56:59], a[44:47], v[28:31]
  v_perm_b32 v63, v199, v199, s77
  v_and_b32 v60, v63, v12
  v_and_b32 v61, v63, v13
  v_and_b32 v62, v63, v14
  v_and_b32 v63, v63, v15
  s_nop 1
  v_mfma_f32_16x16x32_bf16 v[32:35], v[60:63], a[44:47], v[32:35]
  v_perm_b32 v59, v209, v209, s77
  v_and_b32 v56, v59, v12
  v_and_b32 v57, v59, v13
  v_and_b32 v58, v59, v14
  v_and_b32 v59, v59, v15
  s_nop 1
  v_mfma_f32_16x16x32_bf16 v[36:39], v[56:59], a[44:47], v[36:39]
  v_perm_b32 v63, v219, v219, s77
  v_and_b32 v60, v63, v12
  v_and_b32 v61, v63, v13
  v_and_b32 v62, v63, v14
  v_and_b32 v63, v63, v15
  s_nop 1
  v_mfma_f32_16x16x32_bf16 v[40:43], v[60:63], a[44:47], v[40:43]
  buffer_load_dwordx4 v[132:135], v5, s[44:47], s8 offen offset:128 nt
  v_perm_b32 v59, v190, v190, s76
  v_and_b32 v56, v59, v12
  v_and_b32 v57, v59, v13
  v_and_b32 v58, v59, v14
  v_and_b32 v59, v59, v15
  s_waitcnt vmcnt(16)
  s_nop 1
  v_mfma_f32_16x16x32_bf16 v[28:31], v[56:59], a[48:51], v[28:31]
  v_perm_b32 v63, v200, v200, s76
  v_and_b32 v60, v63, v12
  v_and_b32 v61, v63, v13
  v_and_b32 v62, v63, v14
  v_and_b32 v63, v63, v15
  s_nop 1
  v_mfma_f32_16x16x32_bf16 v[32:35], v[60:63], a[48:51], v[32:35]
  v_perm_b32 v59, v210, v210, s76
  v_and_b32 v56, v59, v12
  v_and_b32 v57, v59, v13
  v_and_b32 v58, v59, v14
  v_and_b32 v59, v59, v15
  s_nop 1
  v_mfma_f32_16x16x32_bf16 v[36:39], v[56:59], a[48:51], v[36:39]
  v_perm_b32 v63, v220, v220, s76
  v_and_b32 v60, v63, v12
  v_and_b32 v61, v63, v13
  v_and_b32 v62, v63, v14
  v_and_b32 v63, v63, v15
  s_nop 1
  v_mfma_f32_16x16x32_bf16 v[40:43], v[60:63], a[48:51], v[40:43]
  buffer_load_dwordx4 v[136:139], v5, s[44:47], s8 offen offset:256 nt
  s_add_u32 s8, s8, 12288
  s_cmp_ge_u32 s8, s27
  s_cselect_b32 s11, 1572864, 0
  s_sub_u32 s8, s8, s11
  v_perm_b32 v59, v190, v190, s77
  v_and_b32 v56, v59, v12
  v_and_b32 v57, v59, v13
  v_and_b32 v58, v59, v14
  v_and_b32 v59, v59, v15
  s_waitcnt vmcnt(16)
  s_nop 1
  v_mfma_f32_16x16x32_bf16 v[28:31], v[56:59], a[52:55], v[28:31]
  v_perm_b32 v63, v200, v200, s77
  v_and_b32 v60, v63, v12
  v_and_b32 v61, v63, v13
  v_and_b32 v62, v63, v14
  v_and_b32 v63, v63, v15
  s_nop 1
  v_mfma_f32_16x16x32_bf16 v[32:35], v[60:63], a[52:55], v[32:35]
  v_perm_b32 v59, v210, v210, s77
  v_and_b32 v56, v59, v12
  v_and_b32 v57, v59, v13
  v_and_b32 v58, v59, v14
  v_and_b32 v59, v59, v15
  s_nop 1
  v_mfma_f32_16x16x32_bf16 v[36:39], v[56:59], a[52:55], v[36:39]
  v_perm_b32 v63, v220, v220, s77
  v_and_b32 v60, v63, v12
  v_and_b32 v61, v63, v13
  v_and_b32 v62, v63, v14
  v_and_b32 v63, v63, v15
  s_nop 1
  v_mfma_f32_16x16x32_bf16 v[40:43], v[60:63], a[52:55], v[40:43]
  buffer_load_dwordx4 v[140:143], v5, s[44:47], s8 offen offset:0 nt
  v_perm_b32 v59, v191, v191, s76
  v_and_b32 v56, v59, v12
  v_and_b32 v57, v59, v13
  v_and_b32 v58, v59, v14
  v_and_b32 v59, v59, v15
  s_waitcnt vmcnt(16)
  s_nop 1
  v_mfma_f32_16x16x32_bf16 v[28:31], v[56:59], a[56:59], v[28:31]
  v_perm_b32 v63, v201, v201, s76
  v_and_b32 v60, v63, v12
  v_and_b32 v61, v63, v13
  v_and_b32 v62, v63, v14
  v_and_b32 v63, v63, v15
  s_nop 1
  v_mfma_f32_16x16x32_bf16 v[32:35], v[60:63], a[56:59], v[32:35]
  v_perm_b32 v59, v211, v211, s76
  v_and_b32 v56, v59, v12
  v_and_b32 v57, v59, v13
  v_and_b32 v58, v59, v14
  v_and_b32 v59, v59, v15
  s_nop 1
  v_mfma_f32_16x16x32_bf16 v[36:39], v[56:59], a[56:59], v[36:39]
  v_perm_b32 v63, v221, v221, s76
  v_and_b32 v60, v63, v12
  v_and_b32 v61, v63, v13
  v_and_b32 v62, v63, v14
  v_and_b32 v63, v63, v15
  s_nop 1
  v_mfma_f32_16x16x32_bf16 v[40:43], v[60:63], a[56:59], v[40:43]
  buffer_load_dwordx4 v[144:147], v5, s[44:47], s8 offen offset:128 nt
  v_perm_b32 v59, v191, v191, s77
  v_and_b32 v56, v59, v12
  v_and_b32 v57, v59, v13
  v_and_b32 v58, v59, v14
  v_and_b32 v59, v59, v15
  s_waitcnt vmcnt(16)
  s_nop 1
  v_mfma_f32_16x16x32_bf16 v[28:31], v[56:59], a[60:63], v[28:31]
  v_perm_b32 v63, v201, v201, s77
  v_and_b32 v60, v63, v12
  v_and_b32 v61, v63, v13
  v_and_b32 v62, v63, v14
  v_and_b32 v63, v63, v15
  s_nop 1
  v_mfma_f32_16x16x32_bf16 v[32:35], v[60:63], a[60:63], v[32:35]
  v_perm_b32 v59, v211, v211, s77
  v_and_b32 v56, v59, v12
  v_and_b32 v57, v59, v13
  v_and_b32 v58, v59, v14
  v_and_b32 v59, v59, v15
  s_nop 1
  v_mfma_f32_16x16x32_bf16 v[36:39], v[56:59], a[60:63], v[36:39]
  v_perm_b32 v63, v221, v221, s77
  v_and_b32 v60, v63, v12
  v_and_b32 v61, v63, v13
  v_and_b32 v62, v63, v14
  v_and_b32 v63, v63, v15
  s_nop 1
  v_mfma_f32_16x16x32_bf16 v[40:43], v[60:63], a[60:63], v[40:43]
  buffer_load_dwordx4 v[148:151], v5, s[44:47], s8 offen offset:256 nt
  s_add_u32 s8, s8, 12288
  s_cmp_ge_u32 s8, s27
  s_cselect_b32 s11, 1572864, 0
  s_sub_u32 s8, s8, s11
  v_perm_b32 v59, v192, v192, s76
  v_and_b32 v56, v59, v12
  v_and_b32 v57, v59, v13
  v_and_b32 v58, v59, v14
  v_and_b32 v59, v59, v15
  s_waitcnt vmcnt(16)
  s_nop 1
  v_mfma_f32_16x16x32_bf16 v[28:31], v[56:59], a[64:67], v[28:31]
  v_perm_b32 v63, v202, v202, s76
  v_and_b32 v60, v63, v12
  v_and_b32 v61, v63, v13
  v_and_b32 v62, v63, v14
  v_and_b32 v63, v63, v15
  s_nop 1
  v_mfma_f32_16x16x32_bf16 v[32:35], v[60:63], a[64:67], v[32:35]
  v_perm_b32 v59, v212, v212, s76
  v_and_b32 v56, v59, v12
  v_and_b32 v57, v59, v13
  v_and_b32 v58, v59, v14
  v_and_b32 v59, v59, v15
  s_nop 1
  v_mfma_f32_16x16x32_bf16 v[36:39], v[56:59], a[64:67], v[36:39]
  v_perm_b32 v63, v222, v222, s76
  v_and_b32 v60, v63, v12
  v_and_b32 v61, v63, v13
  v_and_b32 v62, v63, v14
  v_and_b32 v63, v63, v15
  s_nop 1
  v_mfma_f32_16x16x32_bf16 v[40:43], v[60:63], a[64:67], v[40:43]
  buffer_load_dwordx4 v[152:155], v5, s[44:47], s8 offen offset:0 nt
  v_perm_b32 v59, v192, v192, s77
  v_and_b32 v56, v59, v12
  v_and_b32 v57, v59, v13
  v_and_b32 v58, v59, v14
  v_and_b32 v59, v59, v15
  s_waitcnt vmcnt(16)
  s_nop 1
  v_mfma_f32_16x16x32_bf16 v[28:31], v[56:59], a[68:71], v[28:31]
  v_perm_b32 v63, v202, v202, s77
  v_and_b32 v60, v63, v12
  v_and_b32 v61, v63, v13
  v_and_b32 v62, v63, v14
  v_and_b32 v63, v63, v15
  s_nop 1
  v_mfma_f32_16x16x32_bf16 v[32:35], v[60:63], a[68:71], v[32:35]
  v_perm_b32 v59, v212, v212, s77
  v_and_b32 v56, v59, v12
  v_and_b32 v57, v59, v13
  v_and_b32 v58, v59, v14
  v_and_b32 v59, v59, v15
  s_nop 1
  v_mfma_f32_16x16x32_bf16 v[36:39], v[56:59], a[68:71], v[36:39]
  v_perm_b32 v63, v222, v222, s77
  v_and_b32 v60, v63, v12
  v_and_b32 v61, v63, v13
  v_and_b32 v62, v63, v14
  v_and_b32 v63, v63, v15
  s_nop 1
  v_mfma_f32_16x16x32_bf16 v[40:43], v[60:63], a[68:71], v[40:43]
  buffer_load_dwordx4 v[156:159], v5, s[44:47], s8 offen offset:128 nt
  v_perm_b32 v59, v193, v193, s76
  v_and_b32 v56, v59, v12
  v_and_b32 v57, v59, v13
  v_and_b32 v58, v59, v14
  v_and_b32 v59, v59, v15
  s_waitcnt vmcnt(16)
  s_nop 1
  v_mfma_f32_16x16x32_bf16 v[28:31], v[56:59], a[72:75], v[28:31]
  v_perm_b32 v63, v203, v203, s76
  v_and_b32 v60, v63, v12
  v_and_b32 v61, v63, v13
  v_and_b32 v62, v63, v14
  v_and_b32 v63, v63, v15
  s_nop 1
  v_mfma_f32_16x16x32_bf16 v[32:35], v[60:63], a[72:75], v[32:35]
  v_perm_b32 v59, v213, v213, s76
  v_and_b32 v56, v59, v12
  v_and_b32 v57, v59, v13
  v_and_b32 v58, v59, v14
  v_and_b32 v59, v59, v15
  s_nop 1
  v_mfma_f32_16x16x32_bf16 v[36:39], v[56:59], a[72:75], v[36:39]
  v_perm_b32 v63, v223, v223, s76
  v_and_b32 v60, v63, v12
  v_and_b32 v61, v63, v13
  v_and_b32 v62, v63, v14
  v_and_b32 v63, v63, v15
  s_nop 1
  v_mfma_f32_16x16x32_bf16 v[40:43], v[60:63], a[72:75], v[40:43]
  buffer_load_dwordx4 v[160:163], v5, s[44:47], s8 offen offset:256 nt
  s_add_u32 s8, s8, s17
  s_cmp_ge_u32 s8, s27
  s_cselect_b32 s11, 1572864, 0
  s_sub_u32 s8, s8, s11
  v_perm_b32 v59, v193, v193, s77
  v_and_b32 v56, v59, v12
  v_and_b32 v57, v59, v13
  v_and_b32 v58, v59, v14
  v_and_b32 v59, v59, v15
  s_waitcnt vmcnt(16)
  s_nop 1
  v_mfma_f32_16x16x32_bf16 v[28:31], v[56:59], a[76:79], v[28:31]
  v_perm_b32 v63, v203, v203, s77
  v_and_b32 v60, v63, v12
  v_and_b32 v61, v63, v13
  v_and_b32 v62, v63, v14
  v_and_b32 v63, v63, v15
  s_nop 1
  v_mfma_f32_16x16x32_bf16 v[32:35], v[60:63], a[76:79], v[32:35]
  v_perm_b32 v59, v213, v213, s77
  v_and_b32 v56, v59, v12
  v_and_b32 v57, v59, v13
  v_and_b32 v58, v59, v14
  v_and_b32 v59, v59, v15
  s_nop 1
  v_mfma_f32_16x16x32_bf16 v[36:39], v[56:59], a[76:79], v[36:39]
  v_perm_b32 v63, v223, v223, s77
  v_and_b32 v60, v63, v12
  v_and_b32 v61, v63, v13
  v_and_b32 v62, v63, v14
  v_and_b32 v63, v63, v15
  s_nop 1
  v_mfma_f32_16x16x32_bf16 v[40:43], v[60:63], a[76:79], v[40:43]
  buffer_load_dwordx4 v[164:167], v5, s[44:47], s8 offen offset:0 nt
  s_nop 6
  ds_write_b128 v97, v[28:31] offset:16448
  ds_write_b128 v97, v[32:35] offset:17472
  ds_write_b128 v97, v[36:39] offset:18496
  ds_write_b128 v97, v[40:43] offset:19520
  s_lshl_b32 s11, s3, 10
  s_add_u32 s11, s11, 16448
  v_add_u32 v4, s11, v96
  s_waitcnt lgkmcnt(0)
  s_barrier
  ds_read_b128 v[64:67], v4 offset:0
  ds_read_b128 v[68:71], v4 offset:640
  ds_read_b128 v[72:75], v4 offset:4096
  ds_read_b128 v[76:79], v4 offset:4736
  ds_read_b128 v[80:83], v4 offset:8192
  ds_read_b128 v[84:87], v4 offset:8832
  ds_read_b128 v[88:91], v4 offset:12288
  ds_read_b128 v[92:95], v4 offset:12928
  s_waitcnt lgkmcnt(6)
  v_add_f32 v64, v64, v68
  v_add_f32 v65, v65, v69
  v_add_f32 v66, v66, v70
  v_add_f32 v67, v67, v71
  s_waitcnt lgkmcnt(4)
  v_add_f32 v72, v72, v76
  v_add_f32 v73, v73, v77
  v_add_f32 v74, v74, v78
  v_add_f32 v75, v75, v79
  v_add_f32 v64, v64, v72
  v_add_f32 v65, v65, v73
  v_add_f32 v66, v66, v74
  v_add_f32 v67, v67, v75
  s_waitcnt lgkmcnt(2)
  v_add_f32 v80, v80, v84
  v_add_f32 v81, v81, v85
  v_add_f32 v82, v82, v86
  v_add_f32 v83, v83, v87
  v_add_f32 v64, v64, v80
  v_add_f32 v65, v65, v81
  v_add_f32 v66, v66, v82
  v_add_f32 v67, v67, v83
  s_waitcnt lgkmcnt(0)
  v_add_f32 v88, v88, v92
  v_add_f32 v89, v89, v93
  v_add_f32 v90, v90, v94
  v_add_f32 v91, v91, v95
  v_add_f32 v56, v64, v88
  v_add_f32 v57, v65, v89
  v_add_f32 v58, v66, v90
  v_add_f32 v59, v67, v91
  s_waitcnt vmcnt(16)
L_np:
  v_readfirstlane_b32 s92, v98
  v_readfirstlane_b32 s93, v99
  s_add_u32 s9, s9, 1
  s_nop 0
  s_cmp_eq_u32 s92, 0
  s_cbranch_scc1 L_np_z
  s_sub_u32 s11, s92, s23
  s_add_u32 s11, s11, 5000
  s_cmp_lt_u32 s11, 10000
  s_cbranch_scc1 L_np_ok
  s_cmp_gt_u32 s9, 3000
  s_cbranch_scc1 L_np_ok
L_np_z:
  s_cmp_gt_u32 s9, 100000
  s_cbranch_scc1 L_np_ok
  buffer_load_dwordx2 v[98:99], v55, s[72:75], 0 offen sc1
  s_waitcnt vmcnt(0)
  s_branch L_np
L_np_ok:
  v_cvt_pk_bf16_f32 v56, v56, v57
  v_cvt_pk_bf16_f32 v57, v58, v59
  v_mov_b32 v58, s92
  v_mov_b32 v59, s93
  v_lshlrev_b32 v4, 4, v0
  s_mov_b64 exec, 0xffff
  buffer_store_dwordx4 v[56:59], v4, s[64:67], s100 offen sc1
  s_mov_b64 exec, -1
  buffer_load_dwordx4 v[168:171], v5, s[44:47], s8 offen offset:128 nt
  buffer_load_dwordx4 v[172:175], v5, s[44:47], s8 offen offset:256 nt
  s_add_u32 s8, s8, 12288
  s_cmp_ge_u32 s8, s27
  s_cselect_b32 s11, 1572864, 0
  s_sub_u32 s8, s8, s11
  buffer_load_dwordx4 v[176:179], v5, s[44:47], s8 offen offset:0 nt
  buffer_load_dwordx4 v[180:183], v5, s[44:47], s8 offen offset:128 nt
  buffer_load_dwordx4 v[184:187], v5, s[44:47], s8 offen offset:256 nt
  s_add_u32 s8, s8, 12288
  s_cmp_ge_u32 s8, s27
  s_cselect_b32 s11, 1572864, 0
  s_sub_u32 s8, s8, s11
  s_branch L_join
L_noprod:
  s_add_u32 s11, s94, s33
  s_and_b32 s11, s11, 7
  s_cmp_lt_u32 s94, 8
  s_cselect_b32 s11, s11, s7
  s_cselect_b32 s12, s16, s26
  s_cselect_b32 s17, 36, 1
  s_mul_i32 s17, s17, 12288
  s_cselect_b32 s27, 0, -1
  s_and_b32 s13, s11, 3
  s_lshl_b32 s13, s13, 5
  s_add_u32 s13, s13, s5
  s_mul_i32 s13, s13, 1572864
  s_mul_i32 s43, s3, 3072
  s_add_u32 s13, s13, s43
  s_add_u32 s43, s13, s12
  s_add_u32 s13, s13, 1572864
  s_or_b32 s27, s27, s13
  s_cmp_ge_u32 s11, 4
  s_cselect_b32 s44, s28, s18
  s_cselect_b32 s45, s29, s19
  s_cselect_b32 s48, s30, s20
  s_cselect_b32 s49, s31, s21
  s_mov_b32 s8, s43
  s_add_u32 s94, s94, 1
  buffer_load_dwordx4 v[104:107], v5, s[44:47], s8 offen offset:0 nt
  buffer_load_dwordx4 v[108:111], v5, s[44:47], s8 offen offset:128 nt
  buffer_load_dwordx4 v[112:115], v5, s[44:47], s8 offen offset:256 nt
  s_add_u32 s8, s8, 12288
  s_cmp_ge_u32 s8, s27
  s_cselect_b32 s11, 1572864, 0
  s_sub_u32 s8, s8, s11
  buffer_load_dwordx4 v[116:119], v5, s[44:47], s8 offen offset:0 nt
  buffer_load_dwordx4 v[120:123], v5, s[44:47], s8 offen offset:128 nt
  buffer_load_dwordx4 v[124:127], v5, s[44:47], s8 offen offset:256 nt
  s_add_u32 s8, s8, 12288
  s_cmp_ge_u32 s8, s27
  s_cselect_b32 s11, 1572864, 0
  s_sub_u32 s8, s8, s11
  buffer_load_dwordx4 v[128:131], v5, s[44:47], s8 offen offset:0 nt
  buffer_load_dwordx4 v[132:135], v5, s[44:47], s8 offen offset:128 nt
  buffer_load_dwordx4 v[136:139], v5, s[44:47], s8 offen offset:256 nt
  s_add_u32 s8, s8, 12288
  s_cmp_ge_u32 s8, s27
  s_cselect_b32 s11, 1572864, 0
  s_sub_u32 s8, s8, s11
  buffer_load_dwordx4 v[140:143], v5, s[44:47], s8 offen offset:0 nt
  buffer_load_dwordx4 v[144:147], v5, s[44:47], s8 offen offset:128 nt
  buffer_load_dwordx4 v[148:151], v5, s[44:47], s8 offen offset:256 nt
  s_add_u32 s8, s8, 12288
  s_cmp_ge_u32 s8, s27
  s_cselect_b32 s11, 1572864, 0
  s_sub_u32 s8, s8, s11
  s_cmp_lg_u32 s6, 0
  s_cselect_b32 s56, s34, s24
  s_cselect_b32 s57, s35, s25
  s_mul_i32 s14, s5, 245760
  s_add_u32 s56, s56, s14
  s_addc_u32 s57, s57, 0
  s_mov_b32 s58, 245760
  s_mov_b32 s59, 0x20000
  s_mov_b32 s64, s40
  s_mov_b32 s65, s41
  s_mov_b32 s66, 4194304
  s_mov_b32 s67, 0x20000
  s_mov_b32 s68, s36
  s_mov_b32 s69, s37
  s_mov_b32 s70, 10240
  s_mov_b32 s71, 0x20000
  s_mov_b32 s72, s38
  s_mov_b32 s73, s39
  s_mov_b32 s74, 256
  s_mov_b32 s75, 0x20000
  s_mov_b32 s96, s56
  s_mov_b32 s97, s57
  s_mov_b32 s99, 0x20000
  s_cmp_lt_u32 s3, 2
  s_cselect_b32 s98, 245760, 0
  v_mov_b32 v55, 128
  s_mov_b32 s10, 0x3dd53b95
  s_mov_b32 s76, 0x01000100
  s_mov_b32 s77, 0x03020302
  v_and_b32 v4, 1, v0
  v_cmp_eq_u32 vcc, 1, v4
  v_mov_b32 v16, 0xffff
  v_mov_b32 v17, 0xffff0000
  v_cndmask_b32 v16, v16, v17, vcc
  v_lshrrev_b32 v4, 1, v3
  v_cmp_eq_u32 vcc, 0, v4
  s_nop 1
  v_cndmask_b32 v12, 0, v16, vcc
  v_cmp_eq_u32 vcc, 1, v4
  s_nop 1
  v_cndmask_b32 v13, 0, v16, vcc
  v_cmp_eq_u32 vcc, 2, v4
  s_nop 1
  v_cndmask_b32 v14, 0, v16, vcc
  v_cmp_eq_u32 vcc, 3, v4
  s_nop 1
  v_cndmask_b32 v15, 0, v16, vcc
  s_mul_i32 s12, s3, 4096
  v_lshlrev_b32 v97, 4, v0
  v_add_u32 v97, s12, v97
  v_lshrrev_b32 v96, 4, v0
  v_lshlrev_b32 v96, 10, v96
  v_and_b32 v4, 1, v0
  v_lshl_add_u32 v96, v4, 8, v96
  v_bfe_u32 v4, v0, 1, 3
  v_lshl_add_u32 v96, v4, 4, v96
  buffer_load_dwordx2 v[98:99], v55, s[72:75], 0 offen sc1
  buffer_load_dwordx4 v[152:155], v5, s[44:47], s8 offen offset:0 nt
  buffer_load_dwordx4 v[156:159], v5, s[44:47], s8 offen offset:128 nt
  buffer_load_dwordx4 v[160:163], v5, s[44:47], s8 offen offset:256 nt
  s_add_u32 s8, s8, s17
  s_cmp_ge_u32 s8, s27
  s_cselect_b32 s11, 1572864, 0
  s_sub_u32 s8, s8, s11
  buffer_load_dwordx4 v[164:167], v5, s[44:47], s8 offen offset:0 nt
  buffer_load_dwordx4 v[168:171], v5, s[44:47], s8 offen offset:128 nt
  buffer_load_dwordx4 v[172:175], v5, s[44:47], s8 offen offset:256 nt
  s_add_u32 s8, s8, 12288
  s_cmp_ge_u32 s8, s27
  s_cselect_b32 s11, 1572864, 0
  s_sub_u32 s8, s8, s11
  buffer_load_dwordx4 v[176:179], v5, s[44:47], s8 offen offset:0 nt
  buffer_load_dwordx4 v[180:183], v5, s[44:47], s8 offen offset:128 nt
  buffer_load_dwordx4 v[184:187], v5, s[44:47], s8 offen offset:256 nt
  s_add_u32 s8, s8, 12288
  s_cmp_ge_u32 s8, s27
  s_cselect_b32 s11, 1572864, 0
  s_sub_u32 s8, s8, s11
  s_waitcnt vmcnt(9)
L_nn:
  v_readfirstlane_b32 s92, v98
  v_readfirstlane_b32 s93, v99
  s_add_u32 s9, s9, 1
  s_nop 0
  s_cmp_eq_u32 s92, 0
  s_cbranch_scc1 L_nn_z
  s_sub_u32 s11, s92, s23
  s_add_u32 s11, s11, 5000
  s_cmp_lt_u32 s11, 10000
  s_cbranch_scc1 L_nn_ok
  s_cmp_gt_u32 s9, 3000
  s_cbranch_scc1 L_nn_ok
L_nn_z:
  s_cmp_gt_u32 s9, 100000
  s_cbranch_scc1 L_nn_ok
  buffer_load_dwordx2 v[98:99], v55, s[72:75], 0 offen sc1
  s_waitcnt vmcnt(0)
  s_branch L_nn
L_nn_ok:
L_join:
  s_waitcnt vmcnt(10)
  s_and_b32 s32, s33, 7
  s_lshl_b32 s11, s5, 3
  s_add_u32 s11, s11, s32
  s_mul_i32 s11, s11, 768
  s_add_u32 s78, s11, 1048576
  v_lshlrev_b32 v7, 3, v0
  v_mov_b32 v102, s92
  v_mov_b32 v103, s93
  s_mov_b32 s100, 0
  s_mov_b32 s22, 0
  v_mov_b32 v1, 43328
  v_mov_b32 v4, 0
  ds_write_b32 v1, v4
  s_xor_b32 s11, s2, 4
  s_andn2_b32 s11, s11, 56
  s_lshl_b32 s11, s11, 7
  s_add_u32 s11, s11, 2162688
  v_writelane_b32 v55, s11, 0
  s_xor_b32 s11, s2, 77
  s_andn2_b32 s11, s11, 56
  s_lshl_b32 s11, s11, 7
  s_add_u32 s11, s11, 2162688
  v_writelane_b32 v55, s11, 1
  s_xor_b32 s11, s2, 154
  s_andn2_b32 s11, s11, 56
  s_lshl_b32 s11, s11, 7
  s_add_u32 s11, s11, 2162688
  v_writelane_b32 v55, s11, 2
  s_xor_b32 s11, s2, 239
  s_andn2_b32 s11, s11, 56
  s_lshl_b32 s11, s11, 7
  s_add_u32 s11, s11, 2162688
  v_writelane_b32 v55, s11, 3
  s_xor_b32 s11, s2, 35
  s_andn2_b32 s11, s11, 56
  s_lshl_b32 s11, s11, 7
  s_add_u32 s11, s11, 2162688
  v_writelane_b32 v55, s11, 4
  s_xor_b32 s11, s2, 118
  s_andn2_b32 s11, s11, 56
  s_lshl_b32 s11, s11, 7
  s_add_u32 s11, s11, 2162688
  v_writelane_b32 v55, s11, 5
  s_xor_b32 s11, s2, 201
  s_andn2_b32 s11, s11, 56
  s_lshl_b32 s11, s11, 7
  s_add_u32 s11, s11, 2162688
  v_writelane_b32 v55, s11, 6
  s_xor_b32 s11, s2, 172
  s_andn2_b32 s11, s11, 56
  s_lshl_b32 s11, s11, 7
  s_add_u32 s11, s11, 2162688
  v_writelane_b32 v55, s11, 7
  buffer_load_dwordx4 v[64:67], v6, s[64:67], s78 offen offset:0 sc1
  buffer_load_dwordx4 v[68:71], v6, s[64:67], s78 offen offset:16 sc1
  buffer_load_dwordx4 v[72:75], v6, s[64:67], s78 offen offset:256 sc1
  buffer_load_dwordx4 v[76:79], v6, s[64:67], s78 offen offset:272 sc1
  buffer_load_dwordx4 v[80:83], v6, s[64:67], s78 offen offset:512 sc1
  buffer_load_dwordx4 v[84:87], v6, s[64:67], s78 offen offset:528 sc1
  buffer_load_dwordx4 v[188:191], v5, s[44:47], s8 offen offset:0 nt
  buffer_load_dwordx4 v[192:195], v5, s[44:47], s8 offen offset:128 nt
  buffer_load_dwordx4 v[196:199], v5, s[44:47], s8 offen offset:256 nt
  s_add_u32 s8, s8, 12288
  s_cmp_ge_u32 s8, s27
  s_cselect_b32 s11, 1572864, 0
  s_sub_u32 s8, s8, s11
  buffer_load_dwordx4 v[200:203], v5, s[44:47], s8 offen offset:0 nt
  buffer_load_dwordx4 v[204:207], v5, s[44:47], s8 offen offset:128 nt
  buffer_load_dwordx4 v[208:211], v5, s[44:47], s8 offen offset:256 nt
  s_add_u32 s8, s8, 12288
  s_cmp_ge_u32 s8, s27
  s_cselect_b32 s11, 1572864, 0
  s_sub_u32 s8, s8, s11
  buffer_load_dwordx4 v[212:215], v5, s[44:47], s8 offen offset:0 nt
  buffer_load_dwordx4 v[216:219], v5, s[44:47], s8 offen offset:128 nt
  buffer_load_dwordx4 v[220:223], v5, s[44:47], s8 offen offset:256 nt
  s_add_u32 s8, s8, s17
  s_cmp_ge_u32 s8, s27
  s_cselect_b32 s11, 1572864, 0
  s_sub_u32 s8, s8, s11
  s_waitcnt vmcnt(9)
  s_branch L_qc3
L_qp3:
  s_add_u32 s9, s9, 1
  s_cmp_gt_u32 s9, 100000
  s_cbranch_scc1 L_qk3
  buffer_load_dwordx4 v[64:67], v6, s[64:67], s78 offen offset:0 sc1
  buffer_load_dwordx4 v[68:71], v6, s[64:67], s78 offen offset:16 sc1
  buffer_load_dwordx4 v[72:75], v6, s[64:67], s78 offen offset:256 sc1
  buffer_load_dwordx4 v[76:79], v6, s[64:67], s78 offen offset:272 sc1
  buffer_load_dwordx4 v[80:83], v6, s[64:67], s78 offen offset:512 sc1
  buffer_load_dwordx4 v[84:87], v6, s[64:67], s78 offen offset:528 sc1
  s_waitcnt vmcnt(0)
L_qc3:
  v_xor_b32 v66, s92, v66
  v_xor_b32 v67, s93, v67
  v_xor_b32 v70, s92, v70
  v_xor_b32 v71, s93, v71
  v_xor_b32 v74, s92, v74
  v_xor_b32 v75, s93, v75
  v_xor_b32 v78, s92, v78
  v_xor_b32 v79, s93, v79
  v_xor_b32 v82, s92, v82
  v_xor_b32 v83, s93, v83
  v_xor_b32 v86, s92, v86
  v_xor_b32 v87, s93, v87
  v_or_b32 v4, v66, v67
  v_or3_b32 v4, v4, v70, v71
  v_or3_b32 v4, v4, v74, v75
  v_or3_b32 v4, v4, v78, v79
  v_or3_b32 v4, v4, v82, v83
  v_or3_b32 v4, v4, v86, v87
  v_cmp_ne_u32 vcc, 0, v4
  s_nop 1
  s_cbranch_vccnz L_qp3
L_qk3:
  v_mov_b32 v16, v64
  v_mov_b32 v17, v65
  v_mov_b32 v18, v68
  v_mov_b32 v19, v69
  v_mov_b32 v20, v72
  v_mov_b32 v21, v73
  v_mov_b32 v22, v76
  v_mov_b32 v23, v77
  v_mov_b32 v24, v80
  v_mov_b32 v25, v81
  v_mov_b32 v26, v84
  v_mov_b32 v27, v85
  s_mov_b32 vcc_lo, s22
  s_mov_b32 vcc_hi, 0
  v_dot2_f32_bf16 v40, v104, v16, 0
  v_dot2_f32_bf16 v40, v105, v17, v40
  v_dot2_f32_bf16 v40, v106, v18, v40
  v_dot2_f32_bf16 v40, v107, v19, v40
  s_cbranch_vccnz L_ts4
L_th4:
  buffer_load_dwordx4 v[104:107], v5, s[44:47], s8 offen offset:0 nt
  v_dot2_f32_bf16 v40, v108, v20, v40
  v_dot2_f32_bf16 v40, v109, v21, v40
  v_dot2_f32_bf16 v40, v110, v22, v40
  v_dot2_f32_bf16 v40, v111, v23, v40
  s_cbranch_vccnz L_ts5
L_th5:
  buffer_load_dwordx4 v[108:111], v5, s[44:47], s8 offen offset:128 nt
  v_dot2_f32_bf16 v40, v112, v24, v40
  v_dot2_f32_bf16 v40, v113, v25, v40
  v_dot2_f32_bf16 v40, v114, v26, v40
  v_dot2_f32_bf16 v40, v115, v27, v40
  s_cbranch_vccnz L_ts6
L_th6:
  buffer_load_dwordx4 v[112:115], v5, s[44:47], s8 offen offset:256 nt
  s_add_u32 s8, s8, 12288
  s_cmp_ge_u32 s8, s27
  s_cselect_b32 s11, 1572864, 0
  s_sub_u32 s8, s8, s11
  s_nop 1
  v_add_f32_dpp v40, v40, v40 quad_perm:[1,0,3,2] row_mask:0xf bank_mask:0xf
  s_nop 1
  v_add_f32_dpp v40, v40, v40 quad_perm:[2,3,0,1] row_mask:0xf bank_mask:0xf
  s_nop 1
  v_add_f32_dpp v40, v40, v40 row_half_mirror row_mask:0xf bank_mask:0xf
  v_dot2_f32_bf16 v41, v116, v16, 0
  v_dot2_f32_bf16 v41, v117, v17, v41
  v_dot2_f32_bf16 v41, v118, v18, v41
  v_dot2_f32_bf16 v41, v119, v19, v41
  s_cbranch_vccnz L_ts7
L_th7:
  buffer_load_dwordx4 v[116:119], v5, s[44:47], s8 offen offset:0 nt
  v_dot2_f32_bf16 v41, v120, v20, v41
  v_dot2_f32_bf16 v41, v121, v21, v41
  v_dot2_f32_bf16 v41, v122, v22, v41
  v_dot2_f32_bf16 v41, v123, v23, v41
  s_cbranch_vccnz L_ts8
L_th8:
  buffer_load_dwordx4 v[120:123], v5, s[44:47], s8 offen offset:128 nt
  v_dot2_f32_bf16 v41, v124, v24, v41
  v_dot2_f32_bf16 v41, v125, v25, v41
  v_dot2_f32_bf16 v41, v126, v26, v41
  v_dot2_f32_bf16 v41, v127, v27, v41
  s_cbranch_vccnz L_ts9
L_th9:
  buffer_load_dwordx4 v[124:127], v5, s[44:47], s8 offen offset:256 nt
  s_add_u32 s8, s8, 12288
  s_cmp_ge_u32 s8, s27
  s_cselect_b32 s11, 1572864, 0
  s_sub_u32 s8, s8, s11
  s_nop 1
  v_add_f32_dpp v41, v41, v41 quad_perm:[1,0,3,2] row_mask:0xf bank_mask:0xf
  s_nop 1
  v_add_f32_dpp v41, v41, v41 quad_perm:[2,3,0,1] row_mask:0xf bank_mask:0xf
  s_nop 1
  v_add_f32_dpp v41, v41, v41 row_half_mirror row_mask:0xf bank_mask:0xf
  v_dot2_f32_bf16 v42, v128, v16, 0
  v_dot2_f32_bf16 v42, v129, v17, v42
  v_dot2_f32_bf16 v42, v130, v18, v42
  v_dot2_f32_bf16 v42, v131, v19, v42
  v_dot2_f32_bf16 v42, v132, v20, v42
  v_dot2_f32_bf16 v42, v133, v21, v42
  v_dot2_f32_bf16 v42, v134, v22, v42
  v_dot2_f32_bf16 v42, v135, v23, v42
  v_dot2_f32_bf16 v42, v136, v24, v42
  v_dot2_f32_bf16 v42, v137, v25, v42
  v_dot2_f32_bf16 v42, v138, v26, v42
  v_dot2_f32_bf16 v42, v139, v27, v42
  s_nop 2
  v_add_f32_dpp v42, v42, v42 quad_perm:[1,0,3,2] row_mask:0xf bank_mask:0xf
  s_nop 1
  v_add_f32_dpp v42, v42, v42 quad_perm:[2,3,0,1] row_mask:0xf bank_mask:0xf
  s_nop 1
  v_add_f32_dpp v42, v42, v42 row_half_mirror row_mask:0xf bank_mask:0xf
  v_dot2_f32_bf16 v43, v140, v16, 0
  v_dot2_f32_bf16 v43, v141, v17, v43
  v_dot2_f32_bf16 v43, v142, v18, v43
  v_dot2_f32_bf16 v43, v143, v19, v43
  v_dot2_f32_bf16 v43, v144, v20, v43
  v_dot2_f32_bf16 v43, v145, v21, v43
  v_dot2_f32_bf16 v43, v146, v22, v43
  v_dot2_f32_bf16 v43, v147, v23, v43
  v_dot2_f32_bf16 v43, v148, v24, v43
  v_dot2_f32_bf16 v43, v149, v25, v43
  v_dot2_f32_bf16 v43, v150, v26, v43
  v_dot2_f32_bf16 v43, v151, v27, v43
  s_nop 2
  v_add_f32_dpp v43, v43, v43 quad_perm:[1,0,3,2] row_mask:0xf bank_mask:0xf
  s_nop 1
  v_add_f32_dpp v43, v43, v43 quad_perm:[2,3,0,1] row_mask:0xf bank_mask:0xf
  s_nop 1
  v_add_f32_dpp v43, v43, v43 row_half_mirror row_mask:0xf bank_mask:0xf
  v_dot2_f32_bf16 v44, v152, v16, 0
  v_dot2_f32_bf16 v44, v153, v17, v44
  v_dot2_f32_bf16 v44, v154, v18, v44
  v_dot2_f32_bf16 v44, v155, v19, v44
  v_dot2_f32_bf16 v44, v156, v20, v44
  v_dot2_f32_bf16 v44, v157, v21, v44
  v_dot2_f32_bf16 v44, v158, v22, v44
  v_dot2_f32_bf16 v44, v159, v23, v44
  v_dot2_f32_bf16 v44, v160, v24, v44
  v_dot2_f32_bf16 v44, v161, v25, v44
  v_dot2_f32_bf16 v44, v162, v26, v44
  v_dot2_f32_bf16 v44, v163, v27, v44
  s_nop 2
  v_add_f32_dpp v44, v44, v44 quad_perm:[1,0,3,2] row_mask:0xf bank_mask:0xf
  s_nop 1
  v_add_f32_dpp v44, v44, v44 quad_perm:[2,3,0,1] row_mask:0xf bank_mask:0xf
  s_nop 1
  v_add_f32_dpp v44, v44, v44 row_half_mirror row_mask:0xf bank_mask:0xf
  v_dot2_f32_bf16 v45, v164, v16, 0
  v_dot2_f32_bf16 v45, v165, v17, v45
  v_dot2_f32_bf16 v45, v166, v18, v45
  v_dot2_f32_bf16 v45, v167, v19, v45
  v_dot2_f32_bf16 v45, v168, v20, v45
  v_dot2_f32_bf16 v45, v169, v21, v45
  v_dot2_f32_bf16 v45, v170, v22, v45
  v_dot2_f32_bf16 v45, v171, v23, v45
  v_dot2_f32_bf16 v45, v172, v24, v45
  v_dot2_f32_bf16 v45, v173, v25, v45
  v_dot2_f32_bf16 v45, v174, v26, v45
  v_dot2_f32_bf16 v45, v175, v27, v45
  s_nop 2
  v_add_f32_dpp v45, v45, v45 quad_perm:[1,0,3,2] row_mask:0xf bank_mask:0xf
  s_nop 1
  v_add_f32_dpp v45, v45, v45 quad_perm:[2,3,0,1] row_mask:0xf bank_mask:0xf
  s_nop 1
  v_add_f32_dpp v45, v45, v45 row_half_mirror row_mask:0xf bank_mask:0xf
  v_dot2_f32_bf16 v46, v176, v16, 0
  v_dot2_f32_bf16 v46, v177, v17, v46
  v_dot2_f32_bf16 v46, v178, v18, v46
  v_dot2_f32_bf16 v46, v179, v19, v46
  v_dot2_f32_bf16 v46, v180, v20, v46
  v_dot2_f32_bf16 v46, v181, v21, v46
  v_dot2_f32_bf16 v46, v182, v22, v46
  v_dot2_f32_bf16 v46, v183, v23, v46
  v_dot2_f32_bf16 v46, v184, v24, v46
  v_dot2_f32_bf16 v46, v185, v25, v46
  v_dot2_f32_bf16 v46, v186, v26, v46
  v_dot2_f32_bf16 v46, v187, v27, v46
  s_nop 2
  v_add_f32_dpp v46, v46, v46 quad_perm:[1,0,3,2] row_mask:0xf bank_mask:0xf
  s_nop 1
  v_add_f32_dpp v46, v46, v46 quad_perm:[2,3,0,1] row_mask:0xf bank_mask:0xf
  s_nop 1
  v_add_f32_dpp v46, v46, v46 row_half_mirror row_mask:0xf bank_mask:0xf
  buffer_load_dwordx4 a[0:3], v8, s[56:59], s79 offen offset:0
  buffer_load_dwordx4 a[4:7], v8, s[56:59], s79 offen offset:128
  s_waitcnt vmcnt(16)
  v_dot2_f32_bf16 v47, v188, v16, 0
  v_dot2_f32_bf16 v47, v189, v17, v47
  v_dot2_f32_bf16 v47, v190, v18, v47
  v_dot2_f32_bf16 v47, v191, v19, v47
  s_waitcnt vmcnt(15)
  v_dot2_f32_bf16 v47, v192, v20, v47
  v_dot2_f32_bf16 v47, v193, v21, v47
  v_dot2_f32_bf16 v47, v194, v22, v47
  v_dot2_f32_bf16 v47, v195, v23, v47
  s_waitcnt vmcnt(14)
  v_dot2_f32_bf16 v47, v196, v24, v47
  v_dot2_f32_bf16 v47, v197, v25, v47
  v_dot2_f32_bf16 v47, v198, v26, v47
  v_dot2_f32_bf16 v47, v199, v27, v47
  s_nop 2
  v_add_f32_dpp v47, v47, v47 quad_perm:[1,0,3,2] row_mask:0xf bank_mask:0xf
  s_nop 1
  v_add_f32_dpp v47, v47, v47 quad_perm:[2,3,0,1] row_mask:0xf bank_mask:0xf
  s_nop 1
  v_add_f32_dpp v47, v47, v47 row_half_mirror row_mask:0xf bank_mask:0xf
  buffer_load_dwordx4 a[8:11], v8, s[96:99], s79 offen offset:256
  s_add_u32 s79, s79, 10240
  buffer_load_dwordx4 a[12:15], v8, s[56:59], s79 offen offset:0
  s_waitcnt vmcnt(15)
  v_dot2_f32_bf16 v48, v200, v16, 0
  v_dot2_f32_bf16 v48, v201, v17, v48
  v_dot2_f32_bf16 v48, v202, v18, v48
  v_dot2_f32_bf16 v48, v203, v19, v48
  s_waitcnt vmcnt(14)
  v_dot2_f32_bf16 v48, v204, v20, v48
  v_dot2_f32_bf16 v48, v205, v21, v48
  v_dot2_f32_bf16 v48, v206, v22, v48
  v_dot2_f32_bf16 v48, v207, v23, v48
  s_waitcnt vmcnt(13)
  v_dot2_f32_bf16 v48, v208, v24, v48
  v_dot2_f32_bf16 v48, v209, v25, v48
  v_dot2_f32_bf16 v48, v210, v26, v48
  v_dot2_f32_bf16 v48, v211, v27, v48
  s_nop 2
  v_add_f32_dpp v48, v48, v48 quad_perm:[1,0,3,2] row_mask:0xf bank_mask:0xf
  s_nop 1
  v_add_f32_dpp v48, v48, v48 quad_perm:[2,3,0,1] row_mask:0xf bank_mask:0xf
  s_nop 1
  v_add_f32_dpp v48, v48, v48 row_half_mirror row_mask:0xf bank_mask:0xf
  buffer_load_dwordx4 a[16:19], v8, s[56:59], s79 offen offset:128
  buffer_load_dwordx4 a[20:23], v8, s[96:99], s79 offen offset:256
  s_add_u32 s79, s79, 10240
  s_waitcnt vmcnt(14)
  v_dot2_f32_bf16 v49, v212, v16, 0
  v_dot2_f32_bf16 v49, v213, v17, v49
  v_dot2_f32_bf16 v49, v214, v18, v49
  v_dot2_f32_bf16 v49, v215, v19, v49
  s_waitcnt vmcnt(13)
  v_dot2_f32_bf16 v49, v216, v20, v49
  v_dot2_f32_bf16 v49, v217, v21, v49
  v_dot2_f32_bf16 v49, v218, v22, v49
  v_dot2_f32_bf16 v49, v219, v23, v49
  s_waitcnt vmcnt(12)
  v_dot2_f32_bf16 v49, v220, v24, v49
  v_dot2_f32_bf16 v49, v221, v25, v49
  v_dot2_f32_bf16 v49, v222, v26, v49
  v_dot2_f32_bf16 v49, v223, v27, v49
  s_nop 2
  v_add_f32_dpp v49, v49, v49 quad_perm:[1,0,3,2] row_mask:0xf bank_mask:0xf
  s_nop 1
  v_add_f32_dpp v49, v49, v49 quad_perm:[2,3,0,1] row_mask:0xf bank_mask:0xf
  s_nop 1
  v_add_f32_dpp v49, v49, v49 row_half_mirror row_mask:0xf bank_mask:0xf
  buffer_load_dwordx4 a[24:27], v8, s[56:59], s79 offen offset:0
  buffer_load_dwordx4 a[28:31], v8, s[56:59], s79 offen offset:128
  s_waitcnt vmcnt(13)
  v_dot2_f32_bf16 v50, v104, v16, 0
  v_dot2_f32_bf16 v50, v105, v17, v50
  v_dot2_f32_bf16 v50, v106, v18, v50
  v_dot2_f32_bf16 v50, v107, v19, v50
  s_cbranch_vccnz L_ts10
L_th10:
  buffer_load_dwordx4 v[104:107], v5, s[44:47], s8 offen offset:0 nt
  s_waitcnt vmcnt(13)
  v_dot2_f32_bf16 v50, v108, v20, v50
  v_dot2_f32_bf16 v50, v109, v21, v50
  v_dot2_f32_bf16 v50, v110, v22, v50
  v_dot2_f32_bf16 v50, v111, v23, v50
  s_cbranch_vccnz L_ts11
L_th11:
  buffer_load_dwordx4 v[108:111], v5, s[44:47], s8 offen offset:128 nt
  s_waitcnt vmcnt(13)
  v_dot2_f32_bf16 v50, v112, v24, v50
  v_dot2_f32_bf16 v50, v113, v25, v50
  v_dot2_f32_bf16 v50, v114, v26, v50
  v_dot2_f32_bf16 v50, v115, v27, v50
  s_cbranch_vccnz L_ts12
L_th12:
  buffer_load_dwordx4 v[112:115], v5, s[44:47], s8 offen offset:256 nt
  s_add_u32 s8, s8, 12288
  s_cmp_ge_u32 s8, s27
  s_cselect_b32 s11, 1572864, 0
  s_sub_u32 s8, s8, s11
  s_nop 1
  v_add_f32_dpp v50, v50, v50 quad_perm:[1,0,3,2] row_mask:0xf bank_mask:0xf
  s_nop 1
  v_add_f32_dpp v50, v50, v50 quad_perm:[2,3,0,1] row_mask:0xf bank_mask:0xf
  s_nop 1
  v_add_f32_dpp v50, v50, v50 row_half_mirror row_mask:0xf bank_mask:0xf
  buffer_load_dwordx4 a[32:35], v8, s[96:99], s79 offen offset:256
  s_add_u32 s79, s79, 10240
  buffer_load_dwordx4 a[36:39], v8, s[56:59], s79 offen offset:0
  s_waitcnt vmcnt(15)
  v_dot2_f32_bf16 v51, v116, v16, 0
  v_dot2_f32_bf16 v51, v117, v17, v51
  v_dot2_f32_bf16 v51, v118, v18, v51
  v_dot2_f32_bf16 v51, v119, v19, v51
  s_cbranch_vccnz L_ts13
L_th13:
  buffer_load_dwordx4 v[116:119], v5, s[44:47], s8 offen offset:0 nt
  s_waitcnt vmcnt(15)
  v_dot2_f32_bf16 v51, v120, v20, v51
  v_dot2_f32_bf16 v51, v121, v21, v51
  v_dot2_f32_bf16 v51, v122, v22, v51
  v_dot2_f32_bf16 v51, v123, v23, v51
  s_cbranch_vccnz L_ts14
L_th14:
  buffer_load_dwordx4 v[120:123], v5, s[44:47], s8 offen offset:128 nt
  s_waitcnt vmcnt(15)
  v_dot2_f32_bf16 v51, v124, v24, v51
  v_dot2_f32_bf16 v51, v125, v25, v51
  v_dot2_f32_bf16 v51, v126, v26, v51
  v_dot2_f32_bf16 v51, v127, v27, v51
  s_cbranch_vccnz L_ts15
L_th15:
  buffer_load_dwordx4 v[124:127], v5, s[44:47], s8 offen offset:256 nt
  s_add_u32 s8, s8, 12288
  s_cmp_ge_u32 s8, s27
  s_cselect_b32 s11, 1572864, 0
  s_sub_u32 s8, s8, s11
  s_nop 1
  v_add_f32_dpp v51, v51, v51 quad_perm:[1,0,3,2] row_mask:0xf bank_mask:0xf
  s_nop 1
  v_add_f32_dpp v51, v51, v51 quad_perm:[2,3,0,1] row_mask:0xf bank_mask:0xf
  s_nop 1
  v_add_f32_dpp v51, v51, v51 row_half_mirror row_mask:0xf bank_mask:0xf
  buffer_load_dwordx4 a[40:43], v8, s[56:59], s79 offen offset:128
  buffer_load_dwordx4 a[44:47], v8, s[96:99], s79 offen offset:256
  s_add_u32 s79, s79, 10240
  s_waitcnt vmcnt(9)
  v_dot2_f32_bf16 v52, v104, v16, 0
  v_dot2_f32_bf16 v52, v105, v17, v52
  v_dot2_f32_bf16 v52, v106, v18, v52
  v_dot2_f32_bf16 v52, v107, v19, v52
  s_cbranch_vccnz L_ts16
L_th16:
  buffer_load_dwordx4 v[104:107], v5, s[44:47], s8 offen offset:0 nt
  s_waitcnt vmcnt(9)
  v_dot2_f32_bf16 v52, v108, v20, v52
  v_dot2_f32_bf16 v52, v109, v21, v52
  v_dot2_f32_bf16 v52, v110, v22, v52
  v_dot2_f32_bf16 v52, v111, v23, v52
  s_cbranch_vccnz L_ts17
L_th17:
  buffer_load_dwordx4 v[108:111], v5, s[44:47], s8 offen offset:128 nt
  s_waitcnt vmcnt(9)
  v_dot2_f32_bf16 v52, v112, v24, v52
  v_dot2_f32_bf16 v52, v113, v25, v52
  v_dot2_f32_bf16 v52, v114, v26, v52
  v_dot2_f32_bf16 v52, v115, v27, v52
  s_cbranch_vccnz L_ts18
L_th18:
  buffer_load_dwordx4 v[112:115], v5, s[44:47], s8 offen offset:256 nt
  s_add_u32 s8, s8, s17
  s_cmp_ge_u32 s8, s27
  s_cselect_b32 s11, 1572864, 0
  s_sub_u32 s8, s8, s11
  s_nop 1
  v_add_f32_dpp v52, v52, v52 quad_perm:[1,0,3,2] row_mask:0xf bank_mask:0xf
  s_nop 1
  v_add_f32_dpp v52, v52, v52 quad_perm:[2,3,0,1] row_mask:0xf bank_mask:0xf
  s_nop 1
  v_add_f32_dpp v52, v52, v52 row_half_mirror row_mask:0xf bank_mask:0xf
  buffer_load_dwordx4 a[48:51], v8, s[56:59], s79 offen offset:0
  buffer_load_dwordx4 a[52:55], v8, s[56:59], s79 offen offset:128
  s_waitcnt vmcnt(9)
  v_dot2_f32_bf16 v53, v116, v16, 0
  v_dot2_f32_bf16 v53, v117, v17, v53
  v_dot2_f32_bf16 v53, v118, v18, v53
  v_dot2_f32_bf16 v53, v119, v19, v53
  s_cbranch_vccnz L_ts19
L_th19:
  s_mov_b32 s15, s43
  buffer_load_dwordx4 v[116:119], v5, s[48:51], s15 offen offset:0 nt
  s_waitcnt vmcnt(9)
  v_dot2_f32_bf16 v53, v120, v20, v53
  v_dot2_f32_bf16 v53, v121, v21, v53
  v_dot2_f32_bf16 v53, v122, v22, v53
  v_dot2_f32_bf16 v53, v123, v23, v53
  s_cbranch_vccnz L_ts20
L_th20:
  buffer_load_dwordx4 v[120:123], v5, s[48:51], s15 offen offset:128 nt
  s_waitcnt vmcnt(9)
  v_dot2_f32_bf16 v53, v124, v24, v53
  v_dot2_f32_bf16 v53, v125, v25, v53
  v_dot2_f32_bf16 v53, v126, v26, v53
  v_dot2_f32_bf16 v53, v127, v27, v53
  s_cbranch_vccnz L_ts21
L_th21:
  buffer_load_dwordx4 v[124:127], v5, s[48:51], s15 offen offset:256 nt
  s_add_u32 s15, s15, 12288
  s_cmp_ge_u32 s15, s27
  s_cselect_b32 s11, 1572864, 0
  s_sub_u32 s15, s15, s11
  s_nop 1
  v_add_f32_dpp v53, v53, v53 quad_perm:[1,0,3,2] row_mask:0xf bank_mask:0xf
  s_nop 1
  v_add_f32_dpp v53, v53, v53 quad_perm:[2,3,0,1] row_mask:0xf bank_mask:0xf
  s_nop 1
  v_add_f32_dpp v53, v53, v53 row_half_mirror row_mask:0xf bank_mask:0xf
  buffer_load_dwordx4 a[56:59], v8, s[96:99], s79 offen offset:256
  s_add_u32 s79, s79, 10240
  buffer_load_dwordx4 a[60:63], v8, s[56:59], s79 offen offset:0
  s_waitcnt vmcnt(9)
  v_dot2_f32_bf16 v54, v104, v16, 0
  v_dot2_f32_bf16 v54, v105, v17, v54
  v_dot2_f32_bf16 v54, v106, v18, v54
  v_dot2_f32_bf16 v54, v107, v19, v54
  s_cbranch_vccnz L_ts22
L_th22:
  buffer_load_dwordx4 v[104:107], v5, s[48:51], s15 offen offset:0 nt
  s_waitcnt vmcnt(9)
  v_dot2_f32_bf16 v54, v108, v20, v54
  v_dot2_f32_bf16 v54, v109, v21, v54
  v_dot2_f32_bf16 v54, v110, v22, v54
  v_dot2_f32_bf16 v54, v111, v23, v54
  s_cbranch_vccnz L_ts23
L_th23:
  buffer_load_dwordx4 v[108:111], v5, s[48:51], s15 offen offset:128 nt
  s_waitcnt vmcnt(9)
  v_dot2_f32_bf16 v54, v112, v24, v54
  v_dot2_f32_bf16 v54, v113, v25, v54
  v_dot2_f32_bf16 v54, v114, v26, v54
  v_dot2_f32_bf16 v54, v115, v27, v54
  s_cbranch_vccnz L_ts24
L_th24:
  buffer_load_dwordx4 v[112:115], v5, s[48:51], s15 offen offset:256 nt
  s_add_u32 s15, s15, 12288
  s_cmp_ge_u32 s15, s27
  s_cselect_b32 s11, 1572864, 0
  s_sub_u32 s15, s15, s11
  s_nop 1
  v_add_f32_dpp v54, v54, v54 quad_perm:[1,0,3,2] row_mask:0xf bank_mask:0xf
  s_nop 1
  v_add_f32_dpp v54, v54, v54 quad_perm:[2,3,0,1] row_mask:0xf bank_mask:0xf
  s_nop 1
  v_add_f32_dpp v54, v54, v54 row_half_mirror row_mask:0xf bank_mask:0xf
  buffer_load_dwordx4 a[64:67], v8, s[56:59], s79 offen offset:128
  buffer_load_dwordx4 a[68:71], v8, s[96:99], s79 offen offset:256
  s_add_u32 s79, s79, 10240
  v_max3_f32 v1, v40, v41, v42
  v_max3_f32 v1, v1, v43, v44
  v_max3_f32 v1, v1, v45, v46
  v_max3_f32 v1, v1, v47, v48
  v_max3_f32 v1, v1, v49, v50
  v_max3_f32 v1, v1, v51, v52
  v_max3_f32 v1, v1, v53, v54
  s_nop 1
  v_max_f32_dpp v4, v1, v1 row_ror:8 row_mask:0xf bank_mask:0xf
  s_nop 0
  v_readlane_b32 s11, v4, 0
  v_readlane_b32 s12, v4, 16
  v_readlane_b32 s13, v4, 32
  v_readlane_b32 s14, v4, 48
  s_nop 0
  v_mov_b32 v9, s11
  v_max_f32 v9, s12, v9
  v_max_f32 v9, s13, v9
  v_max_f32 v9, s14, v9
  v_mul_f32 v10, s10, v9
  v_fma_f32 v40, v40, s10, -v10
  v_exp_f32 v40, v40
  s_nop 0
  v_cvt_pk_bf16_f32 v59, v40, v40
  v_mov_b32 v11, v40
  v_and_b32 v56, v59, v12
  v_and_b32 v57, v59, v13
  v_and_b32 v58, v59, v14
  v_and_b32 v59, v59, v15
  s_waitcnt vmcnt(9)
  s_nop 0
  v_mfma_f32_16x16x32_bf16 v[28:31], v[56:59], v[116:119], 0
  s_cbranch_vccnz L_ts25
L_th25:
  buffer_load_dwordx4 v[116:119], v5, s[48:51], s15 offen offset:0 nt
  s_waitcnt vmcnt(9)
  v_mfma_f32_16x16x32_bf16 v[32:35], v[56:59], v[120:123], 0
  s_cbranch_vccnz L_ts26
L_th26:
  buffer_load_dwordx4 v[120:123], v5, s[48:51], s15 offen offset:128 nt
  s_waitcnt vmcnt(9)
  v_mfma_f32_16x16x32_bf16 v[36:39], v[56:59], v[124:127], 0
  s_cbranch_vccnz L_ts27
L_th27:
  buffer_load_dwordx4 v[124:127], v5, s[48:51], s15 offen offset:256 nt
  s_add_u32 s15, s15, 12288
  s_cmp_ge_u32 s15, s27
  s_cselect_b32 s11, 1572864, 0
  s_sub_u32 s15, s15, s11
  buffer_load_dwordx4 a[72:75], v8, s[56:59], s79 offen offset:0
  buffer_load_dwordx4 a[76:79], v8, s[56:59], s79 offen offset:128
  v_fma_f32 v41, v41, s10, -v10
  v_exp_f32 v41, v41
  s_nop 0
  v_cvt_pk_bf16_f32 v63, v41, v41
  v_add_f32 v11, v11, v41
  v_and_b32 v60, v63, v12
  v_and_b32 v61, v63, v13
  v_and_b32 v62, v63, v14
  v_and_b32 v63, v63, v15
  s_waitcnt vmcnt(9)
  s_nop 0
  v_mfma_f32_16x16x32_bf16 v[28:31], v[60:63], v[104:107], v[28:31]
  s_cbranch_vccnz L_ts28
L_th28:
  buffer_load_dwordx4 v[104:107], v5, s[48:51], s15 offen offset:0 nt
  s_waitcnt vmcnt(9)
  v_mfma_f32_16x16x32_bf16 v[32:35], v[60:63], v[108:111], v[32:35]
  s_cbranch_vccnz L_ts29
L_th29:
  buffer_load_dwordx4 v[108:111], v5, s[48:51], s15 offen offset:128 nt
  s_waitcnt vmcnt(9)
  v_mfma_f32_16x16x32_bf16 v[36:39], v[60:63], v[112:115], v[36:39]
  s_cbranch_vccnz L_ts30
L_th30:
  buffer_load_dwordx4 v[112:115], v5, s[48:51], s15 offen offset:256 nt
  s_add_u32 s15, s15, 12288
  s_cmp_ge_u32 s15, s27
  s_cselect_b32 s11, 1572864, 0
  s_sub_u32 s15, s15, s11
  buffer_load_dwordx4 a[80:83], v8, s[96:99], s79 offen offset:256
  s_add_u32 s79, s79, 10240
  buffer_load_dwordx4 a[84:87], v8, s[56:59], s79 offen offset:0
  v_fma_f32 v42, v42, s10, -v10
  v_exp_f32 v42, v42
  s_nop 0
  v_cvt_pk_bf16_f32 v59, v42, v42
  v_add_f32 v11, v11, v42
  v_and_b32 v56, v59, v12
  v_and_b32 v57, v59, v13
  v_and_b32 v58, v59, v14
  v_and_b32 v59, v59, v15
  s_waitcnt vmcnt(9)
  s_nop 0
  v_mfma_f32_16x16x32_bf16 v[28:31], v[56:59], v[116:119], v[28:31]
  s_cbranch_vccnz L_ts31
L_th31:
  buffer_load_dwordx4 v[116:119], v5, s[48:51], s15 offen offset:0 nt
  s_waitcnt vmcnt(9)
  v_mfma_f32_16x16x32_bf16 v[32:35], v[56:59], v[120:123], v[32:35]
  s_cbranch_vccnz L_ts32
L_th32:
  buffer_load_dwordx4 v[120:123], v5, s[48:51], s15 offen offset:128 nt
  s_waitcnt vmcnt(9)
  v_mfma_f32_16x16x32_bf16 v[36:39], v[56:59], v[124:127], v[36:39]
  s_cbranch_vccnz L_ts33
L_th33:
  buffer_load_dwordx4 v[124:127], v5, s[48:51], s15 offen offset:256 nt
  s_add_u32 s15, s15, s17
  s_cmp_ge_u32 s15, s27
  s_cselect_b32 s11, 1572864, 0
  s_sub_u32 s15, s15, s11
  buffer_load_dwordx4 a[88:91], v8, s[56:59], s79 offen offset:128
  buffer_load_dwordx4 a[92:95], v8, s[96:99], s79 offen offset:256
  s_add_u32 s79, s79, 10240
  v_fma_f32 v43, v43, s10, -v10
  v_exp_f32 v43, v43
  s_nop 0
  v_cvt_pk_bf16_f32 v63, v43, v43
  v_add_f32 v11, v11, v43
  v_and_b32 v60, v63, v12
  v_and_b32 v61, v63, v13
  v_and_b32 v62, v63, v14
  v_and_b32 v63, v63, v15
  s_waitcnt vmcnt(9)
  s_nop 0
  v_mfma_f32_16x16x32_bf16 v[28:31], v[60:63], v[104:107], v[28:31]
  s_cbranch_vccnz L_ts34
L_th34:
  buffer_load_dwordx4 v[104:107], v5, s[48:51], s15 offen offset:0 nt
  s_waitcnt vmcnt(9)
  v_mfma_f32_16x16x32_bf16 v[32:35], v[60:63], v[108:111], v[32:35]
  s_cbranch_vccnz L_ts35
L_th35:
  buffer_load_dwordx4 v[108:111], v5, s[48:51], s15 offen offset:128 nt
  s_waitcnt vmcnt(9)
  v_mfma_f32_16x16x32_bf16 v[36:39], v[60:63], v[112:115], v[36:39]
  s_cbranch_vccnz L_ts36
L_th36:
  buffer_load_dwordx4 v[112:115], v5, s[48:51], s15 offen offset:256 nt
  s_add_u32 s15, s15, 12288
  s_cmp_ge_u32 s15, s27
  s_cselect_b32 s11, 1572864, 0
  s_sub_u32 s15, s15, s11
  buffer_load_dwordx4 a[96:99], v8, s[56:59], s79 offen offset:0
  buffer_load_dwordx4 a[100:103], v8, s[56:59], s79 offen offset:128
  v_fma_f32 v44, v44, s10, -v10
  v_exp_f32 v44, v44
  s_nop 0
  v_cvt_pk_bf16_f32 v59, v44, v44
  v_add_f32 v11, v11, v44
  v_and_b32 v56, v59, v12
  v_and_b32 v57, v59, v13
  v_and_b32 v58, v59, v14
  v_and_b32 v59, v59, v15
  s_waitcnt vmcnt(9)
  s_nop 0
  v_mfma_f32_16x16x32_bf16 v[28:31], v[56:59], v[116:119], v[28:31]
  s_cbranch_vccnz L_ts37
L_th37:
  buffer_load_dwordx4 v[116:119], v5, s[48:51], s15 offen offset:0 nt
  s_waitcnt vmcnt(9)
  v_mfma_f32_16x16x32_bf16 v[32:35], v[56:59], v[120:123], v[32:35]
  s_cbranch_vccnz L_ts38
L_th38:
  buffer_load_dwordx4 v[120:123], v5, s[48:51], s15 offen offset:128 nt
  s_waitcnt vmcnt(9)
  v_mfma_f32_16x16x32_bf16 v[36:39], v[56:59], v[124:127], v[36:39]
  s_cbranch_vccnz L_ts39
L_th39:
  buffer_load_dwordx4 v[124:127], v5, s[48:51], s15 offen offset:256 nt
  s_add_u32 s15, s15, 12288
  s_cmp_ge_u32 s15, s27
  s_cselect_b32 s11, 1572864, 0
  s_sub_u32 s15, s15, s11
  s_add_u32 s11, s32, 1
  s_and_b32 s11, s11, 7
  s_cmp_lt_u32 s95, 7
  s_cselect_b32 s11, s11, s7
  s_lshl_b32 s12, s5, 3
  s_add_u32 s11, s11, s12
  s_mul_i32 s11, s11, 768
  s_add_u32 s78, s11, 1048576
  buffer_load_dwordx4 v[156:159], v6, s[64:67], s78 offen offset:0 sc1
  buffer_load_dwordx4 v[160:163], v6, s[64:67], s78 offen offset:16 sc1
  buffer_load_dwordx4 v[164:167], v6, s[64:67], s78 offen offset:256 sc1
  buffer_load_dwordx4 v[168:171], v6, s[64:67], s78 offen offset:272 sc1
  buffer_load_dwordx4 v[172:175], v6, s[64:67], s78 offen offset:512 sc1
  buffer_load_dwordx4 v[176:179], v6, s[64:67], s78 offen offset:528 sc1
  buffer_load_dwordx4 a[104:107], v8, s[96:99], s79 offen offset:256
  s_add_u32 s79, s79, 10240
  buffer_load_dwordx4 a[108:111], v8, s[56:59], s79 offen offset:0
  v_fma_f32 v45, v45, s10, -v10
  v_exp_f32 v45, v45
  s_nop 0
  v_cvt_pk_bf16_f32 v63, v45, v45
  v_add_f32 v11, v11, v45
  v_and_b32 v60, v63, v12
  v_and_b32 v61, v63, v13
  v_and_b32 v62, v63, v14
  v_and_b32 v63, v63, v15
  s_waitcnt vmcnt(15)
  s_nop 0
  v_mfma_f32_16x16x32_bf16 v[28:31], v[60:63], v[104:107], v[28:31]
  s_cbranch_vccnz L_ts40
L_th40:
  buffer_load_dwordx4 v[104:107], v5, s[48:51], s15 offen offset:0 nt
  s_waitcnt vmcnt(15)
  v_mfma_f32_16x16x32_bf16 v[32:35], v[60:63], v[108:111], v[32:35]
  s_cbranch_vccnz L_ts41
L_th41:
  buffer_load_dwordx4 v[108:111], v5, s[48:51], s15 offen offset:128 nt
  s_waitcnt vmcnt(15)
  v_mfma_f32_16x16x32_bf16 v[36:39], v[60:63], v[112:115], v[36:39]
  s_cbranch_vccnz L_ts42
L_th42:
  buffer_load_dwordx4 v[112:115], v5, s[48:51], s15 offen offset:256 nt
  s_add_u32 s15, s15, 12288
  s_cmp_ge_u32 s15, s27
  s_cselect_b32 s11, 1572864, 0
  s_sub_u32 s15, s15, s11
  buffer_load_dwordx4 a[112:115], v8, s[56:59], s79 offen offset:128
  buffer_load_dwordx4 a[116:119], v8, s[96:99], s79 offen offset:256
  s_add_u32 s79, s79, 10240
  v_fma_f32 v46, v46, s10, -v10
  v_exp_f32 v46, v46
  s_nop 0
  v_cvt_pk_bf16_f32 v59, v46, v46
  v_add_f32 v11, v11, v46
  v_and_b32 v56, v59, v12
  v_and_b32 v57, v59, v13
  v_and_b32 v58, v59, v14
  v_and_b32 v59, v59, v15
  s_waitcnt vmcnt(15)
  s_nop 0
  v_mfma_f32_16x16x32_bf16 v[28:31], v[56:59], v[116:119], v[28:31]
  s_cbranch_vccnz L_ts43
L_th43:
  buffer_load_dwordx4 v[116:119], v5, s[48:51], s15 offen offset:0 nt
  s_waitcnt vmcnt(15)
  v_mfma_f32_16x16x32_bf16 v[32:35], v[56:59], v[120:123], v[32:35]
  s_cbranch_vccnz L_ts44
L_th44:
  buffer_load_dwordx4 v[120:123], v5, s[48:51], s15 offen offset:128 nt
  s_waitcnt vmcnt(15)
  v_mfma_f32_16x16x32_bf16 v[36:39], v[56:59], v[124:127], v[36:39]
  s_cbranch_vccnz L_ts45
L_th45:
  buffer_load_dwordx4 v[124:127], v5, s[48:51], s15 offen offset:256 nt
  s_add_u32 s15, s15, 12288
  s_cmp_ge_u32 s15, s27
  s_cselect_b32 s11, 1572864, 0
  s_sub_u32 s15, s15, s11
  buffer_load_dwordx4 a[120:123], v8, s[56:59], s79 offen offset:0
  buffer_load_dwordx4 a[124:127], v8, s[56:59], s79 offen offset:128
  v_fma_f32 v47, v47, s10, -v10
  v_exp_f32 v47, v47
  s_nop 0
  v_cvt_pk_bf16_f32 v63, v47, v47
  v_add_f32 v11, v11, v47
  v_and_b32 v60, v63, v12
  v_and_b32 v61, v63, v13
  v_and_b32 v62, v63, v14
  v_and_b32 v63, v63, v15
  s_waitcnt vmcnt(9)
  s_nop 0
  v_mfma_f32_16x16x32_bf16 v[28:31], v[60:63], v[104:107], v[28:31]
  s_cbranch_vccnz L_ts46
L_th46:
  buffer_load_dwordx4 v[104:107], v5, s[48:51], s15 offen offset:0 nt
  s_waitcnt vmcnt(9)
  v_mfma_f32_16x16x32_bf16 v[32:35], v[60:63], v[108:111], v[32:35]
  s_cbranch_vccnz L_ts47
L_th47:
  buffer_load_dwordx4 v[108:111], v5, s[48:51], s15 offen offset:128 nt
  s_waitcnt vmcnt(9)
  v_mfma_f32_16x16x32_bf16 v[36:39], v[60:63], v[112:115], v[36:39]
  s_cbranch_vccnz L_ts48
L_th48:
  buffer_load_dwordx4 v[112:115], v5, s[48:51], s15 offen offset:256 nt
  s_add_u32 s15, s15, s17
  s_cmp_ge_u32 s15, s27
  s_cselect_b32 s11, 1572864, 0
  s_sub_u32 s15, s15, s11
  buffer_load_dwordx4 a[128:131], v8, s[96:99], s79 offen offset:256
  s_add_u32 s79, s79, 10240
  buffer_load_dwordx4 a[132:135], v8, s[56:59], s79 offen offset:0
  v_fma_f32 v48, v48, s10, -v10
  v_exp_f32 v48, v48
  s_nop 0
  v_cvt_pk_bf16_f32 v59, v48, v48
  v_add_f32 v11, v11, v48
  v_and_b32 v56, v59, v12
  v_and_b32 v57, v59, v13
  v_and_b32 v58, v59, v14
  v_and_b32 v59, v59, v15
  s_waitcnt vmcnt(9)
  s_nop 0
  v_mfma_f32_16x16x32_bf16 v[28:31], v[56:59], v[116:119], v[28:31]
  s_cbranch_vccnz L_ts49
L_th49:
  buffer_load_dwordx4 v[116:119], v5, s[48:51], s15 offen offset:0 nt
  s_waitcnt vmcnt(9)
  v_mfma_f32_16x16x32_bf16 v[32:35], v[56:59], v[120:123], v[32:35]
  s_cbranch_vccnz L_ts50
L_th50:
  buffer_load_dwordx4 v[120:123], v5, s[48:51], s15 offen offset:128 nt
  s_waitcnt vmcnt(9)
  v_mfma_f32_16x16x32_bf16 v[36:39], v[56:59], v[124:127], v[36:39]
  s_cbranch_vccnz L_ts51
L_th51:
  buffer_load_dwordx4 v[124:127], v5, s[48:51], s15 offen offset:256 nt
  s_add_u32 s15, s15, 12288
  s_cmp_ge_u32 s15, s27
  s_cselect_b32 s11, 1572864, 0
  s_sub_u32 s15, s15, s11
  buffer_load_dwordx4 a[136:139], v8, s[56:59], s79 offen offset:128
  buffer_load_dwordx4 a[140:143], v8, s[96:99], s79 offen offset:256
  s_add_u32 s79, s79, 10240
  v_fma_f32 v49, v49, s10, -v10
  v_exp_f32 v49, v49
  s_nop 0
  v_cvt_pk_bf16_f32 v63, v49, v49
  v_add_f32 v11, v11, v49
  v_and_b32 v60, v63, v12
  v_and_b32 v61, v63, v13
  v_and_b32 v62, v63, v14
  v_and_b32 v63, v63, v15
  s_waitcnt vmcnt(9)
  s_nop 0
  v_mfma_f32_16x16x32_bf16 v[28:31], v[60:63], v[104:107], v[28:31]
  s_cbranch_vccnz L_ts52
L_th52:
  buffer_load_dwordx4 v[104:107], v5, s[48:51], s15 offen offset:0 nt
  s_waitcnt vmcnt(9)
  v_mfma_f32_16x16x32_bf16 v[32:35], v[60:63], v[108:111], v[32:35]
  s_cbranch_vccnz L_ts53
L_th53:
  buffer_load_dwordx4 v[108:111], v5, s[48:51], s15 offen offset:128 nt
  s_waitcnt vmcnt(9)
  v_mfma_f32_16x16x32_bf16 v[36:39], v[60:63], v[112:115], v[36:39]
  s_cbranch_vccnz L_ts54
L_th54:
  buffer_load_dwordx4 v[112:115], v5, s[48:51], s15 offen offset:256 nt
  s_add_u32 s15, s15, 12288
  s_cmp_ge_u32 s15, s27
  s_cselect_b32 s11, 1572864, 0
  s_sub_u32 s15, s15, s11
  buffer_load_dwordx4 a[144:147], v8, s[56:59], s79 offen offset:0
  buffer_load_dwordx4 a[148:151], v8, s[56:59], s79 offen offset:128
  v_fma_f32 v50, v50, s10, -v10
  v_exp_f32 v50, v50
  s_nop 0
  v_cvt_pk_bf16_f32 v59, v50, v50
  v_add_f32 v11, v11, v50
  v_and_b32 v56, v59, v12
  v_and_b32 v57, v59, v13
  v_and_b32 v58, v59, v14
  v_and_b32 v59, v59, v15
  s_waitcnt vmcnt(9)
  s_nop 0
  v_mfma_f32_16x16x32_bf16 v[28:31], v[56:59], v[116:119], v[28:31]
  s_cbranch_vccnz L_ts55
L_th55:
  buffer_load_dwordx4 v[116:119], v5, s[48:51], s15 offen offset:0 nt
  s_waitcnt vmcnt(9)
  v_mfma_f32_16x16x32_bf16 v[32:35], v[56:59], v[120:123], v[32:35]
  s_cbranch_vccnz L_ts56
L_th56:
  buffer_load_dwordx4 v[120:123], v5, s[48:51], s15 offen offset:128 nt
  s_waitcnt vmcnt(9)
  v_mfma_f32_16x16x32_bf16 v[36:39], v[56:59], v[124:127], v[36:39]
  s_cbranch_vccnz L_ts57
L_th57:
  buffer_load_dwordx4 v[124:127], v5, s[48:51], s15 offen offset:256 nt
  s_add_u32 s15, s15, 12288
  s_cmp_ge_u32 s15, s27
  s_cselect_b32 s11, 1572864, 0
  s_sub_u32 s15, s15, s11
  buffer_load_dwordx4 a[152:155], v8, s[96:99], s79 offen offset:256
  s_add_u32 s79, s79, 10240
  buffer_load_dwordx4 a[156:159], v8, s[56:59], s79 offen offset:0
  v_fma_f32 v51, v51, s10, -v10
  v_exp_f32 v51, v51
  s_nop 0
  v_cvt_pk_bf16_f32 v63, v51, v51
  v_add_f32 v11, v11, v51
  v_and_b32 v60, v63, v12
  v_and_b32 v61, v63, v13
  v_and_b32 v62, v63, v14
  v_and_b32 v63, v63, v15
  s_waitcnt vmcnt(9)
  s_nop 0
  v_mfma_f32_16x16x32_bf16 v[28:31], v[60:63], v[104:107], v[28:31]
  s_cbranch_vccnz L_ts58
L_th58:
  buffer_load_dwordx4 v[104:107], v5, s[48:51], s15 offen offset:0 nt
  s_waitcnt vmcnt(9)
  v_mfma_f32_16x16x32_bf16 v[32:35], v[60:63], v[108:111], v[32:35]
  s_cbranch_vccnz L_ts59
L_th59:
  buffer_load_dwordx4 v[108:111], v5, s[48:51], s15 offen offset:128 nt
  s_waitcnt vmcnt(9)
  v_mfma_f32_16x16x32_bf16 v[36:39], v[60:63], v[112:115], v[36:39]
  s_cbranch_vccnz L_ts60
L_th60:
  buffer_load_dwordx4 v[112:115], v5, s[48:51], s15 offen offset:256 nt
  s_add_u32 s15, s15, 12288
  s_cmp_ge_u32 s15, s27
  s_cselect_b32 s11, 1572864, 0
  s_sub_u32 s15, s15, s11
  buffer_load_dwordx4 a[160:163], v8, s[56:59], s79 offen offset:128
  buffer_load_dwordx4 a[164:167], v8, s[96:99], s79 offen offset:256
  s_add_u32 s79, s79, 10240
  v_fma_f32 v52, v52, s10, -v10
  v_exp_f32 v52, v52
  s_nop 0
  v_cvt_pk_bf16_f32 v59, v52, v52
  v_add_f32 v11, v11, v52
  v_and_b32 v56, v59, v12
  v_and_b32 v57, v59, v13
  v_and_b32 v58, v59, v14
  v_and_b32 v59, v59, v15
  s_waitcnt vmcnt(9)
  s_nop 0
  v_mfma_f32_16x16x32_bf16 v[28:31], v[56:59], v[116:119], v[28:31]
  s_cbranch_vccnz L_ts61
L_th61:
  buffer_load_dwordx4 v[116:119], v5, s[48:51], s15 offen offset:0 nt
  s_waitcnt vmcnt(9)
  v_mfma_f32_16x16x32_bf16 v[32:35], v[56:59], v[120:123], v[32:35]
  s_cbranch_vccnz L_ts62
L_th62:
  buffer_load_dwordx4 v[120:123], v5, s[48:51], s15 offen offset:128 nt
  s_waitcnt vmcnt(9)
  v_mfma_f32_16x16x32_bf16 v[36:39], v[56:59], v[124:127], v[36:39]
  s_cbranch_vccnz L_ts63
L_th63:
  buffer_load_dwordx4 v[124:127], v5, s[48:51], s15 offen offset:256 nt
  s_add_u32 s15, s15, s17
  s_cmp_ge_u32 s15, s27
  s_cselect_b32 s11, 1572864, 0
  s_sub_u32 s15, s15, s11
  buffer_load_dwordx4 a[168:171], v8, s[56:59], s79 offen offset:0
  buffer_load_dwordx4 a[172:175], v8, s[56:59], s79 offen offset:128
  v_fma_f32 v53, v53, s10, -v10
  v_exp_f32 v53, v53
  s_nop 0
  v_cvt_pk_bf16_f32 v63, v53, v53
  v_add_f32 v11, v11, v53
  v_and_b32 v60, v63, v12
  v_and_b32 v61, v63, v13
  v_and_b32 v62, v63, v14
  v_and_b32 v63, v63, v15
  s_waitcnt vmcnt(9)
  s_nop 0
  v_mfma_f32_16x16x32_bf16 v[28:31], v[60:63], v[104:107], v[28:31]
  s_cbranch_vccnz L_ts64
L_th64:
  s_add_u32 s11, s94, s33
  s_and_b32 s11, s11, 7
  s_cmp_lt_u32 s94, 8
  s_cselect_b32 s11, s11, s7
  s_cselect_b32 s12, s16, s26
  s_cselect_b32 s17, 36, 1
  s_mul_i32 s17, s17, 12288
  s_cselect_b32 s27, 0, -1
  s_and_b32 s13, s11, 3
  s_lshl_b32 s13, s13, 5
  s_add_u32 s13, s13, s5
  s_mul_i32 s13, s13, 1572864
  s_mul_i32 s43, s3, 3072
  s_add_u32 s13, s13, s43
  s_add_u32 s43, s13, s12
  s_add_u32 s13, s13, 1572864
  s_or_b32 s27, s27, s13
  s_cmp_ge_u32 s11, 4
  s_cselect_b32 s44, s28, s18
  s_cselect_b32 s45, s29, s19
  s_cselect_b32 s48, s30, s20
  s_cselect_b32 s49, s31, s21
  s_mov_b32 s8, s43
  s_add_u32 s94, s94, 1
  buffer_load_dwordx4 v[104:107], v5, s[44:47], s8 offen offset:0 nt
  s_waitcnt vmcnt(9)
  v_mfma_f32_16x16x32_bf16 v[32:35], v[60:63], v[108:111], v[32:35]
  s_cbranch_vccnz L_ts66
L_th66:
  buffer_load_dwordx4 v[108:111], v5, s[44:47], s8 offen offset:128 nt
  s_waitcnt vmcnt(9)
  v_mfma_f32_16x16x32_bf16 v[36:39], v[60:63], v[112:115], v[36:39]
  s_cbranch_vccnz L_ts67
L_th67:
  buffer_load_dwordx4 v[112:115], v5, s[44:47], s8 offen offset:256 nt
  s_add_u32 s8, s8, 12288
  s_cmp_ge_u32 s8, s27
  s_cselect_b32 s11, 1572864, 0
  s_sub_u32 s8, s8, s11
  buffer_load_dwordx4 a[176:179], v8, s[96:99], s79 offen offset:256
  s_add_u32 s79, s79, 10240
  buffer_load_dwordx4 a[180:183], v8, s[56:59], s79 offen offset:0
  v_fma_f32 v54, v54, s10, -v10
  v_exp_f32 v54, v54
  s_nop 0
  v_cvt_pk_bf16_f32 v59, v54, v54
  v_add_f32 v11, v11, v54
  v_and_b32 v56, v59, v12
  v_and_b32 v57, v59, v13
  v_and_b32 v58, v59, v14
  v_and_b32 v59, v59, v15
  s_waitcnt vmcnt(9)
  s_nop 0
  v_mfma_f32_16x16x32_bf16 v[28:31], v[56:59], v[116:119], v[28:31]
  s_cbranch_vccnz L_ts68
L_th68:
  buffer_load_dwordx4 v[116:119], v5, s[44:47], s8 offen offset:0 nt
  s_waitcnt vmcnt(9)
  v_mfma_f32_16x16x32_bf16 v[32:35], v[56:59], v[120:123], v[32:35]
  s_cbranch_vccnz L_ts69
L_th69:
  buffer_load_dwordx4 v[120:123], v5, s[44:47], s8 offen offset:128 nt
  s_waitcnt vmcnt(9)
  v_mfma_f32_16x16x32_bf16 v[36:39], v[56:59], v[124:127], v[36:39]
  s_cbranch_vccnz L_ts70
L_th70:
  buffer_load_dwordx4 v[124:127], v5, s[44:47], s8 offen offset:256 nt
  s_add_u32 s8, s8, 12288
  s_cmp_ge_u32 s8, s27
  s_cselect_b32 s11, 1572864, 0
  s_sub_u32 s8, s8, s11
  buffer_load_dwordx4 a[184:187], v8, s[56:59], s79 offen offset:128
  buffer_load_dwordx4 a[188:191], v8, s[96:99], s79 offen offset:256
  s_add_u32 s79, s79, 10240
  v_add_f32_dpp v11, v11, v11 row_ror:8 row_mask:0xf bank_mask:0xf
  v_add_u32 v1, s101, v97
  v_readlane_b32 s11, v11, 0
  v_readlane_b32 s12, v11, 16
  v_readlane_b32 s13, v11, 32
  v_readlane_b32 s14, v11, 48
  s_nop 1
  ds_write_b128 v1, v[28:31] offset:0
  ds_write_b128 v1, v[32:35] offset:1024
  ds_write_b128 v1, v[36:39] offset:2048
  v_mov_b32 v10, s11
  v_add_f32 v10, s12, v10
  v_add_f32 v10, s13, v10
  v_add_f32 v10, s14, v10
  s_lshl_b32 s11, s3, 3
  s_add_u32 s11, s11, s101
  v_mov_b32 v1, s11
  v_mov_b32 v180, v9
  v_mov_b32 v181, v10
  ds_write_b64 v1, v[180:181] offset:16384
  s_waitcnt lgkmcnt(0)
  s_barrier
  s_add_u32 s11, s95, 2
  s_and_b32 s11, s11, 3
  s_cmp_lg_u32 s11, s3
  s_cbranch_scc1 L_p71
  s_movk_i32 s11, 0xff
  s_bitcmp1_b32 s11, s95
  s_cbranch_scc0 L_p71
  s_memrealtime s[24:25]
  v_mov_b32 v217, s95
  v_mov_b32 v218, s92
  v_mov_b32 v219, s93
  s_lshl_b32 s11, s2, 7
  s_add_u32 s11, s11, 2162688
  v_lshlrev_b32 v4, 4, v0
  s_waitcnt lgkmcnt(0)
  s_and_b32 s12, s2, 56
  s_cbranch_scc1 L_p71
  v_mov_b32 v216, s24
  s_mov_b64 exec, 0xff
  buffer_store_dwordx4 v[216:219], v4, s[64:67], s11 offen sc1
  s_mov_b64 exec, -1
L_p71:
  s_and_b32 s11, s95, 3
  s_cmp_lg_u32 s11, s3
  s_cbranch_scc1 L_m72
  v_mov_b32 v1, s101
  v_add_u32 v4, s101, v96
  ds_read_b128 v[180:183], v1 offset:16384
  ds_read_b128 v[184:187], v1 offset:16400
  ds_read_b128 v[64:67], v4 offset:0
  ds_read_b128 v[68:71], v4 offset:640
  ds_read_b128 v[72:75], v4 offset:4096
  ds_read_b128 v[76:79], v4 offset:4736
  ds_read_b128 v[80:83], v4 offset:8192
  ds_read_b128 v[84:87], v4 offset:8832
  ds_read_b128 v[88:91], v4 offset:12288
  ds_read_b128 v[92:95], v4 offset:12928
  s_waitcnt lgkmcnt(8)
  v_max3_f32 v100, v180, v182, v184
  v_max_f32 v100, v100, v186
  v_sub_f32 v40, v180, v100
  v_sub_f32 v41, v182, v100
  v_sub_f32 v42, v184, v100
  v_sub_f32 v43, v186, v100
  v_mul_f32 v40, s10, v40
  v_mul_f32 v41, s10, v41
  v_mul_f32 v42, s10, v42
  v_mul_f32 v43, s10, v43
  v_exp_f32 v40, v40
  v_exp_f32 v41, v41
  v_exp_f32 v42, v42
  v_exp_f32 v43, v43
  s_nop 0
  v_mul_f32 v101, v40, v181
  v_fmac_f32 v101, v41, v183
  v_fmac_f32 v101, v42, v185
  v_fmac_f32 v101, v43, v187
  s_waitcnt lgkmcnt(6)
  v_add_f32 v64, v64, v68
  v_add_f32 v65, v65, v69
  v_add_f32 v66, v66, v70
  v_add_f32 v67, v67, v71
  v_mul_f32 v56, v40, v64
  v_mul_f32 v57, v40, v65
  v_mul_f32 v58, v40, v66
  v_mul_f32 v59, v40, v67
  s_waitcnt lgkmcnt(4)
  v_add_f32 v72, v72, v76
  v_add_f32 v73, v73, v77
  v_add_f32 v74, v74, v78
  v_add_f32 v75, v75, v79
  v_fmac_f32 v56, v41, v72
  v_fmac_f32 v57, v41, v73
  v_fmac_f32 v58, v41, v74
  v_fmac_f32 v59, v41, v75
  s_waitcnt lgkmcnt(2)
  v_add_f32 v80, v80, v84
  v_add_f32 v81, v81, v85
  v_add_f32 v82, v82, v86
  v_add_f32 v83, v83, v87
  v_fmac_f32 v56, v42, v80
  v_fmac_f32 v57, v42, v81
  v_fmac_f32 v58, v42, v82
  v_fmac_f32 v59, v42, v83
  s_waitcnt lgkmcnt(0)
  v_add_f32 v88, v88, v92
  v_add_f32 v89, v89, v93
  v_add_f32 v90, v90, v94
  v_add_f32 v91, v91, v95
  v_fmac_f32 v56, v43, v88
  v_fmac_f32 v57, v43, v89
  v_fmac_f32 v58, v43, v90
  v_fmac_f32 v59, v43, v91
  s_lshl_b32 s11, s32, 3
  s_add_u32 s11, s11, 39040
  v_mov_b32 v1, s11
  ds_write_b64 v1, v[100:101]
  s_cmp_lg_u32 s32, s7
  s_cbranch_scc1 L_g72
  v_lshlrev_b32 v1, 4, v0
  ds_write_b128 v1, v[56:59] offset:39104
  s_branch L_h72
L_g72:
  v_cvt_pk_bf16_f32 v56, v56, v57
  v_cvt_pk_bf16_f32 v57, v58, v59
  s_mul_i32 s11, s32, 384
  v_add_u32 v1, s11, v7
  s_mov_b32 exec_hi, 0xffff
  ds_write_b64 v1, v[56:57] offset:40128
  s_mov_b32 exec_hi, -1
L_h72:
  s_waitcnt lgkmcnt(0)
  s_cmp_lg_u32 s95, 7
  s_cbranch_scc1 L_m72
  v_lshlrev_b32 v1, 4, v0
  ds_read_b128 v[64:67], v1 offset:40128
  ds_read_b128 v[68:71], v1 offset:41152
  ds_read_b128 v[72:75], v1 offset:42176
  s_lshl_b32 s11, s5, 3
  s_add_u32 s11, s11, s7
  s_mul_i32 s11, s11, 3072
  s_add_u32 s11, s11, 1310720
  s_waitcnt lgkmcnt(2)
  buffer_store_dwordx4 v[64:67], v1, s[64:67], s11 offen offset:0 sc1
  s_waitcnt lgkmcnt(1)
  buffer_store_dwordx4 v[68:71], v1, s[64:67], s11 offen offset:1024 sc1
  s_waitcnt lgkmcnt(0)
  buffer_store_dwordx4 v[72:75], v1, s[64:67], s11 offen offset:2048 sc1
L_m72:
  s_xor_b32 s101, s101, 16448
  s_add_u32 s95, s95, 1
  s_add_u32 s32, s32, 1
  s_and_b32 s32, s32, 7
  s_branch L_qc73
L_qp73:
  s_add_u32 s9, s9, 1
  s_cmp_gt_u32 s9, 100000
  s_cbranch_scc1 L_qk73
  buffer_load_dwordx4 v[156:159], v6, s[64:67], s78 offen offset:0 sc1
  buffer_load_dwordx4 v[160:163], v6, s[64:67], s78 offen offset:16 sc1
  buffer_load_dwordx4 v[164:167], v6, s[64:67], s78 offen offset:256 sc1
  buffer_load_dwordx4 v[168:171], v6, s[64:67], s78 offen offset:272 sc1
  buffer_load_dwordx4 v[172:175], v6, s[64:67], s78 offen offset:512 sc1
  buffer_load_dwordx4 v[176:179], v6, s[64:67], s78 offen offset:528 sc1
  s_waitcnt vmcnt(0)
L_qc73:
  v_xor_b32 v158, s92, v158
  v_xor_b32 v159, s93, v159
  v_xor_b32 v162, s92, v162
  v_xor_b32 v163, s93, v163
  v_xor_b32 v166, s92, v166
  v_xor_b32 v167, s93, v167
  v_xor_b32 v170, s92, v170
  v_xor_b32 v171, s93, v171
  v_xor_b32 v174, s92, v174
  v_xor_b32 v175, s93, v175
  v_xor_b32 v178, s92, v178
  v_xor_b32 v179, s93, v179
  v_or_b32 v4, v158, v159
  v_or3_b32 v4, v4, v162, v163
  v_or3_b32 v4, v4, v166, v167
  v_or3_b32 v4, v4, v170, v171
  v_or3_b32 v4, v4, v174, v175
  v_or3_b32 v4, v4, v178, v179
  v_cmp_ne_u32 vcc, 0, v4
  s_nop 1
  s_cbranch_vccnz L_qp73
L_qk73:
  v_mov_b32 v16, v156
  v_mov_b32 v17, v157
  v_mov_b32 v18, v160
  v_mov_b32 v19, v161
  v_mov_b32 v20, v164
  v_mov_b32 v21, v165
  v_mov_b32 v22, v168
  v_mov_b32 v23, v169
  v_mov_b32 v24, v172
  v_mov_b32 v25, v173
  v_mov_b32 v26, v176
  v_mov_b32 v27, v177
  s_mov_b32 vcc_lo, s22
  s_mov_b32 vcc_hi, 0
  s_waitcnt vmcnt(9)
  v_dot2_f32_bf16 v40, v104, v16, 0
  v_dot2_f32_bf16 v40, v105, v17, v40
  v_dot2_f32_bf16 v40, v106, v18, v40
  v_dot2_f32_bf16 v40, v107, v19, v40
  s_cbranch_vccnz L_ts74
L_th74:
  buffer_load_dwordx4 v[104:107], v5, s[44:47], s8 offen offset:0 nt
  s_waitcnt vmcnt(9)
  v_dot2_f32_bf16 v40, v108, v20, v40
  v_dot2_f32_bf16 v40, v109, v21, v40
  v_dot2_f32_bf16 v40, v110, v22, v40
  v_dot2_f32_bf16 v40, v111, v23, v40
  s_cbranch_vccnz L_ts75
L_th75:
  buffer_load_dwordx4 v[108:111], v5, s[44:47], s8 offen offset:128 nt
  s_waitcnt vmcnt(9)
  v_dot2_f32_bf16 v40, v112, v24, v40
  v_dot2_f32_bf16 v40, v113, v25, v40
  v_dot2_f32_bf16 v40, v114, v26, v40
  v_dot2_f32_bf16 v40, v115, v27, v40
  s_cbranch_vccnz L_ts76
L_th76:
  buffer_load_dwordx4 v[112:115], v5, s[44:47], s8 offen offset:256 nt
  s_add_u32 s8, s8, 12288
  s_cmp_ge_u32 s8, s27
  s_cselect_b32 s11, 1572864, 0
  s_sub_u32 s8, s8, s11
  s_nop 1
  v_add_f32_dpp v40, v40, v40 quad_perm:[1,0,3,2] row_mask:0xf bank_mask:0xf
  s_nop 1
  v_add_f32_dpp v40, v40, v40 quad_perm:[2,3,0,1] row_mask:0xf bank_mask:0xf
  s_nop 1
  v_add_f32_dpp v40, v40, v40 row_half_mirror row_mask:0xf bank_mask:0xf
  buffer_load_dwordx4 a[192:195], v8, s[56:59], s79 offen offset:0
  buffer_load_dwordx4 a[196:199], v8, s[56:59], s79 offen offset:128
  s_waitcnt vmcnt(9)
  v_dot2_f32_bf16 v41, v116, v16, 0
  v_dot2_f32_bf16 v41, v117, v17, v41
  v_dot2_f32_bf16 v41, v118, v18, v41
  v_dot2_f32_bf16 v41, v119, v19, v41
  s_cbranch_vccnz L_ts77
L_th77:
  buffer_load_dwordx4 v[116:119], v5, s[44:47], s8 offen offset:0 nt
  s_waitcnt vmcnt(9)
  v_dot2_f32_bf16 v41, v120, v20, v41
  v_dot2_f32_bf16 v41, v121, v21, v41
  v_dot2_f32_bf16 v41, v122, v22, v41
  v_dot2_f32_bf16 v41, v123, v23, v41
  s_cbranch_vccnz L_ts78
L_th78:
  buffer_load_dwordx4 v[120:123], v5, s[44:47], s8 offen offset:128 nt
  s_waitcnt vmcnt(9)
  v_dot2_f32_bf16 v41, v124, v24, v41
  v_dot2_f32_bf16 v41, v125, v25, v41
  v_dot2_f32_bf16 v41, v126, v26, v41
  v_dot2_f32_bf16 v41, v127, v27, v41
  s_cbranch_vccnz L_ts79
L_th79:
  buffer_load_dwordx4 v[124:127], v5, s[44:47], s8 offen offset:256 nt
  s_add_u32 s8, s8, 12288
  s_cmp_ge_u32 s8, s27
  s_cselect_b32 s11, 1572864, 0
  s_sub_u32 s8, s8, s11
  s_nop 1
  v_add_f32_dpp v41, v41, v41 quad_perm:[1,0,3,2] row_mask:0xf bank_mask:0xf
  s_nop 1
  v_add_f32_dpp v41, v41, v41 quad_perm:[2,3,0,1] row_mask:0xf bank_mask:0xf
  s_nop 1
  v_add_f32_dpp v41, v41, v41 row_half_mirror row_mask:0xf bank_mask:0xf
  buffer_load_dwordx4 a[200:203], v8, s[96:99], s79 offen offset:256
  s_add_u32 s79, s79, 10240
  buffer_load_dwordx4 a[204:207], v8, s[56:59], s79 offen offset:0
  s_waitcnt vmcnt(9)
  v_dot2_f32_bf16 v42, v104, v16, 0
  v_dot2_f32_bf16 v42, v105, v17, v42
  v_dot2_f32_bf16 v42, v106, v18, v42
  v_dot2_f32_bf16 v42, v107, v19, v42
  s_cbranch_vccnz L_ts80
L_th80:
  buffer_load_dwordx4 v[104:107], v5, s[44:47], s8 offen offset:0 nt
  s_waitcnt vmcnt(9)
  v_dot2_f32_bf16 v42, v108, v20, v42
  v_dot2_f32_bf16 v42, v109, v21, v42
  v_dot2_f32_bf16 v42, v110, v22, v42
  v_dot2_f32_bf16 v42, v111, v23, v42
  s_cbranch_vccnz L_ts81
L_th81:
  buffer_load_dwordx4 v[108:111], v5, s[44:47], s8 offen offset:128 nt
  s_waitcnt vmcnt(9)
  v_dot2_f32_bf16 v42, v112, v24, v42
  v_dot2_f32_bf16 v42, v113, v25, v42
  v_dot2_f32_bf16 v42, v114, v26, v42
  v_dot2_f32_bf16 v42, v115, v27, v42
  s_cbranch_vccnz L_ts82
L_th82:
  buffer_load_dwordx4 v[112:115], v5, s[44:47], s8 offen offset:256 nt
  s_add_u32 s8, s8, s17
  s_cmp_ge_u32 s8, s27
  s_cselect_b32 s11, 1572864, 0
  s_sub_u32 s8, s8, s11
  s_nop 1
  v_add_f32_dpp v42, v42, v42 quad_perm:[1,0,3,2] row_mask:0xf bank_mask:0xf
  s_nop 1
  v_add_f32_dpp v42, v42, v42 quad_perm:[2,3,0,1] row_mask:0xf bank_mask:0xf
  s_nop 1
  v_add_f32_dpp v42, v42, v42 row_half_mirror row_mask:0xf bank_mask:0xf
  buffer_load_dwordx4 a[208:211], v8, s[56:59], s79 offen offset:128
  buffer_load_dwordx4 a[212:215], v8, s[96:99], s79 offen offset:256
  s_add_u32 s79, s79, 10240
  s_waitcnt vmcnt(9)
  v_dot2_f32_bf16 v43, v116, v16, 0
  v_dot2_f32_bf16 v43, v117, v17, v43
  v_dot2_f32_bf16 v43, v118, v18, v43
  v_dot2_f32_bf16 v43, v119, v19, v43
  s_cbranch_vccnz L_ts83
L_th83:
  buffer_load_dwordx4 v[116:119], v5, s[44:47], s8 offen offset:0 nt
  s_waitcnt vmcnt(9)
  v_dot2_f32_bf16 v43, v120, v20, v43
  v_dot2_f32_bf16 v43, v121, v21, v43
  v_dot2_f32_bf16 v43, v122, v22, v43
  v_dot2_f32_bf16 v43, v123, v23, v43
  s_cbranch_vccnz L_ts84
L_th84:
  buffer_load_dwordx4 v[120:123], v5, s[44:47], s8 offen offset:128 nt
  s_waitcnt vmcnt(9)
  v_dot2_f32_bf16 v43, v124, v24, v43
  v_dot2_f32_bf16 v43, v125, v25, v43
  v_dot2_f32_bf16 v43, v126, v26, v43
  v_dot2_f32_bf16 v43, v127, v27, v43
  s_cbranch_vccnz L_ts85
L_th85:
  buffer_load_dwordx4 v[124:127], v5, s[44:47], s8 offen offset:256 nt
  s_add_u32 s8, s8, 12288
  s_cmp_ge_u32 s8, s27
  s_cselect_b32 s11, 1572864, 0
  s_sub_u32 s8, s8, s11
  s_nop 1
  v_add_f32_dpp v43, v43, v43 quad_perm:[1,0,3,2] row_mask:0xf bank_mask:0xf
  s_nop 1
  v_add_f32_dpp v43, v43, v43 quad_perm:[2,3,0,1] row_mask:0xf bank_mask:0xf
  s_nop 1
  v_add_f32_dpp v43, v43, v43 row_half_mirror row_mask:0xf bank_mask:0xf
  buffer_load_dwordx4 a[216:219], v8, s[56:59], s79 offen offset:0
  buffer_load_dwordx4 a[220:223], v8, s[56:59], s79 offen offset:128
  s_waitcnt vmcnt(9)
  v_dot2_f32_bf16 v44, v104, v16, 0
  v_dot2_f32_bf16 v44, v105, v17, v44
  v_dot2_f32_bf16 v44, v106, v18, v44
  v_dot2_f32_bf16 v44, v107, v19, v44
  s_cbranch_vccnz L_ts86
L_th86:
  buffer_load_dwordx4 v[104:107], v5, s[44:47], s8 offen offset:0 nt
  s_waitcnt vmcnt(9)
  v_dot2_f32_bf16 v44, v108, v20, v44
  v_dot2_f32_bf16 v44, v109, v21, v44
  v_dot2_f32_bf16 v44, v110, v22, v44
  v_dot2_f32_bf16 v44, v111, v23, v44
  s_cbranch_vccnz L_ts87
L_th87:
  buffer_load_dwordx4 v[108:111], v5, s[44:47], s8 offen offset:128 nt
  s_waitcnt vmcnt(9)
  v_dot2_f32_bf16 v44, v112, v24, v44
  v_dot2_f32_bf16 v44, v113, v25, v44
  v_dot2_f32_bf16 v44, v114, v26, v44
  v_dot2_f32_bf16 v44, v115, v27, v44
  s_cbranch_vccnz L_ts88
L_th88:
  buffer_load_dwordx4 v[112:115], v5, s[44:47], s8 offen offset:256 nt
  s_add_u32 s8, s8, 12288
  s_cmp_ge_u32 s8, s27
  s_cselect_b32 s11, 1572864, 0
  s_sub_u32 s8, s8, s11
  s_nop 1
  v_add_f32_dpp v44, v44, v44 quad_perm:[1,0,3,2] row_mask:0xf bank_mask:0xf
  s_nop 1
  v_add_f32_dpp v44, v44, v44 quad_perm:[2,3,0,1] row_mask:0xf bank_mask:0xf
  s_nop 1
  v_add_f32_dpp v44, v44, v44 row_half_mirror row_mask:0xf bank_mask:0xf
  buffer_load_dwordx4 a[224:227], v8, s[96:99], s79 offen offset:256
  s_add_u32 s79, s79, 10240
  buffer_load_dwordx4 a[228:231], v8, s[56:59], s79 offen offset:0
  s_waitcnt vmcnt(9)
  v_dot2_f32_bf16 v45, v116, v16, 0
  v_dot2_f32_bf16 v45, v117, v17, v45
  v_dot2_f32_bf16 v45, v118, v18, v45
  v_dot2_f32_bf16 v45, v119, v19, v45
  s_cbranch_vccnz L_ts89
L_th89:
  buffer_load_dwordx4 v[116:119], v5, s[44:47], s8 offen offset:0 nt
  s_waitcnt vmcnt(9)
  v_dot2_f32_bf16 v45, v120, v20, v45
  v_dot2_f32_bf16 v45, v121, v21, v45
  v_dot2_f32_bf16 v45, v122, v22, v45
  v_dot2_f32_bf16 v45, v123, v23, v45
  s_cbranch_vccnz L_ts90
L_th90:
  buffer_load_dwordx4 v[120:123], v5, s[44:47], s8 offen offset:128 nt
  s_waitcnt vmcnt(9)
  v_dot2_f32_bf16 v45, v124, v24, v45
  v_dot2_f32_bf16 v45, v125, v25, v45
  v_dot2_f32_bf16 v45, v126, v26, v45
  v_dot2_f32_bf16 v45, v127, v27, v45
  s_cbranch_vccnz L_ts91
L_th91:
  buffer_load_dwordx4 v[124:127], v5, s[44:47], s8 offen offset:256 nt
  s_add_u32 s8, s8, 12288
  s_cmp_ge_u32 s8, s27
  s_cselect_b32 s11, 1572864, 0
  s_sub_u32 s8, s8, s11
  s_nop 1
  v_add_f32_dpp v45, v45, v45 quad_perm:[1,0,3,2] row_mask:0xf bank_mask:0xf
  s_nop 1
  v_add_f32_dpp v45, v45, v45 quad_perm:[2,3,0,1] row_mask:0xf bank_mask:0xf
  s_nop 1
  v_add_f32_dpp v45, v45, v45 row_half_mirror row_mask:0xf bank_mask:0xf
  buffer_load_dwordx4 a[232:235], v8, s[56:59], s79 offen offset:128
  buffer_load_dwordx4 a[236:239], v8, s[96:99], s79 offen offset:256
  s_add_u32 s79, s79, 10240
  s_waitcnt vmcnt(9)
  v_dot2_f32_bf16 v46, v104, v16, 0
  v_dot2_f32_bf16 v46, v105, v17, v46
  v_dot2_f32_bf16 v46, v106, v18, v46
  v_dot2_f32_bf16 v46, v107, v19, v46
  s_cbranch_vccnz L_ts92
L_th92:
  buffer_load_dwordx4 v[104:107], v5, s[44:47], s8 offen offset:0 nt
  s_waitcnt vmcnt(9)
  v_dot2_f32_bf16 v46, v108, v20, v46
  v_dot2_f32_bf16 v46, v109, v21, v46
  v_dot2_f32_bf16 v46, v110, v22, v46
  v_dot2_f32_bf16 v46, v111, v23, v46
  s_cbranch_vccnz L_ts93
L_th93:
  buffer_load_dwordx4 v[108:111], v5, s[44:47], s8 offen offset:128 nt
  s_waitcnt vmcnt(9)
  v_dot2_f32_bf16 v46, v112, v24, v46
  v_dot2_f32_bf16 v46, v113, v25, v46
  v_dot2_f32_bf16 v46, v114, v26, v46
  v_dot2_f32_bf16 v46, v115, v27, v46
  s_cbranch_vccnz L_ts94
L_th94:
  buffer_load_dwordx4 v[112:115], v5, s[44:47], s8 offen offset:256 nt
  s_add_u32 s8, s8, 12288
  s_cmp_ge_u32 s8, s27
  s_cselect_b32 s11, 1572864, 0
  s_sub_u32 s8, s8, s11
  s_nop 1
  v_add_f32_dpp v46, v46, v46 quad_perm:[1,0,3,2] row_mask:0xf bank_mask:0xf
  s_nop 1
  v_add_f32_dpp v46, v46, v46 quad_perm:[2,3,0,1] row_mask:0xf bank_mask:0xf
  s_nop 1
  v_add_f32_dpp v46, v46, v46 row_half_mirror row_mask:0xf bank_mask:0xf
  s_waitcnt vmcnt(7)
  v_dot2_f32_bf16 v47, v116, v16, 0
  v_dot2_f32_bf16 v47, v117, v17, v47
  v_dot2_f32_bf16 v47, v118, v18, v47
  v_dot2_f32_bf16 v47, v119, v19, v47
  s_cbranch_vccnz L_ts95
L_th95:
  buffer_load_dwordx4 v[116:119], v5, s[44:47], s8 offen offset:0 nt
  s_waitcnt vmcnt(7)
  v_dot2_f32_bf16 v47, v120, v20, v47
  v_dot2_f32_bf16 v47, v121, v21, v47
  v_dot2_f32_bf16 v47, v122, v22, v47
  v_dot2_f32_bf16 v47, v123, v23, v47
  s_cbranch_vccnz L_ts96
L_th96:
  buffer_load_dwordx4 v[120:123], v5, s[44:47], s8 offen offset:128 nt
  s_waitcnt vmcnt(7)
  v_dot2_f32_bf16 v47, v124, v24, v47
  v_dot2_f32_bf16 v47, v125, v25, v47
  v_dot2_f32_bf16 v47, v126, v26, v47
  v_dot2_f32_bf16 v47, v127, v27, v47
  s_cbranch_vccnz L_ts97
L_th97:
  buffer_load_dwordx4 v[124:127], v5, s[44:47], s8 offen offset:256 nt
  s_add_u32 s8, s8, s17
  s_cmp_ge_u32 s8, s27
  s_cselect_b32 s11, 1572864, 0
  s_sub_u32 s8, s8, s11
  s_nop 1
  v_add_f32_dpp v47, v47, v47 quad_perm:[1,0,3,2] row_mask:0xf bank_mask:0xf
  s_nop 1
  v_add_f32_dpp v47, v47, v47 quad_perm:[2,3,0,1] row_mask:0xf bank_mask:0xf
  s_nop 1
  v_add_f32_dpp v47, v47, v47 row_half_mirror row_mask:0xf bank_mask:0xf
  s_waitcnt vmcnt(5)
  v_dot2_f32_bf16 v48, v104, v16, 0
  v_dot2_f32_bf16 v48, v105, v17, v48
  v_dot2_f32_bf16 v48, v106, v18, v48
  v_dot2_f32_bf16 v48, v107, v19, v48
  s_cbranch_vccnz L_ts98
L_th98:
  buffer_load_dwordx4 v[104:107], v5, s[44:47], s8 offen offset:0 nt
  s_waitcnt vmcnt(5)
  v_dot2_f32_bf16 v48, v108, v20, v48
  v_dot2_f32_bf16 v48, v109, v21, v48
  v_dot2_f32_bf16 v48, v110, v22, v48
  v_dot2_f32_bf16 v48, v111, v23, v48
  s_cbranch_vccnz L_ts99
L_th99:
  buffer_load_dwordx4 v[108:111], v5, s[44:47], s8 offen offset:128 nt
  s_waitcnt vmcnt(5)
  v_dot2_f32_bf16 v48, v112, v24, v48
  v_dot2_f32_bf16 v48, v113, v25, v48
  v_dot2_f32_bf16 v48, v114, v26, v48
  v_dot2_f32_bf16 v48, v115, v27, v48
  s_cbranch_vccnz L_ts100
L_th100:
  buffer_load_dwordx4 v[112:115], v5, s[44:47], s8 offen offset:256 nt
  s_add_u32 s8, s8, 12288
  s_cmp_ge_u32 s8, s27
  s_cselect_b32 s11, 1572864, 0
  s_sub_u32 s8, s8, s11
  s_nop 1
  v_add_f32_dpp v48, v48, v48 quad_perm:[1,0,3,2] row_mask:0xf bank_mask:0xf
  s_nop 1
  v_add_f32_dpp v48, v48, v48 quad_perm:[2,3,0,1] row_mask:0xf bank_mask:0xf
  s_nop 1
  v_add_f32_dpp v48, v48, v48 row_half_mirror row_mask:0xf bank_mask:0xf
  s_add_u32 s11, s95, 1
  s_and_b32 s11, s11, 3
  s_cmp_lg_u32 s11, s3
  s_cbranch_scc1 L_c101
  s_movk_i32 s11, 0x1fe
  s_bitcmp1_b32 s11, s95
  s_cbranch_scc0 L_c101
  s_mov_b64 exec, 255
  buffer_load_dwordx4 v[220:223], v55, s[64:67], 0 offen sc1
  s_mov_b64 exec, -1
L_c101:
  s_waitcnt vmcnt(5)
  v_dot2_f32_bf16 v49, v116, v16, 0
  v_dot2_f32_bf16 v49, v117, v17, v49
  v_dot2_f32_bf16 v49, v118, v18, v49
  v_dot2_f32_bf16 v49, v119, v19, v49
  s_cbranch_vccnz L_ts102
L_th102:
  buffer_load_dwordx4 v[116:119], v5, s[44:47], s8 offen offset:0 nt
  s_waitcnt vmcnt(5)
  v_dot2_f32_bf16 v49, v120, v20, v49
  v_dot2_f32_bf16 v49, v121, v21, v49
  v_dot2_f32_bf16 v49, v122, v22, v49
  v_dot2_f32_bf16 v49, v123, v23, v49
  s_cbranch_vccnz L_ts103
L_th103:
  buffer_load_dwordx4 v[120:123], v5, s[44:47], s8 offen offset:128 nt
  s_waitcnt vmcnt(5)
  v_dot2_f32_bf16 v49, v124, v24, v49
  v_dot2_f32_bf16 v49, v125, v25, v49
  v_dot2_f32_bf16 v49, v126, v26, v49
  v_dot2_f32_bf16 v49, v127, v27, v49
  s_cbranch_vccnz L_ts104
L_th104:
  buffer_load_dwordx4 v[124:127], v5, s[44:47], s8 offen offset:256 nt
  s_add_u32 s8, s8, 12288
  s_cmp_ge_u32 s8, s27
  s_cselect_b32 s11, 1572864, 0
  s_sub_u32 s8, s8, s11
  s_nop 1
  v_add_f32_dpp v49, v49, v49 quad_perm:[1,0,3,2] row_mask:0xf bank_mask:0xf
  s_nop 1
  v_add_f32_dpp v49, v49, v49 quad_perm:[2,3,0,1] row_mask:0xf bank_mask:0xf
  s_nop 1
  v_add_f32_dpp v49, v49, v49 row_half_mirror row_mask:0xf bank_mask:0xf
  s_waitcnt vmcnt(5)
  v_dot2_f32_bf16 v50, v104, v16, 0
  v_dot2_f32_bf16 v50, v105, v17, v50
  v_dot2_f32_bf16 v50, v106, v18, v50
  v_dot2_f32_bf16 v50, v107, v19, v50
  s_cbranch_vccnz L_ts105
L_th105:
  buffer_load_dwordx4 v[104:107], v5, s[44:47], s8 offen offset:0 nt
  s_waitcnt vmcnt(5)
  v_dot2_f32_bf16 v50, v108, v20, v50
  v_dot2_f32_bf16 v50, v109, v21, v50
  v_dot2_f32_bf16 v50, v110, v22, v50
  v_dot2_f32_bf16 v50, v111, v23, v50
  s_cbranch_vccnz L_ts106
L_th106:
  buffer_load_dwordx4 v[108:111], v5, s[44:47], s8 offen offset:128 nt
  s_waitcnt vmcnt(5)
  v_dot2_f32_bf16 v50, v112, v24, v50
  v_dot2_f32_bf16 v50, v113, v25, v50
  v_dot2_f32_bf16 v50, v114, v26, v50
  v_dot2_f32_bf16 v50, v115, v27, v50
  s_cbranch_vccnz L_ts107
L_th107:
  buffer_load_dwordx4 v[112:115], v5, s[44:47], s8 offen offset:256 nt
  s_add_u32 s8, s8, 12288
  s_cmp_ge_u32 s8, s27
  s_cselect_b32 s11, 1572864, 0
  s_sub_u32 s8, s8, s11
  s_nop 1
  v_add_f32_dpp v50, v50, v50 quad_perm:[1,0,3,2] row_mask:0xf bank_mask:0xf
  s_nop 1
  v_add_f32_dpp v50, v50, v50 quad_perm:[2,3,0,1] row_mask:0xf bank_mask:0xf
  s_nop 1
  v_add_f32_dpp v50, v50, v50 row_half_mirror row_mask:0xf bank_mask:0xf
  s_waitcnt vmcnt(5)
  v_dot2_f32_bf16 v51, v116, v16, 0
  v_dot2_f32_bf16 v51, v117, v17, v51
  v_dot2_f32_bf16 v51, v118, v18, v51
  v_dot2_f32_bf16 v51, v119, v19, v51
  s_cbranch_vccnz L_ts108
L_th108:
  buffer_load_dwordx4 v[116:119], v5, s[44:47], s8 offen offset:0 nt
  s_waitcnt vmcnt(5)
  v_dot2_f32_bf16 v51, v120, v20, v51
  v_dot2_f32_bf16 v51, v121, v21, v51
  v_dot2_f32_bf16 v51, v122, v22, v51
  v_dot2_f32_bf16 v51, v123, v23, v51
  s_cbranch_vccnz L_ts109
L_th109:
  buffer_load_dwordx4 v[120:123], v5, s[44:47], s8 offen offset:128 nt
  s_waitcnt vmcnt(5)
  v_dot2_f32_bf16 v51, v124, v24, v51
  v_dot2_f32_bf16 v51, v125, v25, v51
  v_dot2_f32_bf16 v51, v126, v26, v51
  v_dot2_f32_bf16 v51, v127, v27, v51
  s_cbranch_vccnz L_ts110
L_th110:
  buffer_load_dwordx4 v[124:127], v5, s[44:47], s8 offen offset:256 nt
  s_add_u32 s8, s8, 12288
  s_cmp_ge_u32 s8, s27
  s_cselect_b32 s11, 1572864, 0
  s_sub_u32 s8, s8, s11
  s_nop 1
  v_add_f32_dpp v51, v51, v51 quad_perm:[1,0,3,2] row_mask:0xf bank_mask:0xf
  s_nop 1
  v_add_f32_dpp v51, v51, v51 quad_perm:[2,3,0,1] row_mask:0xf bank_mask:0xf
  s_nop 1
  v_add_f32_dpp v51, v51, v51 row_half_mirror row_mask:0xf bank_mask:0xf
  s_waitcnt vmcnt(5)
  v_dot2_f32_bf16 v52, v104, v16, 0
  v_dot2_f32_bf16 v52, v105, v17, v52
  v_dot2_f32_bf16 v52, v106, v18, v52
  v_dot2_f32_bf16 v52, v107, v19, v52
  s_cbranch_vccnz L_ts111
L_th111:
  buffer_load_dwordx4 v[104:107], v5, s[44:47], s8 offen offset:0 nt
  s_waitcnt vmcnt(5)
  v_dot2_f32_bf16 v52, v108, v20, v52
  v_dot2_f32_bf16 v52, v109, v21, v52
  v_dot2_f32_bf16 v52, v110, v22, v52
  v_dot2_f32_bf16 v52, v111, v23, v52
  s_cbranch_vccnz L_ts112
L_th112:
  buffer_load_dwordx4 v[108:111], v5, s[44:47], s8 offen offset:128 nt
  s_waitcnt vmcnt(5)
  v_dot2_f32_bf16 v52, v112, v24, v52
  v_dot2_f32_bf16 v52, v113, v25, v52
  v_dot2_f32_bf16 v52, v114, v26, v52
  v_dot2_f32_bf16 v52, v115, v27, v52
  s_cbranch_vccnz L_ts113
L_th113:
  buffer_load_dwordx4 v[112:115], v5, s[44:47], s8 offen offset:256 nt
  s_add_u32 s8, s8, s17
  s_cmp_ge_u32 s8, s27
  s_cselect_b32 s11, 1572864, 0
  s_sub_u32 s8, s8, s11
  s_nop 1
  v_add_f32_dpp v52, v52, v52 quad_perm:[1,0,3,2] row_mask:0xf bank_mask:0xf
  s_nop 1
  v_add_f32_dpp v52, v52, v52 quad_perm:[2,3,0,1] row_mask:0xf bank_mask:0xf
  s_nop 1
  v_add_f32_dpp v52, v52, v52 row_half_mirror row_mask:0xf bank_mask:0xf
  s_add_u32 s11, s95, 1
  s_and_b32 s11, s11, 3
  s_cmp_lg_u32 s11, s3
  s_cbranch_scc1 L_c114
  s_movk_i32 s11, 0x1fe
  s_bitcmp1_b32 s11, s95
  s_cbranch_scc0 L_c114
  s_sub_u32 s12, s95, 1
  v_sub_u32 v220, s24, v220
  v_xor_b32 v221, s12, v221
  v_xor_b32 v222, s92, v222
  v_or_b32 v221, v221, v222
  v_cmp_eq_u32 vcc, 0, v221
  v_mov_b32 v222, -350
  s_nop 0
  v_cndmask_b32 v220, v222, v220, vcc
  s_nop 0
  v_readlane_b32 s14, v220, 0
  v_readlane_b32 s11, v220, 1
  s_nop 0
  s_add_i32 s14, s14, s11
  v_readlane_b32 s11, v220, 2
  s_nop 0
  s_add_i32 s14, s14, s11
  v_readlane_b32 s11, v220, 3
  s_nop 0
  s_add_i32 s14, s14, s11
  v_readlane_b32 s11, v220, 4
  s_nop 0
  s_add_i32 s14, s14, s11
  v_readlane_b32 s11, v220, 5
  s_nop 0
  s_add_i32 s14, s14, s11
  v_readlane_b32 s11, v220, 6
  s_nop 0
  s_add_i32 s14, s14, s11
  v_readlane_b32 s11, v220, 7
  s_nop 0
  s_add_i32 s14, s14, s11
  s_nop 0
  s_ashr_i32 s14, s14, 3
  s_sub_i32 s11, -160, s14
  s_mul_i32 s11, s11, 6
  s_ashr_i32 s11, s11, 8
  s_max_i32 s11, s11, 0
  s_min_i32 s11, s11, 4
  s_sub_i32 s14, 80, s14
  s_mul_i32 s14, s14, 14
  s_ashr_i32 s14, s14, 8
  s_max_i32 s14, s14, 0
  s_min_i32 s22, s14, 8
  s_add_u32 s22, s22, s11
  v_mov_b32 v1, 43328
  v_mov_b32 v4, s22
  ds_write_b32 v1, v4
  s_mov_b32 vcc_lo, s22
  s_mov_b32 vcc_hi, 0
L_c114:
  s_waitcnt vmcnt(5)
  v_dot2_f32_bf16 v53, v116, v16, 0
  v_dot2_f32_bf16 v53, v117, v17, v53
  v_dot2_f32_bf16 v53, v118, v18, v53
  v_dot2_f32_bf16 v53, v119, v19, v53
  s_cbranch_vccnz L_ts115
L_th115:
  s_mov_b32 s15, s43
  buffer_load_dwordx4 v[116:119], v5, s[48:51], s15 offen offset:0 nt
  s_waitcnt vmcnt(5)
  v_dot2_f32_bf16 v53, v120, v20, v53
  v_dot2_f32_bf16 v53, v121, v21, v53
  v_dot2_f32_bf16 v53, v122, v22, v53
  v_dot2_f32_bf16 v53, v123, v23, v53
  s_cbranch_vccnz L_ts116
L_th116:
  buffer_load_dwordx4 v[120:123], v5, s[48:51], s15 offen offset:128 nt
  s_waitcnt vmcnt(5)
  v_dot2_f32_bf16 v53, v124, v24, v53
  v_dot2_f32_bf16 v53, v125, v25, v53
  v_dot2_f32_bf16 v53, v126, v26, v53
  v_dot2_f32_bf16 v53, v127, v27, v53
  s_cbranch_vccnz L_ts117
L_th117:
  buffer_load_dwordx4 v[124:127], v5, s[48:51], s15 offen offset:256 nt
  s_add_u32 s15, s15, 12288
  s_cmp_ge_u32 s15, s27
  s_cselect_b32 s11, 1572864, 0
  s_sub_u32 s15, s15, s11
  s_nop 1
  v_add_f32_dpp v53, v53, v53 quad_perm:[1,0,3,2] row_mask:0xf bank_mask:0xf
  s_nop 1
  v_add_f32_dpp v53, v53, v53 quad_perm:[2,3,0,1] row_mask:0xf bank_mask:0xf
  s_nop 1
  v_add_f32_dpp v53, v53, v53 row_half_mirror row_mask:0xf bank_mask:0xf
  s_waitcnt vmcnt(5)
  v_dot2_f32_bf16 v54, v104, v16, 0
  v_dot2_f32_bf16 v54, v105, v17, v54
  v_dot2_f32_bf16 v54, v106, v18, v54
  v_dot2_f32_bf16 v54, v107, v19, v54
  s_cbranch_vccnz L_ts118
L_th118:
  buffer_load_dwordx4 v[104:107], v5, s[48:51], s15 offen offset:0 nt
  s_waitcnt vmcnt(5)
  v_dot2_f32_bf16 v54, v108, v20, v54
  v_dot2_f32_bf16 v54, v109, v21, v54
  v_dot2_f32_bf16 v54, v110, v22, v54
  v_dot2_f32_bf16 v54, v111, v23, v54
  s_cbranch_vccnz L_ts119
L_th119:
  buffer_load_dwordx4 v[108:111], v5, s[48:51], s15 offen offset:128 nt
  s_waitcnt vmcnt(5)
  v_dot2_f32_bf16 v54, v112, v24, v54
  v_dot2_f32_bf16 v54, v113, v25, v54
  v_dot2_f32_bf16 v54, v114, v26, v54
  v_dot2_f32_bf16 v54, v115, v27, v54
  s_cbranch_vccnz L_ts120
L_th120:
  buffer_load_dwordx4 v[112:115], v5, s[48:51], s15 offen offset:256 nt
  s_add_u32 s15, s15, 12288
  s_cmp_ge_u32 s15, s27
  s_cselect_b32 s11, 1572864, 0
  s_sub_u32 s15, s15, s11
  s_nop 1
  v_add_f32_dpp v54, v54, v54 quad_perm:[1,0,3,2] row_mask:0xf bank_mask:0xf
  s_nop 1
  v_add_f32_dpp v54, v54, v54 quad_perm:[2,3,0,1] row_mask:0xf bank_mask:0xf
  s_nop 1
  v_add_f32_dpp v54, v54, v54 row_half_mirror row_mask:0xf bank_mask:0xf
  v_mov_b32 v1, 43328
  ds_read_b32 v4, v1
  s_waitcnt lgkmcnt(0)
  v_readfirstlane_b32 s22, v4
  s_nop 1
  s_mov_b32 vcc_lo, s22
  s_mov_b32 vcc_hi, 0
  v_max3_f32 v1, v40, v41, v42
  v_max3_f32 v1, v1, v43, v44
  v_max3_f32 v1, v1, v45, v46
  v_max3_f32 v1, v1, v47, v48
  v_max3_f32 v1, v1, v49, v50
  v_max3_f32 v1, v1, v51, v52
  v_max3_f32 v1, v1, v53, v54
  s_nop 1
  v_max_f32_dpp v4, v1, v1 row_ror:8 row_mask:0xf bank_mask:0xf
  s_nop 0
  v_readlane_b32 s11, v4, 0
  v_readlane_b32 s12, v4, 16
  v_readlane_b32 s13, v4, 32
  v_readlane_b32 s14, v4, 48
  s_nop 0
  v_mov_b32 v9, s11
  v_max_f32 v9, s12, v9
  v_max_f32 v9, s13, v9
  v_max_f32 v9, s14, v9
  v_mul_f32 v10, s10, v9
  v_fma_f32 v40, v40, s10, -v10
  v_exp_f32 v40, v40
  s_nop 0
  v_cvt_pk_bf16_f32 v59, v40, v40
  v_mov_b32 v11, v40
  v_and_b32 v56, v59, v12
  v_and_b32 v57, v59, v13
  v_and_b32 v58, v59, v14
  v_and_b32 v59, v59, v15
  s_waitcnt vmcnt(5)
  s_nop 0
  v_mfma_f32_16x16x32_bf16 v[28:31], v[56:59], v[116:119], 0
  s_cbranch_vccnz L_ts121
L_th121:
  buffer_load_dwordx4 v[116:119], v5, s[48:51], s15 offen offset:0 nt
  s_waitcnt vmcnt(5)
  v_mfma_f32_16x16x32_bf16 v[32:35], v[56:59], v[120:123], 0
  s_cbranch_vccnz L_ts122
L_th122:
  buffer_load_dwordx4 v[120:123], v5, s[48:51], s15 offen offset:128 nt
  s_waitcnt vmcnt(5)
  v_mfma_f32_16x16x32_bf16 v[36:39], v[56:59], v[124:127], 0
  s_cbranch_vccnz L_ts123
L_th123:
  buffer_load_dwordx4 v[124:127], v5, s[48:51], s15 offen offset:256 nt
  s_add_u32 s15, s15, 12288
  s_cmp_ge_u32 s15, s27
  s_cselect_b32 s11, 1572864, 0
  s_sub_u32 s15, s15, s11
  v_fma_f32 v41, v41, s10, -v10
  v_exp_f32 v41, v41
  s_nop 0
  v_cvt_pk_bf16_f32 v63, v41, v41
  v_add_f32 v11, v11, v41
  v_and_b32 v60, v63, v12
  v_and_b32 v61, v63, v13
  v_and_b32 v62, v63, v14
  v_and_b32 v63, v63, v15
  s_waitcnt vmcnt(5)
  s_nop 0
  v_mfma_f32_16x16x32_bf16 v[28:31], v[60:63], v[104:107], v[28:31]
  s_cbranch_vccnz L_ts124
L_th124:
  buffer_load_dwordx4 v[104:107], v5, s[48:51], s15 offen offset:0 nt
  s_waitcnt vmcnt(5)
  v_mfma_f32_16x16x32_bf16 v[32:35], v[60:63], v[108:111], v[32:35]
  s_cbranch_vccnz L_ts125
L_th125:
  buffer_load_dwordx4 v[108:111], v5, s[48:51], s15 offen offset:128 nt
  s_waitcnt vmcnt(5)
  v_mfma_f32_16x16x32_bf16 v[36:39], v[60:63], v[112:115], v[36:39]
  s_cbranch_vccnz L_ts126
L_th126:
  buffer_load_dwordx4 v[112:115], v5, s[48:51], s15 offen offset:256 nt
  s_add_u32 s15, s15, 12288
  s_cmp_ge_u32 s15, s27
  s_cselect_b32 s11, 1572864, 0
  s_sub_u32 s15, s15, s11
  v_fma_f32 v42, v42, s10, -v10
  v_exp_f32 v42, v42
  s_nop 0
  v_cvt_pk_bf16_f32 v59, v42, v42
  v_add_f32 v11, v11, v42
  v_and_b32 v56, v59, v12
  v_and_b32 v57, v59, v13
  v_and_b32 v58, v59, v14
  v_and_b32 v59, v59, v15
  s_waitcnt vmcnt(5)
  s_nop 0
  v_mfma_f32_16x16x32_bf16 v[28:31], v[56:59], v[116:119], v[28:31]
  s_cbranch_vccnz L_ts127
L_th127:
  buffer_load_dwordx4 v[116:119], v5, s[48:51], s15 offen offset:0 nt
  s_waitcnt vmcnt(5)
  v_mfma_f32_16x16x32_bf16 v[32:35], v[56:59], v[120:123], v[32:35]
  s_cbranch_vccnz L_ts128
L_th128:
  buffer_load_dwordx4 v[120:123], v5, s[48:51], s15 offen offset:128 nt
  s_waitcnt vmcnt(5)
  v_mfma_f32_16x16x32_bf16 v[36:39], v[56:59], v[124:127], v[36:39]
  s_cbranch_vccnz L_ts129
L_th129:
  buffer_load_dwordx4 v[124:127], v5, s[48:51], s15 offen offset:256 nt
  s_add_u32 s15, s15, s17
  s_cmp_ge_u32 s15, s27
  s_cselect_b32 s11, 1572864, 0
  s_sub_u32 s15, s15, s11
  v_fma_f32 v43, v43, s10, -v10
  v_exp_f32 v43, v43
  s_nop 0
  v_cvt_pk_bf16_f32 v63, v43, v43
  v_add_f32 v11, v11, v43
  v_and_b32 v60, v63, v12
  v_and_b32 v61, v63, v13
  v_and_b32 v62, v63, v14
  v_and_b32 v63, v63, v15
  s_waitcnt vmcnt(5)
  s_nop 0
  v_mfma_f32_16x16x32_bf16 v[28:31], v[60:63], v[104:107], v[28:31]
  s_cbranch_vccnz L_ts130
L_th130:
  buffer_load_dwordx4 v[104:107], v5, s[48:51], s15 offen offset:0 nt
  s_waitcnt vmcnt(5)
  v_mfma_f32_16x16x32_bf16 v[32:35], v[60:63], v[108:111], v[32:35]
  s_cbranch_vccnz L_ts131
L_th131:
  buffer_load_dwordx4 v[108:111], v5, s[48:51], s15 offen offset:128 nt
  s_waitcnt vmcnt(5)
  v_mfma_f32_16x16x32_bf16 v[36:39], v[60:63], v[112:115], v[36:39]
  s_cbranch_vccnz L_ts132
L_th132:
  buffer_load_dwordx4 v[112:115], v5, s[48:51], s15 offen offset:256 nt
  s_add_u32 s15, s15, 12288
  s_cmp_ge_u32 s15, s27
  s_cselect_b32 s11, 1572864, 0
  s_sub_u32 s15, s15, s11
  v_fma_f32 v44, v44, s10, -v10
  v_exp_f32 v44, v44
  s_nop 0
  v_cvt_pk_bf16_f32 v59, v44, v44
  v_add_f32 v11, v11, v44
  v_and_b32 v56, v59, v12
  v_and_b32 v57, v59, v13
  v_and_b32 v58, v59, v14
  v_and_b32 v59, v59, v15
  s_waitcnt vmcnt(5)
  s_nop 0
  v_mfma_f32_16x16x32_bf16 v[28:31], v[56:59], v[116:119], v[28:31]
  s_cbranch_vccnz L_ts133
L_th133:
  buffer_load_dwordx4 v[116:119], v5, s[48:51], s15 offen offset:0 nt
  s_waitcnt vmcnt(5)
  v_mfma_f32_16x16x32_bf16 v[32:35], v[56:59], v[120:123], v[32:35]
  s_cbranch_vccnz L_ts134
L_th134:
  buffer_load_dwordx4 v[120:123], v5, s[48:51], s15 offen offset:128 nt
  s_waitcnt vmcnt(5)
  v_mfma_f32_16x16x32_bf16 v[36:39], v[56:59], v[124:127], v[36:39]
  s_cbranch_vccnz L_ts135
L_th135:
  buffer_load_dwordx4 v[124:127], v5, s[48:51], s15 offen offset:256 nt
  s_add_u32 s15, s15, 12288
  s_cmp_ge_u32 s15, s27
  s_cselect_b32 s11, 1572864, 0
  s_sub_u32 s15, s15, s11
  s_add_u32 s11, s32, 1
  s_and_b32 s11, s11, 7
  s_cmp_lt_u32 s95, 7
  s_cselect_b32 s11, s11, s7
  s_lshl_b32 s12, s5, 3
  s_add_u32 s11, s11, s12
  s_mul_i32 s11, s11, 768
  s_add_u32 s78, s11, 1048576
  buffer_load_dwordx4 v[156:159], v6, s[64:67], s78 offen offset:0 sc1
  buffer_load_dwordx4 v[160:163], v6, s[64:67], s78 offen offset:16 sc1
  buffer_load_dwordx4 v[164:167], v6, s[64:67], s78 offen offset:256 sc1
  buffer_load_dwordx4 v[168:171], v6, s[64:67], s78 offen offset:272 sc1
  buffer_load_dwordx4 v[172:175], v6, s[64:67], s78 offen offset:512 sc1
  buffer_load_dwordx4 v[176:179], v6, s[64:67], s78 offen offset:528 sc1
  v_fma_f32 v45, v45, s10, -v10
  v_exp_f32 v45, v45
  s_nop 0
  v_cvt_pk_bf16_f32 v63, v45, v45
  v_add_f32 v11, v11, v45
  v_and_b32 v60, v63, v12
  v_and_b32 v61, v63, v13
  v_and_b32 v62, v63, v14
  v_and_b32 v63, v63, v15
  s_waitcnt vmcnt(11)
  s_nop 0
  v_mfma_f32_16x16x32_bf16 v[28:31], v[60:63], v[104:107], v[28:31]
  s_cbranch_vccnz L_ts136
L_th136:
  buffer_load_dwordx4 v[104:107], v5, s[48:51], s15 offen offset:0 nt
  s_waitcnt vmcnt(11)
  v_mfma_f32_16x16x32_bf16 v[32:35], v[60:63], v[108:111], v[32:35]
  s_cbranch_vccnz L_ts137
L_th137:
  buffer_load_dwordx4 v[108:111], v5, s[48:51], s15 offen offset:128 nt
  s_waitcnt vmcnt(11)
  v_mfma_f32_16x16x32_bf16 v[36:39], v[60:63], v[112:115], v[36:39]
  s_cbranch_vccnz L_ts138
L_th138:
  buffer_load_dwordx4 v[112:115], v5, s[48:51], s15 offen offset:256 nt
  s_add_u32 s15, s15, 12288
  s_cmp_ge_u32 s15, s27
  s_cselect_b32 s11, 1572864, 0
  s_sub_u32 s15, s15, s11
  v_fma_f32 v46, v46, s10, -v10
  v_exp_f32 v46, v46
  s_nop 0
  v_cvt_pk_bf16_f32 v59, v46, v46
  v_add_f32 v11, v11, v46
  v_and_b32 v56, v59, v12
  v_and_b32 v57, v59, v13
  v_and_b32 v58, v59, v14
  v_and_b32 v59, v59, v15
  s_waitcnt vmcnt(11)
  s_nop 0
  v_mfma_f32_16x16x32_bf16 v[28:31], v[56:59], v[116:119], v[28:31]
  s_cbranch_vccnz L_ts139
L_th139:
  buffer_load_dwordx4 v[116:119], v5, s[48:51], s15 offen offset:0 nt
  s_waitcnt vmcnt(11)
  v_mfma_f32_16x16x32_bf16 v[32:35], v[56:59], v[120:123], v[32:35]
  s_cbranch_vccnz L_ts140
L_th140:
  buffer_load_dwordx4 v[120:123], v5, s[48:51], s15 offen offset:128 nt
  s_waitcnt vmcnt(11)
  v_mfma_f32_16x16x32_bf16 v[36:39], v[56:59], v[124:127], v[36:39]
  s_cbranch_vccnz L_ts141
L_th141:
  buffer_load_dwordx4 v[124:127], v5, s[48:51], s15 offen offset:256 nt
  s_add_u32 s15, s15, 12288
  s_cmp_ge_u32 s15, s27
  s_cselect_b32 s11, 1572864, 0
  s_sub_u32 s15, s15, s11
  v_fma_f32 v47, v47, s10, -v10
  v_exp_f32 v47, v47
  s_nop 0
  v_cvt_pk_bf16_f32 v63, v47, v47
  v_add_f32 v11, v11, v47
  v_and_b32 v60, v63, v12
  v_and_b32 v61, v63, v13
  v_and_b32 v62, v63, v14
  v_and_b32 v63, v63, v15
  s_waitcnt vmcnt(5)
  s_nop 0
  v_mfma_f32_16x16x32_bf16 v[28:31], v[60:63], v[104:107], v[28:31]
  s_cbranch_vccnz L_ts142
L_th142:
  buffer_load_dwordx4 v[104:107], v5, s[48:51], s15 offen offset:0 nt
  s_waitcnt vmcnt(5)
  v_mfma_f32_16x16x32_bf16 v[32:35], v[60:63], v[108:111], v[32:35]
  s_cbranch_vccnz L_ts143
L_th143:
  buffer_load_dwordx4 v[108:111], v5, s[48:51], s15 offen offset:128 nt
  s_waitcnt vmcnt(5)
  v_mfma_f32_16x16x32_bf16 v[36:39], v[60:63], v[112:115], v[36:39]
  s_cbranch_vccnz L_ts144
L_th144:
  buffer_load_dwordx4 v[112:115], v5, s[48:51], s15 offen offset:256 nt
  s_add_u32 s15, s15, s17
  s_cmp_ge_u32 s15, s27
  s_cselect_b32 s11, 1572864, 0
  s_sub_u32 s15, s15, s11
  v_fma_f32 v48, v48, s10, -v10
  v_exp_f32 v48, v48
  s_nop 0
  v_cvt_pk_bf16_f32 v59, v48, v48
  v_add_f32 v11, v11, v48
  v_and_b32 v56, v59, v12
  v_and_b32 v57, v59, v13
  v_and_b32 v58, v59, v14
  v_and_b32 v59, v59, v15
  s_waitcnt vmcnt(5)
  s_nop 0
  v_mfma_f32_16x16x32_bf16 v[28:31], v[56:59], v[116:119], v[28:31]
  s_cbranch_vccnz L_ts145
L_th145:
  buffer_load_dwordx4 v[116:119], v5, s[48:51], s15 offen offset:0 nt
  s_waitcnt vmcnt(5)
  v_mfma_f32_16x16x32_bf16 v[32:35], v[56:59], v[120:123], v[32:35]
  s_cbranch_vccnz L_ts146
L_th146:
  buffer_load_dwordx4 v[120:123], v5, s[48:51], s15 offen offset:128 nt
  s_waitcnt vmcnt(5)
  v_mfma_f32_16x16x32_bf16 v[36:39], v[56:59], v[124:127], v[36:39]
  s_cbranch_vccnz L_ts147
L_th147:
  buffer_load_dwordx4 v[124:127], v5, s[48:51], s15 offen offset:256 nt
  s_add_u32 s15, s15, 12288
  s_cmp_ge_u32 s15, s27
  s_cselect_b32 s11, 1572864, 0
  s_sub_u32 s15, s15, s11
  v_fma_f32 v49, v49, s10, -v10
  v_exp_f32 v49, v49
  s_nop 0
  v_cvt_pk_bf16_f32 v63, v49, v49
  v_add_f32 v11, v11, v49
  v_and_b32 v60, v63, v12
  v_and_b32 v61, v63, v13
  v_and_b32 v62, v63, v14
  v_and_b32 v63, v63, v15
  s_waitcnt vmcnt(5)
  s_nop 0
  v_mfma_f32_16x16x32_bf16 v[28:31], v[60:63], v[104:107], v[28:31]
  s_cbranch_vccnz L_ts148
L_th148:
  buffer_load_dwordx4 v[104:107], v5, s[48:51], s15 offen offset:0 nt
  s_waitcnt vmcnt(5)
  v_mfma_f32_16x16x32_bf16 v[32:35], v[60:63], v[108:111], v[32:35]
  s_cbranch_vccnz L_ts149
L_th149:
  buffer_load_dwordx4 v[108:111], v5, s[48:51], s15 offen offset:128 nt
  s_waitcnt vmcnt(5)
  v_mfma_f32_16x16x32_bf16 v[36:39], v[60:63], v[112:115], v[36:39]
  s_cbranch_vccnz L_ts150
L_th150:
  buffer_load_dwordx4 v[112:115], v5, s[48:51], s15 offen offset:256 nt
  s_add_u32 s15, s15, 12288
  s_cmp_ge_u32 s15, s27
  s_cselect_b32 s11, 1572864, 0
  s_sub_u32 s15, s15, s11
  v_fma_f32 v50, v50, s10, -v10
  v_exp_f32 v50, v50
  s_nop 0
  v_cvt_pk_bf16_f32 v59, v50, v50
  v_add_f32 v11, v11, v50
  v_and_b32 v56, v59, v12
  v_and_b32 v57, v59, v13
  v_and_b32 v58, v59, v14
  v_and_b32 v59, v59, v15
  s_waitcnt vmcnt(5)
  s_nop 0
  v_mfma_f32_16x16x32_bf16 v[28:31], v[56:59], v[116:119], v[28:31]
  s_cbranch_vccnz L_ts151
L_th151:
  buffer_load_dwordx4 v[116:119], v5, s[48:51], s15 offen offset:0 nt
  s_waitcnt vmcnt(5)
  v_mfma_f32_16x16x32_bf16 v[32:35], v[56:59], v[120:123], v[32:35]
  s_cbranch_vccnz L_ts152
L_th152:
  buffer_load_dwordx4 v[120:123], v5, s[48:51], s15 offen offset:128 nt
  s_waitcnt vmcnt(5)
  v_mfma_f32_16x16x32_bf16 v[36:39], v[56:59], v[124:127], v[36:39]
  s_cbranch_vccnz L_ts153
L_th153:
  buffer_load_dwordx4 v[124:127], v5, s[48:51], s15 offen offset:256 nt
  s_add_u32 s15, s15, 12288
  s_cmp_ge_u32 s15, s27
  s_cselect_b32 s11, 1572864, 0
  s_sub_u32 s15, s15, s11
  v_fma_f32 v51, v51, s10, -v10
  v_exp_f32 v51, v51
  s_nop 0
  v_cvt_pk_bf16_f32 v63, v51, v51
  v_add_f32 v11, v11, v51
  v_and_b32 v60, v63, v12
  v_and_b32 v61, v63, v13
  v_and_b32 v62, v63, v14
  v_and_b32 v63, v63, v15
  s_waitcnt vmcnt(5)
  s_nop 0
  v_mfma_f32_16x16x32_bf16 v[28:31], v[60:63], v[104:107], v[28:31]
  s_cbranch_vccnz L_ts154
L_th154:
  buffer_load_dwordx4 v[104:107], v5, s[48:51], s15 offen offset:0 nt
  s_waitcnt vmcnt(5)
  v_mfma_f32_16x16x32_bf16 v[32:35], v[60:63], v[108:111], v[32:35]
  s_cbranch_vccnz L_ts155
L_th155:
  buffer_load_dwordx4 v[108:111], v5, s[48:51], s15 offen offset:128 nt
  s_waitcnt vmcnt(5)
  v_mfma_f32_16x16x32_bf16 v[36:39], v[60:63], v[112:115], v[36:39]
  s_cbranch_vccnz L_ts156
L_th156:
  buffer_load_dwordx4 v[112:115], v5, s[48:51], s15 offen offset:256 nt
  s_add_u32 s15, s15, 12288
  s_cmp_ge_u32 s15, s27
  s_cselect_b32 s11, 1572864, 0
  s_sub_u32 s15, s15, s11
  v_fma_f32 v52, v52, s10, -v10
  v_exp_f32 v52, v52
  s_nop 0
  v_cvt_pk_bf16_f32 v59, v52, v52
  v_add_f32 v11, v11, v52
  v_and_b32 v56, v59, v12
  v_and_b32 v57, v59, v13
  v_and_b32 v58, v59, v14
  v_and_b32 v59, v59, v15
  s_waitcnt vmcnt(5)
  s_nop 0
  v_mfma_f32_16x16x32_bf16 v[28:31], v[56:59], v[116:119], v[28:31]
  s_cbranch_vccnz L_ts157
L_th157:
  buffer_load_dwordx4 v[116:119], v5, s[48:51], s15 offen offset:0 nt
  s_waitcnt vmcnt(5)
  v_mfma_f32_16x16x32_bf16 v[32:35], v[56:59], v[120:123], v[32:35]
  s_cbranch_vccnz L_ts158
L_th158:
  buffer_load_dwordx4 v[120:123], v5, s[48:51], s15 offen offset:128 nt
  s_waitcnt vmcnt(5)
  v_mfma_f32_16x16x32_bf16 v[36:39], v[56:59], v[124:127], v[36:39]
  s_cbranch_vccnz L_ts159
L_th159:
  buffer_load_dwordx4 v[124:127], v5, s[48:51], s15 offen offset:256 nt
  s_add_u32 s15, s15, s17
  s_cmp_ge_u32 s15, s27
  s_cselect_b32 s11, 1572864, 0
  s_sub_u32 s15, s15, s11
  v_fma_f32 v53, v53, s10, -v10
  v_exp_f32 v53, v53
  s_nop 0
  v_cvt_pk_bf16_f32 v63, v53, v53
  v_add_f32 v11, v11, v53
  v_and_b32 v60, v63, v12
  v_and_b32 v61, v63, v13
  v_and_b32 v62, v63, v14
  v_and_b32 v63, v63, v15
  s_waitcnt vmcnt(5)
  s_nop 0
  v_mfma_f32_16x16x32_bf16 v[28:31], v[60:63], v[104:107], v[28:31]
  s_cbranch_vccnz L_ts160
L_th160:
  s_add_u32 s11, s94, s33
  s_and_b32 s11, s11, 7
  s_cmp_lt_u32 s94, 8
  s_cselect_b32 s11, s11, s7
  s_cselect_b32 s12, s16, s26
  s_cselect_b32 s17, 36, 1
  s_mul_i32 s17, s17, 12288
  s_cselect_b32 s27, 0, -1
  s_and_b32 s13, s11, 3
  s_lshl_b32 s13, s13, 5
  s_add_u32 s13, s13, s5
  s_mul_i32 s13, s13, 1572864
  s_mul_i32 s43, s3, 3072
  s_add_u32 s13, s13, s43
  s_add_u32 s43, s13, s12
  s_add_u32 s13, s13, 1572864
  s_or_b32 s27, s27, s13
  s_cmp_ge_u32 s11, 4
  s_cselect_b32 s44, s28, s18
  s_cselect_b32 s45, s29, s19
  s_cselect_b32 s48, s30, s20
  s_cselect_b32 s49, s31, s21
  s_mov_b32 s8, s43
  s_add_u32 s94, s94, 1
  buffer_load_dwordx4 v[104:107], v5, s[44:47], s8 offen offset:0 nt
  s_waitcnt vmcnt(5)
  v_mfma_f32_16x16x32_bf16 v[32:35], v[60:63], v[108:111], v[32:35]
  s_cbranch_vccnz L_ts162
L_th162:
  buffer_load_dwordx4 v[108:111], v5, s[44:47], s8 offen offset:128 nt
  s_waitcnt vmcnt(5)
  v_mfma_f32_16x16x32_bf16 v[36:39], v[60:63], v[112:115], v[36:39]
  s_cbranch_vccnz L_ts163
L_th163:
  buffer_load_dwordx4 v[112:115], v5, s[44:47], s8 offen offset:256 nt
  s_add_u32 s8, s8, 12288
  s_cmp_ge_u32 s8, s27
  s_cselect_b32 s11, 1572864, 0
  s_sub_u32 s8, s8, s11
  v_fma_f32 v54, v54, s10, -v10
  v_exp_f32 v54, v54
  s_nop 0
  v_cvt_pk_bf16_f32 v59, v54, v54
  v_add_f32 v11, v11, v54
  v_and_b32 v56, v59, v12
  v_and_b32 v57, v59, v13
  v_and_b32 v58, v59, v14
  v_and_b32 v59, v59, v15
  s_waitcnt vmcnt(5)
  s_nop 0
  v_mfma_f32_16x16x32_bf16 v[28:31], v[56:59], v[116:119], v[28:31]
  s_cbranch_vccnz L_ts164
L_th164:
  buffer_load_dwordx4 v[116:119], v5, s[44:47], s8 offen offset:0 nt
  s_waitcnt vmcnt(5)
  v_mfma_f32_16x16x32_bf16 v[32:35], v[56:59], v[120:123], v[32:35]
  s_cbranch_vccnz L_ts165
L_th165:
  buffer_load_dwordx4 v[120:123], v5, s[44:47], s8 offen offset:128 nt
  s_waitcnt vmcnt(5)
  v_mfma_f32_16x16x32_bf16 v[36:39], v[56:59], v[124:127], v[36:39]
  s_cbranch_vccnz L_ts166
L_th166:
  buffer_load_dwordx4 v[124:127], v5, s[44:47], s8 offen offset:256 nt
  s_add_u32 s8, s8, 12288
  s_cmp_ge_u32 s8, s27
  s_cselect_b32 s11, 1572864, 0
  s_sub_u32 s8, s8, s11
  v_add_f32_dpp v11, v11, v11 row_ror:8 row_mask:0xf bank_mask:0xf
  v_add_u32 v1, s101, v97
  v_readlane_b32 s11, v11, 0
  v_readlane_b32 s12, v11, 16
  v_readlane_b32 s13, v11, 32
  v_readlane_b32 s14, v11, 48
  s_nop 1
  ds_write_b128 v1, v[28:31] offset:0
  ds_write_b128 v1, v[32:35] offset:1024
  ds_write_b128 v1, v[36:39] offset:2048
  v_mov_b32 v10, s11
  v_add_f32 v10, s12, v10
  v_add_f32 v10, s13, v10
  v_add_f32 v10, s14, v10
  s_lshl_b32 s11, s3, 3
  s_add_u32 s11, s11, s101
  v_mov_b32 v1, s11
  v_mov_b32 v180, v9
  v_mov_b32 v181, v10
  ds_write_b64 v1, v[180:181] offset:16384
  s_waitcnt lgkmcnt(0)
  s_barrier
  s_add_u32 s11, s95, 2
  s_and_b32 s11, s11, 3
  s_cmp_lg_u32 s11, s3
  s_cbranch_scc1 L_p167
  s_movk_i32 s11, 0xff
  s_bitcmp1_b32 s11, s95
  s_cbranch_scc0 L_p167
  s_memrealtime s[24:25]
  v_mov_b32 v217, s95
  v_mov_b32 v218, s92
  v_mov_b32 v219, s93
  s_lshl_b32 s11, s2, 7
  s_add_u32 s11, s11, 2162688
  v_lshlrev_b32 v4, 4, v0
  s_waitcnt lgkmcnt(0)
  s_and_b32 s12, s2, 56
  s_cbranch_scc1 L_p167
  v_mov_b32 v216, s24
  s_mov_b64 exec, 0xff
  buffer_store_dwordx4 v[216:219], v4, s[64:67], s11 offen sc1
  s_mov_b64 exec, -1
L_p167:
  s_and_b32 s11, s95, 3
  s_cmp_lg_u32 s11, s3
  s_cbranch_scc1 L_m168
  v_mov_b32 v1, s101
  v_add_u32 v4, s101, v96
  ds_read_b128 v[180:183], v1 offset:16384
  ds_read_b128 v[184:187], v1 offset:16400
  ds_read_b128 v[64:67], v4 offset:0
  ds_read_b128 v[68:71], v4 offset:640
  ds_read_b128 v[72:75], v4 offset:4096
  ds_read_b128 v[76:79], v4 offset:4736
  ds_read_b128 v[80:83], v4 offset:8192
  ds_read_b128 v[84:87], v4 offset:8832
  ds_read_b128 v[88:91], v4 offset:12288
  ds_read_b128 v[92:95], v4 offset:12928
  s_waitcnt lgkmcnt(8)
  v_max3_f32 v100, v180, v182, v184
  v_max_f32 v100, v100, v186
  v_sub_f32 v40, v180, v100
  v_sub_f32 v41, v182, v100
  v_sub_f32 v42, v184, v100
  v_sub_f32 v43, v186, v100
  v_mul_f32 v40, s10, v40
  v_mul_f32 v41, s10, v41
  v_mul_f32 v42, s10, v42
  v_mul_f32 v43, s10, v43
  v_exp_f32 v40, v40
  v_exp_f32 v41, v41
  v_exp_f32 v42, v42
  v_exp_f32 v43, v43
  s_nop 0
  v_mul_f32 v101, v40, v181
  v_fmac_f32 v101, v41, v183
  v_fmac_f32 v101, v42, v185
  v_fmac_f32 v101, v43, v187
  s_waitcnt lgkmcnt(6)
  v_add_f32 v64, v64, v68
  v_add_f32 v65, v65, v69
  v_add_f32 v66, v66, v70
  v_add_f32 v67, v67, v71
  v_mul_f32 v56, v40, v64
  v_mul_f32 v57, v40, v65
  v_mul_f32 v58, v40, v66
  v_mul_f32 v59, v40, v67
  s_waitcnt lgkmcnt(4)
  v_add_f32 v72, v72, v76
  v_add_f32 v73, v73, v77
  v_add_f32 v74, v74, v78
  v_add_f32 v75, v75, v79
  v_fmac_f32 v56, v41, v72
  v_fmac_f32 v57, v41, v73
  v_fmac_f32 v58, v41, v74
  v_fmac_f32 v59, v41, v75
  s_waitcnt lgkmcnt(2)
  v_add_f32 v80, v80, v84
  v_add_f32 v81, v81, v85
  v_add_f32 v82, v82, v86
  v_add_f32 v83, v83, v87
  v_fmac_f32 v56, v42, v80
  v_fmac_f32 v57, v42, v81
  v_fmac_f32 v58, v42, v82
  v_fmac_f32 v59, v42, v83
  s_waitcnt lgkmcnt(0)
  v_add_f32 v88, v88, v92
  v_add_f32 v89, v89, v93
  v_add_f32 v90, v90, v94
  v_add_f32 v91, v91, v95
  v_fmac_f32 v56, v43, v88
  v_fmac_f32 v57, v43, v89
  v_fmac_f32 v58, v43, v90
  v_fmac_f32 v59, v43, v91
  s_lshl_b32 s11, s32, 3
  s_add_u32 s11, s11, 39040
  v_mov_b32 v1, s11
  ds_write_b64 v1, v[100:101]
  s_cmp_lg_u32 s32, s7
  s_cbranch_scc1 L_g168
  v_lshlrev_b32 v1, 4, v0
  ds_write_b128 v1, v[56:59] offset:39104
  s_branch L_h168
L_g168:
  v_cvt_pk_bf16_f32 v56, v56, v57
  v_cvt_pk_bf16_f32 v57, v58, v59
  s_mul_i32 s11, s32, 384
  v_add_u32 v1, s11, v7
  s_mov_b32 exec_hi, 0xffff
  ds_write_b64 v1, v[56:57] offset:40128
  s_mov_b32 exec_hi, -1
L_h168:
  s_waitcnt lgkmcnt(0)
  s_cmp_lg_u32 s95, 7
  s_cbranch_scc1 L_m168
  v_lshlrev_b32 v1, 4, v0
  ds_read_b128 v[64:67], v1 offset:40128
  ds_read_b128 v[68:71], v1 offset:41152
  ds_read_b128 v[72:75], v1 offset:42176
  s_lshl_b32 s11, s5, 3
  s_add_u32 s11, s11, s7
  s_mul_i32 s11, s11, 3072
  s_add_u32 s11, s11, 1310720
  s_waitcnt lgkmcnt(2)
  buffer_store_dwordx4 v[64:67], v1, s[64:67], s11 offen offset:0 sc1
  s_waitcnt lgkmcnt(1)
  buffer_store_dwordx4 v[68:71], v1, s[64:67], s11 offen offset:1024 sc1
  s_waitcnt lgkmcnt(0)
  buffer_store_dwordx4 v[72:75], v1, s[64:67], s11 offen offset:2048 sc1
L_m168:
  s_xor_b32 s101, s101, 16448
  s_add_u32 s95, s95, 1
  s_add_u32 s32, s32, 1
  s_and_b32 s32, s32, 7
L_loop:
  s_branch L_qc169
L_qp169:
  s_add_u32 s9, s9, 1
  s_cmp_gt_u32 s9, 100000
  s_cbranch_scc1 L_qk169
  buffer_load_dwordx4 v[156:159], v6, s[64:67], s78 offen offset:0 sc1
  buffer_load_dwordx4 v[160:163], v6, s[64:67], s78 offen offset:16 sc1
  buffer_load_dwordx4 v[164:167], v6, s[64:67], s78 offen offset:256 sc1
  buffer_load_dwordx4 v[168:171], v6, s[64:67], s78 offen offset:272 sc1
  buffer_load_dwordx4 v[172:175], v6, s[64:67], s78 offen offset:512 sc1
  buffer_load_dwordx4 v[176:179], v6, s[64:67], s78 offen offset:528 sc1
  s_waitcnt vmcnt(0)
L_qc169:
  v_xor_b32 v158, s92, v158
  v_xor_b32 v159, s93, v159
  v_xor_b32 v162, s92, v162
  v_xor_b32 v163, s93, v163
  v_xor_b32 v166, s92, v166
  v_xor_b32 v167, s93, v167
  v_xor_b32 v170, s92, v170
  v_xor_b32 v171, s93, v171
  v_xor_b32 v174, s92, v174
  v_xor_b32 v175, s93, v175
  v_xor_b32 v178, s92, v178
  v_xor_b32 v179, s93, v179
  v_or_b32 v4, v158, v159
  v_or3_b32 v4, v4, v162, v163
  v_or3_b32 v4, v4, v166, v167
  v_or3_b32 v4, v4, v170, v171
  v_or3_b32 v4, v4, v174, v175
  v_or3_b32 v4, v4, v178, v179
  v_cmp_ne_u32 vcc, 0, v4
  s_nop 1
  s_cbranch_vccnz L_qp169
L_qk169:
  v_mov_b32 v16, v156
  v_mov_b32 v17, v157
  v_mov_b32 v18, v160
  v_mov_b32 v19, v161
  v_mov_b32 v20, v164
  v_mov_b32 v21, v165
  v_mov_b32 v22, v168
  v_mov_b32 v23, v169
  v_mov_b32 v24, v172
  v_mov_b32 v25, v173
  v_mov_b32 v26, v176
  v_mov_b32 v27, v177
  s_mov_b32 vcc_lo, s22
  s_mov_b32 vcc_hi, 0
  s_waitcnt vmcnt(5)
  v_dot2_f32_bf16 v40, v104, v16, 0
  v_dot2_f32_bf16 v40, v105, v17, v40
  v_dot2_f32_bf16 v40, v106, v18, v40
  v_dot2_f32_bf16 v40, v107, v19, v40
  s_cbranch_vccnz L_ts170
L_th170:
  buffer_load_dwordx4 v[104:107], v5, s[44:47], s8 offen offset:0 nt
  s_waitcnt vmcnt(5)
  v_dot2_f32_bf16 v40, v108, v20, v40
  v_dot2_f32_bf16 v40, v109, v21, v40
  v_dot2_f32_bf16 v40, v110, v22, v40
  v_dot2_f32_bf16 v40, v111, v23, v40
  s_cbranch_vccnz L_ts171
L_th171:
  buffer_load_dwordx4 v[108:111], v5, s[44:47], s8 offen offset:128 nt
  s_waitcnt vmcnt(5)
  v_dot2_f32_bf16 v40, v112, v24, v40
  v_dot2_f32_bf16 v40, v113, v25, v40
  v_dot2_f32_bf16 v40, v114, v26, v40
  v_dot2_f32_bf16 v40, v115, v27, v40
  s_cbranch_vccnz L_ts172
L_th172:
  buffer_load_dwordx4 v[112:115], v5, s[44:47], s8 offen offset:256 nt
  s_add_u32 s8, s8, 12288
  s_cmp_ge_u32 s8, s27
  s_cselect_b32 s11, 1572864, 0
  s_sub_u32 s8, s8, s11
  s_nop 1
  v_add_f32_dpp v40, v40, v40 quad_perm:[1,0,3,2] row_mask:0xf bank_mask:0xf
  s_nop 1
  v_add_f32_dpp v40, v40, v40 quad_perm:[2,3,0,1] row_mask:0xf bank_mask:0xf
  s_nop 1
  v_add_f32_dpp v40, v40, v40 row_half_mirror row_mask:0xf bank_mask:0xf
  s_waitcnt vmcnt(5)
  v_dot2_f32_bf16 v41, v116, v16, 0
  v_dot2_f32_bf16 v41, v117, v17, v41
  v_dot2_f32_bf16 v41, v118, v18, v41
  v_dot2_f32_bf16 v41, v119, v19, v41
  s_cbranch_vccnz L_ts173
L_th173:
  buffer_load_dwordx4 v[116:119], v5, s[44:47], s8 offen offset:0 nt
  s_waitcnt vmcnt(5)
  v_dot2_f32_bf16 v41, v120, v20, v41
  v_dot2_f32_bf16 v41, v121, v21, v41
  v_dot2_f32_bf16 v41, v122, v22, v41
  v_dot2_f32_bf16 v41, v123, v23, v41
  s_cbranch_vccnz L_ts174
L_th174:
  buffer_load_dwordx4 v[120:123], v5, s[44:47], s8 offen offset:128 nt
  s_waitcnt vmcnt(5)
  v_dot2_f32_bf16 v41, v124, v24, v41
  v_dot2_f32_bf16 v41, v125, v25, v41
  v_dot2_f32_bf16 v41, v126, v26, v41
  v_dot2_f32_bf16 v41, v127, v27, v41
  s_cbranch_vccnz L_ts175
L_th175:
  buffer_load_dwordx4 v[124:127], v5, s[44:47], s8 offen offset:256 nt
  s_add_u32 s8, s8, 12288
  s_cmp_ge_u32 s8, s27
  s_cselect_b32 s11, 1572864, 0
  s_sub_u32 s8, s8, s11
  s_nop 1
  v_add_f32_dpp v41, v41, v41 quad_perm:[1,0,3,2] row_mask:0xf bank_mask:0xf
  s_nop 1
  v_add_f32_dpp v41, v41, v41 quad_perm:[2,3,0,1] row_mask:0xf bank_mask:0xf
  s_nop 1
  v_add_f32_dpp v41, v41, v41 row_half_mirror row_mask:0xf bank_mask:0xf
  s_waitcnt vmcnt(5)
  v_dot2_f32_bf16 v42, v104, v16, 0
  v_dot2_f32_bf16 v42, v105, v17, v42
  v_dot2_f32_bf16 v42, v106, v18, v42
  v_dot2_f32_bf16 v42, v107, v19, v42
  s_cbranch_vccnz L_ts176
L_th176:
  buffer_load_dwordx4 v[104:107], v5, s[44:47], s8 offen offset:0 nt
  s_waitcnt vmcnt(5)
  v_dot2_f32_bf16 v42, v108, v20, v42
  v_dot2_f32_bf16 v42, v109, v21, v42
  v_dot2_f32_bf16 v42, v110, v22, v42
  v_dot2_f32_bf16 v42, v111, v23, v42
  s_cbranch_vccnz L_ts177
L_th177:
  buffer_load_dwordx4 v[108:111], v5, s[44:47], s8 offen offset:128 nt
  s_waitcnt vmcnt(5)
  v_dot2_f32_bf16 v42, v112, v24, v42
  v_dot2_f32_bf16 v42, v113, v25, v42
  v_dot2_f32_bf16 v42, v114, v26, v42
  v_dot2_f32_bf16 v42, v115, v27, v42
  s_cbranch_vccnz L_ts178
L_th178:
  buffer_load_dwordx4 v[112:115], v5, s[44:47], s8 offen offset:256 nt
  s_add_u32 s8, s8, s17
  s_cmp_ge_u32 s8, s27
  s_cselect_b32 s11, 1572864, 0
  s_sub_u32 s8, s8, s11
  s_nop 1
  v_add_f32_dpp v42, v42, v42 quad_perm:[1,0,3,2] row_mask:0xf bank_mask:0xf
  s_nop 1
  v_add_f32_dpp v42, v42, v42 quad_perm:[2,3,0,1] row_mask:0xf bank_mask:0xf
  s_nop 1
  v_add_f32_dpp v42, v42, v42 row_half_mirror row_mask:0xf bank_mask:0xf
  s_waitcnt vmcnt(5)
  v_dot2_f32_bf16 v43, v116, v16, 0
  v_dot2_f32_bf16 v43, v117, v17, v43
  v_dot2_f32_bf16 v43, v118, v18, v43
  v_dot2_f32_bf16 v43, v119, v19, v43
  s_cbranch_vccnz L_ts179
L_th179:
  buffer_load_dwordx4 v[116:119], v5, s[44:47], s8 offen offset:0 nt
  s_waitcnt vmcnt(5)
  v_dot2_f32_bf16 v43, v120, v20, v43
  v_dot2_f32_bf16 v43, v121, v21, v43
  v_dot2_f32_bf16 v43, v122, v22, v43
  v_dot2_f32_bf16 v43, v123, v23, v43
  s_cbranch_vccnz L_ts180
L_th180:
  buffer_load_dwordx4 v[120:123], v5, s[44:47], s8 offen offset:128 nt
  s_waitcnt vmcnt(5)
  v_dot2_f32_bf16 v43, v124, v24, v43
  v_dot2_f32_bf16 v43, v125, v25, v43
  v_dot2_f32_bf16 v43, v126, v26, v43
  v_dot2_f32_bf16 v43, v127, v27, v43
  s_cbranch_vccnz L_ts181
L_th181:
  buffer_load_dwordx4 v[124:127], v5, s[44:47], s8 offen offset:256 nt
  s_add_u32 s8, s8, 12288
  s_cmp_ge_u32 s8, s27
  s_cselect_b32 s11, 1572864, 0
  s_sub_u32 s8, s8, s11
  s_nop 1
  v_add_f32_dpp v43, v43, v43 quad_perm:[1,0,3,2] row_mask:0xf bank_mask:0xf
  s_nop 1
  v_add_f32_dpp v43, v43, v43 quad_perm:[2,3,0,1] row_mask:0xf bank_mask:0xf
  s_nop 1
  v_add_f32_dpp v43, v43, v43 row_half_mirror row_mask:0xf bank_mask:0xf
  s_waitcnt vmcnt(5)
  v_dot2_f32_bf16 v44, v104, v16, 0
  v_dot2_f32_bf16 v44, v105, v17, v44
  v_dot2_f32_bf16 v44, v106, v18, v44
  v_dot2_f32_bf16 v44, v107, v19, v44
  s_cbranch_vccnz L_ts182
L_th182:
  buffer_load_dwordx4 v[104:107], v5, s[44:47], s8 offen offset:0 nt
  s_waitcnt vmcnt(5)
  v_dot2_f32_bf16 v44, v108, v20, v44
  v_dot2_f32_bf16 v44, v109, v21, v44
  v_dot2_f32_bf16 v44, v110, v22, v44
  v_dot2_f32_bf16 v44, v111, v23, v44
  s_cbranch_vccnz L_ts183
L_th183:
  buffer_load_dwordx4 v[108:111], v5, s[44:47], s8 offen offset:128 nt
  s_waitcnt vmcnt(5)
  v_dot2_f32_bf16 v44, v112, v24, v44
  v_dot2_f32_bf16 v44, v113, v25, v44
  v_dot2_f32_bf16 v44, v114, v26, v44
  v_dot2_f32_bf16 v44, v115, v27, v44
  s_cbranch_vccnz L_ts184
L_th184:
  buffer_load_dwordx4 v[112:115], v5, s[44:47], s8 offen offset:256 nt
  s_add_u32 s8, s8, 12288
  s_cmp_ge_u32 s8, s27
  s_cselect_b32 s11, 1572864, 0
  s_sub_u32 s8, s8, s11
  s_nop 1
  v_add_f32_dpp v44, v44, v44 quad_perm:[1,0,3,2] row_mask:0xf bank_mask:0xf
  s_nop 1
  v_add_f32_dpp v44, v44, v44 quad_perm:[2,3,0,1] row_mask:0xf bank_mask:0xf
  s_nop 1
  v_add_f32_dpp v44, v44, v44 row_half_mirror row_mask:0xf bank_mask:0xf
  s_waitcnt vmcnt(5)
  v_dot2_f32_bf16 v45, v116, v16, 0
  v_dot2_f32_bf16 v45, v117, v17, v45
  v_dot2_f32_bf16 v45, v118, v18, v45
  v_dot2_f32_bf16 v45, v119, v19, v45
  s_cbranch_vccnz L_ts185
L_th185:
  buffer_load_dwordx4 v[116:119], v5, s[44:47], s8 offen offset:0 nt
  s_waitcnt vmcnt(5)
  v_dot2_f32_bf16 v45, v120, v20, v45
  v_dot2_f32_bf16 v45, v121, v21, v45
  v_dot2_f32_bf16 v45, v122, v22, v45
  v_dot2_f32_bf16 v45, v123, v23, v45
  s_cbranch_vccnz L_ts186
L_th186:
  buffer_load_dwordx4 v[120:123], v5, s[44:47], s8 offen offset:128 nt
  s_waitcnt vmcnt(5)
  v_dot2_f32_bf16 v45, v124, v24, v45
  v_dot2_f32_bf16 v45, v125, v25, v45
  v_dot2_f32_bf16 v45, v126, v26, v45
  v_dot2_f32_bf16 v45, v127, v27, v45
  s_cbranch_vccnz L_ts187
L_th187:
  buffer_load_dwordx4 v[124:127], v5, s[44:47], s8 offen offset:256 nt
  s_add_u32 s8, s8, 12288
  s_cmp_ge_u32 s8, s27
  s_cselect_b32 s11, 1572864, 0
  s_sub_u32 s8, s8, s11
  s_nop 1
  v_add_f32_dpp v45, v45, v45 quad_perm:[1,0,3,2] row_mask:0xf bank_mask:0xf
  s_nop 1
  v_add_f32_dpp v45, v45, v45 quad_perm:[2,3,0,1] row_mask:0xf bank_mask:0xf
  s_nop 1
  v_add_f32_dpp v45, v45, v45 row_half_mirror row_mask:0xf bank_mask:0xf
  s_waitcnt vmcnt(5)
  v_dot2_f32_bf16 v46, v104, v16, 0
  v_dot2_f32_bf16 v46, v105, v17, v46
  v_dot2_f32_bf16 v46, v106, v18, v46
  v_dot2_f32_bf16 v46, v107, v19, v46
  s_cbranch_vccnz L_ts188
L_th188:
  buffer_load_dwordx4 v[104:107], v5, s[44:47], s8 offen offset:0 nt
  s_waitcnt vmcnt(5)
  v_dot2_f32_bf16 v46, v108, v20, v46
  v_dot2_f32_bf16 v46, v109, v21, v46
  v_dot2_f32_bf16 v46, v110, v22, v46
  v_dot2_f32_bf16 v46, v111, v23, v46
  s_cbranch_vccnz L_ts189
L_th189:
  buffer_load_dwordx4 v[108:111], v5, s[44:47], s8 offen offset:128 nt
  s_waitcnt vmcnt(5)
  v_dot2_f32_bf16 v46, v112, v24, v46
  v_dot2_f32_bf16 v46, v113, v25, v46
  v_dot2_f32_bf16 v46, v114, v26, v46
  v_dot2_f32_bf16 v46, v115, v27, v46
  s_cbranch_vccnz L_ts190
L_th190:
  buffer_load_dwordx4 v[112:115], v5, s[44:47], s8 offen offset:256 nt
  s_add_u32 s8, s8, 12288
  s_cmp_ge_u32 s8, s27
  s_cselect_b32 s11, 1572864, 0
  s_sub_u32 s8, s8, s11
  s_nop 1
  v_add_f32_dpp v46, v46, v46 quad_perm:[1,0,3,2] row_mask:0xf bank_mask:0xf
  s_nop 1
  v_add_f32_dpp v46, v46, v46 quad_perm:[2,3,0,1] row_mask:0xf bank_mask:0xf
  s_nop 1
  v_add_f32_dpp v46, v46, v46 row_half_mirror row_mask:0xf bank_mask:0xf
  s_waitcnt vmcnt(5)
  v_dot2_f32_bf16 v47, v116, v16, 0
  v_dot2_f32_bf16 v47, v117, v17, v47
  v_dot2_f32_bf16 v47, v118, v18, v47
  v_dot2_f32_bf16 v47, v119, v19, v47
  s_cbranch_vccnz L_ts191
L_th191:
  buffer_load_dwordx4 v[116:119], v5, s[44:47], s8 offen offset:0 nt
  s_waitcnt vmcnt(5)
  v_dot2_f32_bf16 v47, v120, v20, v47
  v_dot2_f32_bf16 v47, v121, v21, v47
  v_dot2_f32_bf16 v47, v122, v22, v47
  v_dot2_f32_bf16 v47, v123, v23, v47
  s_cbranch_vccnz L_ts192
L_th192:
  buffer_load_dwordx4 v[120:123], v5, s[44:47], s8 offen offset:128 nt
  s_waitcnt vmcnt(5)
  v_dot2_f32_bf16 v47, v124, v24, v47
  v_dot2_f32_bf16 v47, v125, v25, v47
  v_dot2_f32_bf16 v47, v126, v26, v47
  v_dot2_f32_bf16 v47, v127, v27, v47
  s_cbranch_vccnz L_ts193
L_th193:
  buffer_load_dwordx4 v[124:127], v5, s[44:47], s8 offen offset:256 nt
  s_add_u32 s8, s8, s17
  s_cmp_ge_u32 s8, s27
  s_cselect_b32 s11, 1572864, 0
  s_sub_u32 s8, s8, s11
  s_nop 1
  v_add_f32_dpp v47, v47, v47 quad_perm:[1,0,3,2] row_mask:0xf bank_mask:0xf
  s_nop 1
  v_add_f32_dpp v47, v47, v47 quad_perm:[2,3,0,1] row_mask:0xf bank_mask:0xf
  s_nop 1
  v_add_f32_dpp v47, v47, v47 row_half_mirror row_mask:0xf bank_mask:0xf
  s_waitcnt vmcnt(5)
  v_dot2_f32_bf16 v48, v104, v16, 0
  v_dot2_f32_bf16 v48, v105, v17, v48
  v_dot2_f32_bf16 v48, v106, v18, v48
  v_dot2_f32_bf16 v48, v107, v19, v48
  s_cbranch_vccnz L_ts194
L_th194:
  buffer_load_dwordx4 v[104:107], v5, s[44:47], s8 offen offset:0 nt
  s_waitcnt vmcnt(5)
  v_dot2_f32_bf16 v48, v108, v20, v48
  v_dot2_f32_bf16 v48, v109, v21, v48
  v_dot2_f32_bf16 v48, v110, v22, v48
  v_dot2_f32_bf16 v48, v111, v23, v48
  s_cbranch_vccnz L_ts195
L_th195:
  buffer_load_dwordx4 v[108:111], v5, s[44:47], s8 offen offset:128 nt
  s_waitcnt vmcnt(5)
  v_dot2_f32_bf16 v48, v112, v24, v48
  v_dot2_f32_bf16 v48, v113, v25, v48
  v_dot2_f32_bf16 v48, v114, v26, v48
  v_dot2_f32_bf16 v48, v115, v27, v48
  s_cbranch_vccnz L_ts196
L_th196:
  buffer_load_dwordx4 v[112:115], v5, s[44:47], s8 offen offset:256 nt
  s_add_u32 s8, s8, 12288
  s_cmp_ge_u32 s8, s27
  s_cselect_b32 s11, 1572864, 0
  s_sub_u32 s8, s8, s11
  s_nop 1
  v_add_f32_dpp v48, v48, v48 quad_perm:[1,0,3,2] row_mask:0xf bank_mask:0xf
  s_nop 1
  v_add_f32_dpp v48, v48, v48 quad_perm:[2,3,0,1] row_mask:0xf bank_mask:0xf
  s_nop 1
  v_add_f32_dpp v48, v48, v48 row_half_mirror row_mask:0xf bank_mask:0xf
  s_add_u32 s11, s95, 1
  s_and_b32 s11, s11, 3
  s_cmp_lg_u32 s11, s3
  s_cbranch_scc1 L_c197
  s_movk_i32 s11, 0x1fe
  s_bitcmp1_b32 s11, s95
  s_cbranch_scc0 L_c197
  s_mov_b64 exec, 255
  buffer_load_dwordx4 v[220:223], v55, s[64:67], 0 offen sc1
  s_mov_b64 exec, -1
L_c197:
  s_waitcnt vmcnt(5)
  v_dot2_f32_bf16 v49, v116, v16, 0
  v_dot2_f32_bf16 v49, v117, v17, v49
  v_dot2_f32_bf16 v49, v118, v18, v49
  v_dot2_f32_bf16 v49, v119, v19, v49
  s_cbranch_vccnz L_ts198
L_th198:
  buffer_load_dwordx4 v[116:119], v5, s[44:47], s8 offen offset:0 nt
  s_waitcnt vmcnt(5)
  v_dot2_f32_bf16 v49, v120, v20, v49
  v_dot2_f32_bf16 v49, v121, v21, v49
  v_dot2_f32_bf16 v49, v122, v22, v49
  v_dot2_f32_bf16 v49, v123, v23, v49
  s_cbranch_vccnz L_ts199
L_th199:
  buffer_load_dwordx4 v[120:123], v5, s[44:47], s8 offen offset:128 nt
  s_waitcnt vmcnt(5)
  v_dot2_f32_bf16 v49, v124, v24, v49
  v_dot2_f32_bf16 v49, v125, v25, v49
  v_dot2_f32_bf16 v49, v126, v26, v49
  v_dot2_f32_bf16 v49, v127, v27, v49
  s_cbranch_vccnz L_ts200
L_th200:
  buffer_load_dwordx4 v[124:127], v5, s[44:47], s8 offen offset:256 nt
  s_add_u32 s8, s8, 12288
  s_cmp_ge_u32 s8, s27
  s_cselect_b32 s11, 1572864, 0
  s_sub_u32 s8, s8, s11
  s_nop 1
  v_add_f32_dpp v49, v49, v49 quad_perm:[1,0,3,2] row_mask:0xf bank_mask:0xf
  s_nop 1
  v_add_f32_dpp v49, v49, v49 quad_perm:[2,3,0,1] row_mask:0xf bank_mask:0xf
  s_nop 1
  v_add_f32_dpp v49, v49, v49 row_half_mirror row_mask:0xf bank_mask:0xf
  s_waitcnt vmcnt(5)
  v_dot2_f32_bf16 v50, v104, v16, 0
  v_dot2_f32_bf16 v50, v105, v17, v50
  v_dot2_f32_bf16 v50, v106, v18, v50
  v_dot2_f32_bf16 v50, v107, v19, v50
  s_cbranch_vccnz L_ts201
L_th201:
  buffer_load_dwordx4 v[104:107], v5, s[44:47], s8 offen offset:0 nt
  s_waitcnt vmcnt(5)
  v_dot2_f32_bf16 v50, v108, v20, v50
  v_dot2_f32_bf16 v50, v109, v21, v50
  v_dot2_f32_bf16 v50, v110, v22, v50
  v_dot2_f32_bf16 v50, v111, v23, v50
  s_cbranch_vccnz L_ts202
L_th202:
  buffer_load_dwordx4 v[108:111], v5, s[44:47], s8 offen offset:128 nt
  s_waitcnt vmcnt(5)
  v_dot2_f32_bf16 v50, v112, v24, v50
  v_dot2_f32_bf16 v50, v113, v25, v50
  v_dot2_f32_bf16 v50, v114, v26, v50
  v_dot2_f32_bf16 v50, v115, v27, v50
  s_cbranch_vccnz L_ts203
L_th203:
  buffer_load_dwordx4 v[112:115], v5, s[44:47], s8 offen offset:256 nt
  s_add_u32 s8, s8, 12288
  s_cmp_ge_u32 s8, s27
  s_cselect_b32 s11, 1572864, 0
  s_sub_u32 s8, s8, s11
  s_nop 1
  v_add_f32_dpp v50, v50, v50 quad_perm:[1,0,3,2] row_mask:0xf bank_mask:0xf
  s_nop 1
  v_add_f32_dpp v50, v50, v50 quad_perm:[2,3,0,1] row_mask:0xf bank_mask:0xf
  s_nop 1
  v_add_f32_dpp v50, v50, v50 row_half_mirror row_mask:0xf bank_mask:0xf
  s_waitcnt vmcnt(5)
  v_dot2_f32_bf16 v51, v116, v16, 0
  v_dot2_f32_bf16 v51, v117, v17, v51
  v_dot2_f32_bf16 v51, v118, v18, v51
  v_dot2_f32_bf16 v51, v119, v19, v51
  s_cbranch_vccnz L_ts204
L_th204:
  buffer_load_dwordx4 v[116:119], v5, s[44:47], s8 offen offset:0 nt
  s_waitcnt vmcnt(5)
  v_dot2_f32_bf16 v51, v120, v20, v51
  v_dot2_f32_bf16 v51, v121, v21, v51
  v_dot2_f32_bf16 v51, v122, v22, v51
  v_dot2_f32_bf16 v51, v123, v23, v51
  s_cbranch_vccnz L_ts205
L_th205:
  buffer_load_dwordx4 v[120:123], v5, s[44:47], s8 offen offset:128 nt
  s_waitcnt vmcnt(5)
  v_dot2_f32_bf16 v51, v124, v24, v51
  v_dot2_f32_bf16 v51, v125, v25, v51
  v_dot2_f32_bf16 v51, v126, v26, v51
  v_dot2_f32_bf16 v51, v127, v27, v51
  s_cbranch_vccnz L_ts206
L_th206:
  buffer_load_dwordx4 v[124:127], v5, s[44:47], s8 offen offset:256 nt
  s_add_u32 s8, s8, 12288
  s_cmp_ge_u32 s8, s27
  s_cselect_b32 s11, 1572864, 0
  s_sub_u32 s8, s8, s11
  s_nop 1
  v_add_f32_dpp v51, v51, v51 quad_perm:[1,0,3,2] row_mask:0xf bank_mask:0xf
  s_nop 1
  v_add_f32_dpp v51, v51, v51 quad_perm:[2,3,0,1] row_mask:0xf bank_mask:0xf
  s_nop 1
  v_add_f32_dpp v51, v51, v51 row_half_mirror row_mask:0xf bank_mask:0xf
  s_waitcnt vmcnt(5)
  v_dot2_f32_bf16 v52, v104, v16, 0
  v_dot2_f32_bf16 v52, v105, v17, v52
  v_dot2_f32_bf16 v52, v106, v18, v52
  v_dot2_f32_bf16 v52, v107, v19, v52
  s_cbranch_vccnz L_ts207
L_th207:
  buffer_load_dwordx4 v[104:107], v5, s[44:47], s8 offen offset:0 nt
  s_waitcnt vmcnt(5)
  v_dot2_f32_bf16 v52, v108, v20, v52
  v_dot2_f32_bf16 v52, v109, v21, v52
  v_dot2_f32_bf16 v52, v110, v22, v52
  v_dot2_f32_bf16 v52, v111, v23, v52
  s_cbranch_vccnz L_ts208
L_th208:
  buffer_load_dwordx4 v[108:111], v5, s[44:47], s8 offen offset:128 nt
  s_waitcnt vmcnt(5)
  v_dot2_f32_bf16 v52, v112, v24, v52
  v_dot2_f32_bf16 v52, v113, v25, v52
  v_dot2_f32_bf16 v52, v114, v26, v52
  v_dot2_f32_bf16 v52, v115, v27, v52
  s_cbranch_vccnz L_ts209
L_th209:
  buffer_load_dwordx4 v[112:115], v5, s[44:47], s8 offen offset:256 nt
  s_add_u32 s8, s8, s17
  s_cmp_ge_u32 s8, s27
  s_cselect_b32 s11, 1572864, 0
  s_sub_u32 s8, s8, s11
  s_nop 1
  v_add_f32_dpp v52, v52, v52 quad_perm:[1,0,3,2] row_mask:0xf bank_mask:0xf
  s_nop 1
  v_add_f32_dpp v52, v52, v52 quad_perm:[2,3,0,1] row_mask:0xf bank_mask:0xf
  s_nop 1
  v_add_f32_dpp v52, v52, v52 row_half_mirror row_mask:0xf bank_mask:0xf
  s_add_u32 s11, s95, 1
  s_and_b32 s11, s11, 3
  s_cmp_lg_u32 s11, s3
  s_cbranch_scc1 L_c210
  s_movk_i32 s11, 0x1fe
  s_bitcmp1_b32 s11, s95
  s_cbranch_scc0 L_c210
  s_sub_u32 s12, s95, 1
  v_sub_u32 v220, s24, v220
  v_xor_b32 v221, s12, v221
  v_xor_b32 v222, s92, v222
  v_or_b32 v221, v221, v222
  v_cmp_eq_u32 vcc, 0, v221
  v_mov_b32 v222, -350
  s_nop 0
  v_cndmask_b32 v220, v222, v220, vcc
  s_nop 0
  v_readlane_b32 s14, v220, 0
  v_readlane_b32 s11, v220, 1
  s_nop 0
  s_add_i32 s14, s14, s11
  v_readlane_b32 s11, v220, 2
  s_nop 0
  s_add_i32 s14, s14, s11
  v_readlane_b32 s11, v220, 3
  s_nop 0
  s_add_i32 s14, s14, s11
  v_readlane_b32 s11, v220, 4
  s_nop 0
  s_add_i32 s14, s14, s11
  v_readlane_b32 s11, v220, 5
  s_nop 0
  s_add_i32 s14, s14, s11
  v_readlane_b32 s11, v220, 6
  s_nop 0
  s_add_i32 s14, s14, s11
  v_readlane_b32 s11, v220, 7
  s_nop 0
  s_add_i32 s14, s14, s11
  s_nop 0
  s_ashr_i32 s14, s14, 3
  s_sub_i32 s11, -160, s14
  s_mul_i32 s11, s11, 6
  s_ashr_i32 s11, s11, 8
  s_max_i32 s11, s11, 0
  s_min_i32 s11, s11, 4
  s_sub_i32 s14, 80, s14
  s_mul_i32 s14, s14, 14
  s_ashr_i32 s14, s14, 8
  s_max_i32 s14, s14, 0
  s_min_i32 s22, s14, 8
  s_add_u32 s22, s22, s11
  v_mov_b32 v1, 43328
  v_mov_b32 v4, s22
  ds_write_b32 v1, v4
  s_mov_b32 vcc_lo, s22
  s_mov_b32 vcc_hi, 0
L_c210:
  s_waitcnt vmcnt(5)
  v_dot2_f32_bf16 v53, v116, v16, 0
  v_dot2_f32_bf16 v53, v117, v17, v53
  v_dot2_f32_bf16 v53, v118, v18, v53
  v_dot2_f32_bf16 v53, v119, v19, v53
  s_cbranch_vccnz L_ts211
L_th211:
  s_mov_b32 s15, s43
  buffer_load_dwordx4 v[116:119], v5, s[48:51], s15 offen offset:0 nt
  s_waitcnt vmcnt(5)
  v_dot2_f32_bf16 v53, v120, v20, v53
  v_dot2_f32_bf16 v53, v121, v21, v53
  v_dot2_f32_bf16 v53, v122, v22, v53
  v_dot2_f32_bf16 v53, v123, v23, v53
  s_cbranch_vccnz L_ts212
L_th212:
  buffer_load_dwordx4 v[120:123], v5, s[48:51], s15 offen offset:128 nt
  s_waitcnt vmcnt(5)
  v_dot2_f32_bf16 v53, v124, v24, v53
  v_dot2_f32_bf16 v53, v125, v25, v53
  v_dot2_f32_bf16 v53, v126, v26, v53
  v_dot2_f32_bf16 v53, v127, v27, v53
  s_cbranch_vccnz L_ts213
L_th213:
  buffer_load_dwordx4 v[124:127], v5, s[48:51], s15 offen offset:256 nt
  s_add_u32 s15, s15, 12288
  s_cmp_ge_u32 s15, s27
  s_cselect_b32 s11, 1572864, 0
  s_sub_u32 s15, s15, s11
  s_nop 1
  v_add_f32_dpp v53, v53, v53 quad_perm:[1,0,3,2] row_mask:0xf bank_mask:0xf
  s_nop 1
  v_add_f32_dpp v53, v53, v53 quad_perm:[2,3,0,1] row_mask:0xf bank_mask:0xf
  s_nop 1
  v_add_f32_dpp v53, v53, v53 row_half_mirror row_mask:0xf bank_mask:0xf
  s_waitcnt vmcnt(5)
  v_dot2_f32_bf16 v54, v104, v16, 0
  v_dot2_f32_bf16 v54, v105, v17, v54
  v_dot2_f32_bf16 v54, v106, v18, v54
  v_dot2_f32_bf16 v54, v107, v19, v54
  s_cbranch_vccnz L_ts214
L_th214:
  buffer_load_dwordx4 v[104:107], v5, s[48:51], s15 offen offset:0 nt
  s_waitcnt vmcnt(5)
  v_dot2_f32_bf16 v54, v108, v20, v54
  v_dot2_f32_bf16 v54, v109, v21, v54
  v_dot2_f32_bf16 v54, v110, v22, v54
  v_dot2_f32_bf16 v54, v111, v23, v54
  s_cbranch_vccnz L_ts215
L_th215:
  buffer_load_dwordx4 v[108:111], v5, s[48:51], s15 offen offset:128 nt
  s_waitcnt vmcnt(5)
  v_dot2_f32_bf16 v54, v112, v24, v54
  v_dot2_f32_bf16 v54, v113, v25, v54
  v_dot2_f32_bf16 v54, v114, v26, v54
  v_dot2_f32_bf16 v54, v115, v27, v54
  s_cbranch_vccnz L_ts216
L_th216:
  buffer_load_dwordx4 v[112:115], v5, s[48:51], s15 offen offset:256 nt
  s_add_u32 s15, s15, 12288
  s_cmp_ge_u32 s15, s27
  s_cselect_b32 s11, 1572864, 0
  s_sub_u32 s15, s15, s11
  s_nop 1
  v_add_f32_dpp v54, v54, v54 quad_perm:[1,0,3,2] row_mask:0xf bank_mask:0xf
  s_nop 1
  v_add_f32_dpp v54, v54, v54 quad_perm:[2,3,0,1] row_mask:0xf bank_mask:0xf
  s_nop 1
  v_add_f32_dpp v54, v54, v54 row_half_mirror row_mask:0xf bank_mask:0xf
  v_mov_b32 v1, 43328
  ds_read_b32 v4, v1
  s_waitcnt lgkmcnt(0)
  v_readfirstlane_b32 s22, v4
  s_nop 1
  s_mov_b32 vcc_lo, s22
  s_mov_b32 vcc_hi, 0
  v_max3_f32 v1, v40, v41, v42
  v_max3_f32 v1, v1, v43, v44
  v_max3_f32 v1, v1, v45, v46
  v_max3_f32 v1, v1, v47, v48
  v_max3_f32 v1, v1, v49, v50
  v_max3_f32 v1, v1, v51, v52
  v_max3_f32 v1, v1, v53, v54
  s_nop 1
  v_max_f32_dpp v4, v1, v1 row_ror:8 row_mask:0xf bank_mask:0xf
  s_nop 0
  v_readlane_b32 s11, v4, 0
  v_readlane_b32 s12, v4, 16
  v_readlane_b32 s13, v4, 32
  v_readlane_b32 s14, v4, 48
  s_nop 0
  v_mov_b32 v9, s11
  v_max_f32 v9, s12, v9
  v_max_f32 v9, s13, v9
  v_max_f32 v9, s14, v9
  v_mul_f32 v10, s10, v9
  v_fma_f32 v40, v40, s10, -v10
  v_exp_f32 v40, v40
  s_nop 0
  v_cvt_pk_bf16_f32 v59, v40, v40
  v_mov_b32 v11, v40
  v_and_b32 v56, v59, v12
  v_and_b32 v57, v59, v13
  v_and_b32 v58, v59, v14
  v_and_b32 v59, v59, v15
  s_waitcnt vmcnt(5)
  s_nop 0
  v_mfma_f32_16x16x32_bf16 v[28:31], v[56:59], v[116:119], 0
  s_cbranch_vccnz L_ts217
L_th217:
  buffer_load_dwordx4 v[116:119], v5, s[48:51], s15 offen offset:0 nt
  s_waitcnt vmcnt(5)
  v_mfma_f32_16x16x32_bf16 v[32:35], v[56:59], v[120:123], 0
  s_cbranch_vccnz L_ts218
L_th218:
  buffer_load_dwordx4 v[120:123], v5, s[48:51], s15 offen offset:128 nt
  s_waitcnt vmcnt(5)
  v_mfma_f32_16x16x32_bf16 v[36:39], v[56:59], v[124:127], 0
  s_cbranch_vccnz L_ts219
L_th219:
  buffer_load_dwordx4 v[124:127], v5, s[48:51], s15 offen offset:256 nt
  s_add_u32 s15, s15, 12288
  s_cmp_ge_u32 s15, s27
  s_cselect_b32 s11, 1572864, 0
  s_sub_u32 s15, s15, s11
  v_fma_f32 v41, v41, s10, -v10
  v_exp_f32 v41, v41
  s_nop 0
  v_cvt_pk_bf16_f32 v63, v41, v41
  v_add_f32 v11, v11, v41
  v_and_b32 v60, v63, v12
  v_and_b32 v61, v63, v13
  v_and_b32 v62, v63, v14
  v_and_b32 v63, v63, v15
  s_waitcnt vmcnt(5)
  s_nop 0
  v_mfma_f32_16x16x32_bf16 v[28:31], v[60:63], v[104:107], v[28:31]
  s_cbranch_vccnz L_ts220
L_th220:
  buffer_load_dwordx4 v[104:107], v5, s[48:51], s15 offen offset:0 nt
  s_waitcnt vmcnt(5)
  v_mfma_f32_16x16x32_bf16 v[32:35], v[60:63], v[108:111], v[32:35]
  s_cbranch_vccnz L_ts221
L_th221:
  buffer_load_dwordx4 v[108:111], v5, s[48:51], s15 offen offset:128 nt
  s_waitcnt vmcnt(5)
  v_mfma_f32_16x16x32_bf16 v[36:39], v[60:63], v[112:115], v[36:39]
  s_cbranch_vccnz L_ts222
L_th222:
  buffer_load_dwordx4 v[112:115], v5, s[48:51], s15 offen offset:256 nt
  s_add_u32 s15, s15, 12288
  s_cmp_ge_u32 s15, s27
  s_cselect_b32 s11, 1572864, 0
  s_sub_u32 s15, s15, s11
  v_fma_f32 v42, v42, s10, -v10
  v_exp_f32 v42, v42
  s_nop 0
  v_cvt_pk_bf16_f32 v59, v42, v42
  v_add_f32 v11, v11, v42
  v_and_b32 v56, v59, v12
  v_and_b32 v57, v59, v13
  v_and_b32 v58, v59, v14
  v_and_b32 v59, v59, v15
  s_waitcnt vmcnt(5)
  s_nop 0
  v_mfma_f32_16x16x32_bf16 v[28:31], v[56:59], v[116:119], v[28:31]
  s_cbranch_vccnz L_ts223
L_th223:
  buffer_load_dwordx4 v[116:119], v5, s[48:51], s15 offen offset:0 nt
  s_waitcnt vmcnt(5)
  v_mfma_f32_16x16x32_bf16 v[32:35], v[56:59], v[120:123], v[32:35]
  s_cbranch_vccnz L_ts224
L_th224:
  buffer_load_dwordx4 v[120:123], v5, s[48:51], s15 offen offset:128 nt
  s_waitcnt vmcnt(5)
  v_mfma_f32_16x16x32_bf16 v[36:39], v[56:59], v[124:127], v[36:39]
  s_cbranch_vccnz L_ts225
L_th225:
  buffer_load_dwordx4 v[124:127], v5, s[48:51], s15 offen offset:256 nt
  s_add_u32 s15, s15, s17
  s_cmp_ge_u32 s15, s27
  s_cselect_b32 s11, 1572864, 0
  s_sub_u32 s15, s15, s11
  v_fma_f32 v43, v43, s10, -v10
  v_exp_f32 v43, v43
  s_nop 0
  v_cvt_pk_bf16_f32 v63, v43, v43
  v_add_f32 v11, v11, v43
  v_and_b32 v60, v63, v12
  v_and_b32 v61, v63, v13
  v_and_b32 v62, v63, v14
  v_and_b32 v63, v63, v15
  s_waitcnt vmcnt(5)
  s_nop 0
  v_mfma_f32_16x16x32_bf16 v[28:31], v[60:63], v[104:107], v[28:31]
  s_cbranch_vccnz L_ts226
L_th226:
  buffer_load_dwordx4 v[104:107], v5, s[48:51], s15 offen offset:0 nt
  s_waitcnt vmcnt(5)
  v_mfma_f32_16x16x32_bf16 v[32:35], v[60:63], v[108:111], v[32:35]
  s_cbranch_vccnz L_ts227
L_th227:
  buffer_load_dwordx4 v[108:111], v5, s[48:51], s15 offen offset:128 nt
  s_waitcnt vmcnt(5)
  v_mfma_f32_16x16x32_bf16 v[36:39], v[60:63], v[112:115], v[36:39]
  s_cbranch_vccnz L_ts228
L_th228:
  buffer_load_dwordx4 v[112:115], v5, s[48:51], s15 offen offset:256 nt
  s_add_u32 s15, s15, 12288
  s_cmp_ge_u32 s15, s27
  s_cselect_b32 s11, 1572864, 0
  s_sub_u32 s15, s15, s11
  v_fma_f32 v44, v44, s10, -v10
  v_exp_f32 v44, v44
  s_nop 0
  v_cvt_pk_bf16_f32 v59, v44, v44
  v_add_f32 v11, v11, v44
  v_and_b32 v56, v59, v12
  v_and_b32 v57, v59, v13
  v_and_b32 v58, v59, v14
  v_and_b32 v59, v59, v15
  s_waitcnt vmcnt(5)
  s_nop 0
  v_mfma_f32_16x16x32_bf16 v[28:31], v[56:59], v[116:119], v[28:31]
  s_cbranch_vccnz L_ts229
L_th229:
  buffer_load_dwordx4 v[116:119], v5, s[48:51], s15 offen offset:0 nt
  s_waitcnt vmcnt(5)
  v_mfma_f32_16x16x32_bf16 v[32:35], v[56:59], v[120:123], v[32:35]
  s_cbranch_vccnz L_ts230
L_th230:
  buffer_load_dwordx4 v[120:123], v5, s[48:51], s15 offen offset:128 nt
  s_waitcnt vmcnt(5)
  v_mfma_f32_16x16x32_bf16 v[36:39], v[56:59], v[124:127], v[36:39]
  s_cbranch_vccnz L_ts231
L_th231:
  buffer_load_dwordx4 v[124:127], v5, s[48:51], s15 offen offset:256 nt
  s_add_u32 s15, s15, 12288
  s_cmp_ge_u32 s15, s27
  s_cselect_b32 s11, 1572864, 0
  s_sub_u32 s15, s15, s11
  s_add_u32 s11, s32, 1
  s_and_b32 s11, s11, 7
  s_cmp_lt_u32 s95, 7
  s_cselect_b32 s11, s11, s7
  s_lshl_b32 s12, s5, 3
  s_add_u32 s11, s11, s12
  s_mul_i32 s11, s11, 768
  s_add_u32 s78, s11, 1048576
  buffer_load_dwordx4 v[156:159], v6, s[64:67], s78 offen offset:0 sc1
  buffer_load_dwordx4 v[160:163], v6, s[64:67], s78 offen offset:16 sc1
  buffer_load_dwordx4 v[164:167], v6, s[64:67], s78 offen offset:256 sc1
  buffer_load_dwordx4 v[168:171], v6, s[64:67], s78 offen offset:272 sc1
  buffer_load_dwordx4 v[172:175], v6, s[64:67], s78 offen offset:512 sc1
  buffer_load_dwordx4 v[176:179], v6, s[64:67], s78 offen offset:528 sc1
  v_fma_f32 v45, v45, s10, -v10
  v_exp_f32 v45, v45
  s_nop 0
  v_cvt_pk_bf16_f32 v63, v45, v45
  v_add_f32 v11, v11, v45
  v_and_b32 v60, v63, v12
  v_and_b32 v61, v63, v13
  v_and_b32 v62, v63, v14
  v_and_b32 v63, v63, v15
  s_waitcnt vmcnt(11)
  s_nop 0
  v_mfma_f32_16x16x32_bf16 v[28:31], v[60:63], v[104:107], v[28:31]
  s_cbranch_vccnz L_ts232
L_th232:
  buffer_load_dwordx4 v[104:107], v5, s[48:51], s15 offen offset:0 nt
  s_waitcnt vmcnt(11)
  v_mfma_f32_16x16x32_bf16 v[32:35], v[60:63], v[108:111], v[32:35]
  s_cbranch_vccnz L_ts233
L_th233:
  buffer_load_dwordx4 v[108:111], v5, s[48:51], s15 offen offset:128 nt
  s_waitcnt vmcnt(11)
  v_mfma_f32_16x16x32_bf16 v[36:39], v[60:63], v[112:115], v[36:39]
  s_cbranch_vccnz L_ts234
L_th234:
  buffer_load_dwordx4 v[112:115], v5, s[48:51], s15 offen offset:256 nt
  s_add_u32 s15, s15, 12288
  s_cmp_ge_u32 s15, s27
  s_cselect_b32 s11, 1572864, 0
  s_sub_u32 s15, s15, s11
  v_fma_f32 v46, v46, s10, -v10
  v_exp_f32 v46, v46
  s_nop 0
  v_cvt_pk_bf16_f32 v59, v46, v46
  v_add_f32 v11, v11, v46
  v_and_b32 v56, v59, v12
  v_and_b32 v57, v59, v13
  v_and_b32 v58, v59, v14
  v_and_b32 v59, v59, v15
  s_waitcnt vmcnt(11)
  s_nop 0
  v_mfma_f32_16x16x32_bf16 v[28:31], v[56:59], v[116:119], v[28:31]
  s_cbranch_vccnz L_ts235
L_th235:
  buffer_load_dwordx4 v[116:119], v5, s[48:51], s15 offen offset:0 nt
  s_waitcnt vmcnt(11)
  v_mfma_f32_16x16x32_bf16 v[32:35], v[56:59], v[120:123], v[32:35]
  s_cbranch_vccnz L_ts236
L_th236:
  buffer_load_dwordx4 v[120:123], v5, s[48:51], s15 offen offset:128 nt
  s_waitcnt vmcnt(11)
  v_mfma_f32_16x16x32_bf16 v[36:39], v[56:59], v[124:127], v[36:39]
  s_cbranch_vccnz L_ts237
L_th237:
  buffer_load_dwordx4 v[124:127], v5, s[48:51], s15 offen offset:256 nt
  s_add_u32 s15, s15, 12288
  s_cmp_ge_u32 s15, s27
  s_cselect_b32 s11, 1572864, 0
  s_sub_u32 s15, s15, s11
  v_fma_f32 v47, v47, s10, -v10
  v_exp_f32 v47, v47
  s_nop 0
  v_cvt_pk_bf16_f32 v63, v47, v47
  v_add_f32 v11, v11, v47
  v_and_b32 v60, v63, v12
  v_and_b32 v61, v63, v13
  v_and_b32 v62, v63, v14
  v_and_b32 v63, v63, v15
  s_waitcnt vmcnt(5)
  s_nop 0
  v_mfma_f32_16x16x32_bf16 v[28:31], v[60:63], v[104:107], v[28:31]
  s_cbranch_vccnz L_ts238
L_th238:
  buffer_load_dwordx4 v[104:107], v5, s[48:51], s15 offen offset:0 nt
  s_waitcnt vmcnt(5)
  v_mfma_f32_16x16x32_bf16 v[32:35], v[60:63], v[108:111], v[32:35]
  s_cbranch_vccnz L_ts239
L_th239:
  buffer_load_dwordx4 v[108:111], v5, s[48:51], s15 offen offset:128 nt
  s_waitcnt vmcnt(5)
  v_mfma_f32_16x16x32_bf16 v[36:39], v[60:63], v[112:115], v[36:39]
  s_cbranch_vccnz L_ts240
L_th240:
  buffer_load_dwordx4 v[112:115], v5, s[48:51], s15 offen offset:256 nt
  s_add_u32 s15, s15, s17
  s_cmp_ge_u32 s15, s27
  s_cselect_b32 s11, 1572864, 0
  s_sub_u32 s15, s15, s11
  v_fma_f32 v48, v48, s10, -v10
  v_exp_f32 v48, v48
  s_nop 0
  v_cvt_pk_bf16_f32 v59, v48, v48
  v_add_f32 v11, v11, v48
  v_and_b32 v56, v59, v12
  v_and_b32 v57, v59, v13
  v_and_b32 v58, v59, v14
  v_and_b32 v59, v59, v15
  s_waitcnt vmcnt(5)
  s_nop 0
  v_mfma_f32_16x16x32_bf16 v[28:31], v[56:59], v[116:119], v[28:31]
  s_cbranch_vccnz L_ts241
L_th241:
  buffer_load_dwordx4 v[116:119], v5, s[48:51], s15 offen offset:0 nt
  s_waitcnt vmcnt(5)
  v_mfma_f32_16x16x32_bf16 v[32:35], v[56:59], v[120:123], v[32:35]
  s_cbranch_vccnz L_ts242
L_th242:
  buffer_load_dwordx4 v[120:123], v5, s[48:51], s15 offen offset:128 nt
  s_waitcnt vmcnt(5)
  v_mfma_f32_16x16x32_bf16 v[36:39], v[56:59], v[124:127], v[36:39]
  s_cbranch_vccnz L_ts243
L_th243:
  buffer_load_dwordx4 v[124:127], v5, s[48:51], s15 offen offset:256 nt
  s_add_u32 s15, s15, 12288
  s_cmp_ge_u32 s15, s27
  s_cselect_b32 s11, 1572864, 0
  s_sub_u32 s15, s15, s11
  v_fma_f32 v49, v49, s10, -v10
  v_exp_f32 v49, v49
  s_nop 0
  v_cvt_pk_bf16_f32 v63, v49, v49
  v_add_f32 v11, v11, v49
  v_and_b32 v60, v63, v12
  v_and_b32 v61, v63, v13
  v_and_b32 v62, v63, v14
  v_and_b32 v63, v63, v15
  s_waitcnt vmcnt(5)
  s_nop 0
  v_mfma_f32_16x16x32_bf16 v[28:31], v[60:63], v[104:107], v[28:31]
  s_cbranch_vccnz L_ts244
L_th244:
  buffer_load_dwordx4 v[104:107], v5, s[48:51], s15 offen offset:0 nt
  s_waitcnt vmcnt(5)
  v_mfma_f32_16x16x32_bf16 v[32:35], v[60:63], v[108:111], v[32:35]
  s_cbranch_vccnz L_ts245
L_th245:
  buffer_load_dwordx4 v[108:111], v5, s[48:51], s15 offen offset:128 nt
  s_waitcnt vmcnt(5)
  v_mfma_f32_16x16x32_bf16 v[36:39], v[60:63], v[112:115], v[36:39]
  s_cbranch_vccnz L_ts246
L_th246:
  buffer_load_dwordx4 v[112:115], v5, s[48:51], s15 offen offset:256 nt
  s_add_u32 s15, s15, 12288
  s_cmp_ge_u32 s15, s27
  s_cselect_b32 s11, 1572864, 0
  s_sub_u32 s15, s15, s11
  v_fma_f32 v50, v50, s10, -v10
  v_exp_f32 v50, v50
  s_nop 0
  v_cvt_pk_bf16_f32 v59, v50, v50
  v_add_f32 v11, v11, v50
  v_and_b32 v56, v59, v12
  v_and_b32 v57, v59, v13
  v_and_b32 v58, v59, v14
  v_and_b32 v59, v59, v15
  s_waitcnt vmcnt(5)
  s_nop 0
  v_mfma_f32_16x16x32_bf16 v[28:31], v[56:59], v[116:119], v[28:31]
  s_cbranch_vccnz L_ts247
L_th247:
  buffer_load_dwordx4 v[116:119], v5, s[48:51], s15 offen offset:0 nt
  s_waitcnt vmcnt(5)
  v_mfma_f32_16x16x32_bf16 v[32:35], v[56:59], v[120:123], v[32:35]
  s_cbranch_vccnz L_ts248
L_th248:
  buffer_load_dwordx4 v[120:123], v5, s[48:51], s15 offen offset:128 nt
  s_waitcnt vmcnt(5)
  v_mfma_f32_16x16x32_bf16 v[36:39], v[56:59], v[124:127], v[36:39]
  s_cbranch_vccnz L_ts249
L_th249:
  buffer_load_dwordx4 v[124:127], v5, s[48:51], s15 offen offset:256 nt
  s_add_u32 s15, s15, 12288
  s_cmp_ge_u32 s15, s27
  s_cselect_b32 s11, 1572864, 0
  s_sub_u32 s15, s15, s11
  v_fma_f32 v51, v51, s10, -v10
  v_exp_f32 v51, v51
  s_nop 0
  v_cvt_pk_bf16_f32 v63, v51, v51
  v_add_f32 v11, v11, v51
  v_and_b32 v60, v63, v12
  v_and_b32 v61, v63, v13
  v_and_b32 v62, v63, v14
  v_and_b32 v63, v63, v15
  s_waitcnt vmcnt(5)
  s_nop 0
  v_mfma_f32_16x16x32_bf16 v[28:31], v[60:63], v[104:107], v[28:31]
  s_cbranch_vccnz L_ts250
L_th250:
  buffer_load_dwordx4 v[104:107], v5, s[48:51], s15 offen offset:0 nt
  s_waitcnt vmcnt(5)
  v_mfma_f32_16x16x32_bf16 v[32:35], v[60:63], v[108:111], v[32:35]
  s_cbranch_vccnz L_ts251
L_th251:
  buffer_load_dwordx4 v[108:111], v5, s[48:51], s15 offen offset:128 nt
  s_waitcnt vmcnt(5)
  v_mfma_f32_16x16x32_bf16 v[36:39], v[60:63], v[112:115], v[36:39]
  s_cbranch_vccnz L_ts252
L_th252:
  buffer_load_dwordx4 v[112:115], v5, s[48:51], s15 offen offset:256 nt
  s_add_u32 s15, s15, 12288
  s_cmp_ge_u32 s15, s27
  s_cselect_b32 s11, 1572864, 0
  s_sub_u32 s15, s15, s11
  v_fma_f32 v52, v52, s10, -v10
  v_exp_f32 v52, v52
  s_nop 0
  v_cvt_pk_bf16_f32 v59, v52, v52
  v_add_f32 v11, v11, v52
  v_and_b32 v56, v59, v12
  v_and_b32 v57, v59, v13
  v_and_b32 v58, v59, v14
  v_and_b32 v59, v59, v15
  s_waitcnt vmcnt(5)
  s_nop 0
  v_mfma_f32_16x16x32_bf16 v[28:31], v[56:59], v[116:119], v[28:31]
  s_cbranch_vccnz L_ts253
L_th253:
  buffer_load_dwordx4 v[116:119], v5, s[48:51], s15 offen offset:0 nt
  s_waitcnt vmcnt(5)
  v_mfma_f32_16x16x32_bf16 v[32:35], v[56:59], v[120:123], v[32:35]
  s_cbranch_vccnz L_ts254
L_th254:
  buffer_load_dwordx4 v[120:123], v5, s[48:51], s15 offen offset:128 nt
  s_waitcnt vmcnt(5)
  v_mfma_f32_16x16x32_bf16 v[36:39], v[56:59], v[124:127], v[36:39]
  s_cbranch_vccnz L_ts255
L_th255:
  buffer_load_dwordx4 v[124:127], v5, s[48:51], s15 offen offset:256 nt
  s_add_u32 s15, s15, s17
  s_cmp_ge_u32 s15, s27
  s_cselect_b32 s11, 1572864, 0
  s_sub_u32 s15, s15, s11
  v_fma_f32 v53, v53, s10, -v10
  v_exp_f32 v53, v53
  s_nop 0
  v_cvt_pk_bf16_f32 v63, v53, v53
  v_add_f32 v11, v11, v53
  v_and_b32 v60, v63, v12
  v_and_b32 v61, v63, v13
  v_and_b32 v62, v63, v14
  v_and_b32 v63, v63, v15
  s_waitcnt vmcnt(5)
  s_nop 0
  v_mfma_f32_16x16x32_bf16 v[28:31], v[60:63], v[104:107], v[28:31]
  s_cbranch_vccnz L_ts256
L_th256:
  s_add_u32 s11, s94, s33
  s_and_b32 s11, s11, 7
  s_cmp_lt_u32 s94, 8
  s_cselect_b32 s11, s11, s7
  s_cselect_b32 s12, s16, s26
  s_cselect_b32 s17, 36, 1
  s_mul_i32 s17, s17, 12288
  s_cselect_b32 s27, 0, -1
  s_and_b32 s13, s11, 3
  s_lshl_b32 s13, s13, 5
  s_add_u32 s13, s13, s5
  s_mul_i32 s13, s13, 1572864
  s_mul_i32 s43, s3, 3072
  s_add_u32 s13, s13, s43
  s_add_u32 s43, s13, s12
  s_add_u32 s13, s13, 1572864
  s_or_b32 s27, s27, s13
  s_cmp_ge_u32 s11, 4
  s_cselect_b32 s44, s28, s18
  s_cselect_b32 s45, s29, s19
  s_cselect_b32 s48, s30, s20
  s_cselect_b32 s49, s31, s21
  s_mov_b32 s8, s43
  s_add_u32 s94, s94, 1
  buffer_load_dwordx4 v[104:107], v5, s[44:47], s8 offen offset:0 nt
  s_waitcnt vmcnt(5)
  v_mfma_f32_16x16x32_bf16 v[32:35], v[60:63], v[108:111], v[32:35]
  s_cbranch_vccnz L_ts258
L_th258:
  buffer_load_dwordx4 v[108:111], v5, s[44:47], s8 offen offset:128 nt
  s_waitcnt vmcnt(5)
  v_mfma_f32_16x16x32_bf16 v[36:39], v[60:63], v[112:115], v[36:39]
  s_cbranch_vccnz L_ts259
L_th259:
  buffer_load_dwordx4 v[112:115], v5, s[44:47], s8 offen offset:256 nt
  s_add_u32 s8, s8, 12288
  s_cmp_ge_u32 s8, s27
  s_cselect_b32 s11, 1572864, 0
  s_sub_u32 s8, s8, s11
  v_fma_f32 v54, v54, s10, -v10
  v_exp_f32 v54, v54
  s_nop 0
  v_cvt_pk_bf16_f32 v59, v54, v54
  v_add_f32 v11, v11, v54
  v_and_b32 v56, v59, v12
  v_and_b32 v57, v59, v13
  v_and_b32 v58, v59, v14
  v_and_b32 v59, v59, v15
  s_waitcnt vmcnt(5)
  s_nop 0
  v_mfma_f32_16x16x32_bf16 v[28:31], v[56:59], v[116:119], v[28:31]
  s_cbranch_vccnz L_ts260
L_th260:
  buffer_load_dwordx4 v[116:119], v5, s[44:47], s8 offen offset:0 nt
  s_waitcnt vmcnt(5)
  v_mfma_f32_16x16x32_bf16 v[32:35], v[56:59], v[120:123], v[32:35]
  s_cbranch_vccnz L_ts261
L_th261:
  buffer_load_dwordx4 v[120:123], v5, s[44:47], s8 offen offset:128 nt
  s_waitcnt vmcnt(5)
  v_mfma_f32_16x16x32_bf16 v[36:39], v[56:59], v[124:127], v[36:39]
  s_cbranch_vccnz L_ts262
L_th262:
  buffer_load_dwordx4 v[124:127], v5, s[44:47], s8 offen offset:256 nt
  s_add_u32 s8, s8, 12288
  s_cmp_ge_u32 s8, s27
  s_cselect_b32 s11, 1572864, 0
  s_sub_u32 s8, s8, s11
  v_add_f32_dpp v11, v11, v11 row_ror:8 row_mask:0xf bank_mask:0xf
  v_add_u32 v1, s101, v97
  v_readlane_b32 s11, v11, 0
  v_readlane_b32 s12, v11, 16
  v_readlane_b32 s13, v11, 32
  v_readlane_b32 s14, v11, 48
  s_nop 1
  ds_write_b128 v1, v[28:31] offset:0
  ds_write_b128 v1, v[32:35] offset:1024
  ds_write_b128 v1, v[36:39] offset:2048
  v_mov_b32 v10, s11
  v_add_f32 v10, s12, v10
  v_add_f32 v10, s13, v10
  v_add_f32 v10, s14, v10
  s_lshl_b32 s11, s3, 3
  s_add_u32 s11, s11, s101
  v_mov_b32 v1, s11
  v_mov_b32 v180, v9
  v_mov_b32 v181, v10
  ds_write_b64 v1, v[180:181] offset:16384
  s_waitcnt lgkmcnt(0)
  s_barrier
  s_add_u32 s11, s95, 2
  s_and_b32 s11, s11, 3
  s_cmp_lg_u32 s11, s3
  s_cbranch_scc1 L_p263
  s_movk_i32 s11, 0xff
  s_bitcmp1_b32 s11, s95
  s_cbranch_scc0 L_p263
  s_memrealtime s[24:25]
  v_mov_b32 v217, s95
  v_mov_b32 v218, s92
  v_mov_b32 v219, s93
  s_lshl_b32 s11, s2, 7
  s_add_u32 s11, s11, 2162688
  v_lshlrev_b32 v4, 4, v0
  s_waitcnt lgkmcnt(0)
  s_and_b32 s12, s2, 56
  s_cbranch_scc1 L_p263
  v_mov_b32 v216, s24
  s_mov_b64 exec, 0xff
  buffer_store_dwordx4 v[216:219], v4, s[64:67], s11 offen sc1
  s_mov_b64 exec, -1
L_p263:
  s_and_b32 s11, s95, 3
  s_cmp_lg_u32 s11, s3
  s_cbranch_scc1 L_m264
  v_mov_b32 v1, s101
  v_add_u32 v4, s101, v96
  ds_read_b128 v[180:183], v1 offset:16384
  ds_read_b128 v[184:187], v1 offset:16400
  ds_read_b128 v[64:67], v4 offset:0
  ds_read_b128 v[68:71], v4 offset:640
  ds_read_b128 v[72:75], v4 offset:4096
  ds_read_b128 v[76:79], v4 offset:4736
  ds_read_b128 v[80:83], v4 offset:8192
  ds_read_b128 v[84:87], v4 offset:8832
  ds_read_b128 v[88:91], v4 offset:12288
  ds_read_b128 v[92:95], v4 offset:12928
  s_waitcnt lgkmcnt(8)
  v_max3_f32 v100, v180, v182, v184
  v_max_f32 v100, v100, v186
  v_sub_f32 v40, v180, v100
  v_sub_f32 v41, v182, v100
  v_sub_f32 v42, v184, v100
  v_sub_f32 v43, v186, v100
  v_mul_f32 v40, s10, v40
  v_mul_f32 v41, s10, v41
  v_mul_f32 v42, s10, v42
  v_mul_f32 v43, s10, v43
  v_exp_f32 v40, v40
  v_exp_f32 v41, v41
  v_exp_f32 v42, v42
  v_exp_f32 v43, v43
  s_nop 0
  v_mul_f32 v101, v40, v181
  v_fmac_f32 v101, v41, v183
  v_fmac_f32 v101, v42, v185
  v_fmac_f32 v101, v43, v187
  s_waitcnt lgkmcnt(6)
  v_add_f32 v64, v64, v68
  v_add_f32 v65, v65, v69
  v_add_f32 v66, v66, v70
  v_add_f32 v67, v67, v71
  v_mul_f32 v56, v40, v64
  v_mul_f32 v57, v40, v65
  v_mul_f32 v58, v40, v66
  v_mul_f32 v59, v40, v67
  s_waitcnt lgkmcnt(4)
  v_add_f32 v72, v72, v76
  v_add_f32 v73, v73, v77
  v_add_f32 v74, v74, v78
  v_add_f32 v75, v75, v79
  v_fmac_f32 v56, v41, v72
  v_fmac_f32 v57, v41, v73
  v_fmac_f32 v58, v41, v74
  v_fmac_f32 v59, v41, v75
  s_waitcnt lgkmcnt(2)
  v_add_f32 v80, v80, v84
  v_add_f32 v81, v81, v85
  v_add_f32 v82, v82, v86
  v_add_f32 v83, v83, v87
  v_fmac_f32 v56, v42, v80
  v_fmac_f32 v57, v42, v81
  v_fmac_f32 v58, v42, v82
  v_fmac_f32 v59, v42, v83
  s_waitcnt lgkmcnt(0)
  v_add_f32 v88, v88, v92
  v_add_f32 v89, v89, v93
  v_add_f32 v90, v90, v94
  v_add_f32 v91, v91, v95
  v_fmac_f32 v56, v43, v88
  v_fmac_f32 v57, v43, v89
  v_fmac_f32 v58, v43, v90
  v_fmac_f32 v59, v43, v91
  s_lshl_b32 s11, s32, 3
  s_add_u32 s11, s11, 39040
  v_mov_b32 v1, s11
  ds_write_b64 v1, v[100:101]
  s_cmp_lg_u32 s32, s7
  s_cbranch_scc1 L_g264
  v_lshlrev_b32 v1, 4, v0
  ds_write_b128 v1, v[56:59] offset:39104
  s_branch L_h264
L_g264:
  v_cvt_pk_bf16_f32 v56, v56, v57
  v_cvt_pk_bf16_f32 v57, v58, v59
  s_mul_i32 s11, s32, 384
  v_add_u32 v1, s11, v7
  s_mov_b32 exec_hi, 0xffff
  ds_write_b64 v1, v[56:57] offset:40128
  s_mov_b32 exec_hi, -1
L_h264:
  s_waitcnt lgkmcnt(0)
  s_cmp_lg_u32 s95, 7
  s_cbranch_scc1 L_m264
  v_lshlrev_b32 v1, 4, v0
  ds_read_b128 v[64:67], v1 offset:40128
  ds_read_b128 v[68:71], v1 offset:41152
  ds_read_b128 v[72:75], v1 offset:42176
  s_lshl_b32 s11, s5, 3
  s_add_u32 s11, s11, s7
  s_mul_i32 s11, s11, 3072
  s_add_u32 s11, s11, 1310720
  s_waitcnt lgkmcnt(2)
  buffer_store_dwordx4 v[64:67], v1, s[64:67], s11 offen offset:0 sc1
  s_waitcnt lgkmcnt(1)
  buffer_store_dwordx4 v[68:71], v1, s[64:67], s11 offen offset:1024 sc1
  s_waitcnt lgkmcnt(0)
  buffer_store_dwordx4 v[72:75], v1, s[64:67], s11 offen offset:2048 sc1
L_m264:
  s_xor_b32 s101, s101, 16448
  s_add_u32 s95, s95, 1
  s_add_u32 s32, s32, 1
  s_and_b32 s32, s32, 7
  s_cmp_lt_u32 s95, 8
  s_cbranch_scc1 L_loop
  s_branch L_qc265
L_qp265:
  s_add_u32 s9, s9, 1
  s_cmp_gt_u32 s9, 100000
  s_cbranch_scc1 L_qk265
  buffer_load_dwordx4 v[156:159], v6, s[64:67], s78 offen offset:0 sc1
  buffer_load_dwordx4 v[160:163], v6, s[64:67], s78 offen offset:16 sc1
  buffer_load_dwordx4 v[164:167], v6, s[64:67], s78 offen offset:256 sc1
  buffer_load_dwordx4 v[168:171], v6, s[64:67], s78 offen offset:272 sc1
  buffer_load_dwordx4 v[172:175], v6, s[64:67], s78 offen offset:512 sc1
  buffer_load_dwordx4 v[176:179], v6, s[64:67], s78 offen offset:528 sc1
  s_waitcnt vmcnt(0)
L_qc265:
  v_xor_b32 v158, s92, v158
  v_xor_b32 v159, s93, v159
  v_xor_b32 v162, s92, v162
  v_xor_b32 v163, s93, v163
  v_xor_b32 v166, s92, v166
  v_xor_b32 v167, s93, v167
  v_xor_b32 v170, s92, v170
  v_xor_b32 v171, s93, v171
  v_xor_b32 v174, s92, v174
  v_xor_b32 v175, s93, v175
  v_xor_b32 v178, s92, v178
  v_xor_b32 v179, s93, v179
  v_or_b32 v4, v158, v159
  v_or3_b32 v4, v4, v162, v163
  v_or3_b32 v4, v4, v166, v167
  v_or3_b32 v4, v4, v170, v171
  v_or3_b32 v4, v4, v174, v175
  v_or3_b32 v4, v4, v178, v179
  v_cmp_ne_u32 vcc, 0, v4
  s_nop 1
  s_cbranch_vccnz L_qp265
L_qk265:
  v_mov_b32 v16, v156
  v_mov_b32 v17, v157
  v_mov_b32 v18, v160
  v_mov_b32 v19, v161
  v_mov_b32 v20, v164
  v_mov_b32 v21, v165
  v_mov_b32 v22, v168
  v_mov_b32 v23, v169
  v_mov_b32 v24, v172
  v_mov_b32 v25, v173
  v_mov_b32 v26, v176
  v_mov_b32 v27, v177
  s_mov_b32 vcc_lo, s22
  s_mov_b32 vcc_hi, 0
  s_waitcnt vmcnt(5)
  v_dot2_f32_bf16 v40, v104, v16, 0
  v_dot2_f32_bf16 v40, v105, v17, v40
  v_dot2_f32_bf16 v40, v106, v18, v40
  v_dot2_f32_bf16 v40, v107, v19, v40
  s_cbranch_vccnz L_ts266
L_th266:
  buffer_load_dwordx4 v[104:107], v5, s[44:47], s8 offen offset:0 nt
  s_waitcnt vmcnt(5)
  v_dot2_f32_bf16 v40, v108, v20, v40
  v_dot2_f32_bf16 v40, v109, v21, v40
  v_dot2_f32_bf16 v40, v110, v22, v40
  v_dot2_f32_bf16 v40, v111, v23, v40
  s_cbranch_vccnz L_ts267
L_th267:
  buffer_load_dwordx4 v[108:111], v5, s[44:47], s8 offen offset:128 nt
  s_waitcnt vmcnt(5)
  v_dot2_f32_bf16 v40, v112, v24, v40
  v_dot2_f32_bf16 v40, v113, v25, v40
  v_dot2_f32_bf16 v40, v114, v26, v40
  v_dot2_f32_bf16 v40, v115, v27, v40
  s_cbranch_vccnz L_ts268
L_th268:
  buffer_load_dwordx4 v[112:115], v5, s[44:47], s8 offen offset:256 nt
  s_add_u32 s8, s8, 12288
  s_cmp_ge_u32 s8, s27
  s_cselect_b32 s11, 1572864, 0
  s_sub_u32 s8, s8, s11
  s_nop 1
  v_add_f32_dpp v40, v40, v40 quad_perm:[1,0,3,2] row_mask:0xf bank_mask:0xf
  s_nop 1
  v_add_f32_dpp v40, v40, v40 quad_perm:[2,3,0,1] row_mask:0xf bank_mask:0xf
  s_nop 1
  v_add_f32_dpp v40, v40, v40 row_half_mirror row_mask:0xf bank_mask:0xf
  s_waitcnt vmcnt(5)
  v_dot2_f32_bf16 v41, v116, v16, 0
  v_dot2_f32_bf16 v41, v117, v17, v41
  v_dot2_f32_bf16 v41, v118, v18, v41
  v_dot2_f32_bf16 v41, v119, v19, v41
  s_cbranch_vccnz L_ts269
L_th269:
  buffer_load_dwordx4 v[116:119], v5, s[44:47], s8 offen offset:0 nt
  s_waitcnt vmcnt(5)
  v_dot2_f32_bf16 v41, v120, v20, v41
  v_dot2_f32_bf16 v41, v121, v21, v41
  v_dot2_f32_bf16 v41, v122, v22, v41
  v_dot2_f32_bf16 v41, v123, v23, v41
  s_cbranch_vccnz L_ts270
L_th270:
  buffer_load_dwordx4 v[120:123], v5, s[44:47], s8 offen offset:128 nt
  s_waitcnt vmcnt(5)
  v_dot2_f32_bf16 v41, v124, v24, v41
  v_dot2_f32_bf16 v41, v125, v25, v41
  v_dot2_f32_bf16 v41, v126, v26, v41
  v_dot2_f32_bf16 v41, v127, v27, v41
  s_cbranch_vccnz L_ts271
L_th271:
  buffer_load_dwordx4 v[124:127], v5, s[44:47], s8 offen offset:256 nt
  s_add_u32 s8, s8, 12288
  s_cmp_ge_u32 s8, s27
  s_cselect_b32 s11, 1572864, 0
  s_sub_u32 s8, s8, s11
  s_nop 1
  v_add_f32_dpp v41, v41, v41 quad_perm:[1,0,3,2] row_mask:0xf bank_mask:0xf
  s_nop 1
  v_add_f32_dpp v41, v41, v41 quad_perm:[2,3,0,1] row_mask:0xf bank_mask:0xf
  s_nop 1
  v_add_f32_dpp v41, v41, v41 row_half_mirror row_mask:0xf bank_mask:0xf
  s_waitcnt vmcnt(5)
  v_dot2_f32_bf16 v42, v104, v16, 0
  v_dot2_f32_bf16 v42, v105, v17, v42
  v_dot2_f32_bf16 v42, v106, v18, v42
  v_dot2_f32_bf16 v42, v107, v19, v42
  s_cbranch_vccnz L_ts272
L_th272:
  buffer_load_dwordx4 v[104:107], v5, s[44:47], s8 offen offset:0 nt
  s_waitcnt vmcnt(5)
  v_dot2_f32_bf16 v42, v108, v20, v42
  v_dot2_f32_bf16 v42, v109, v21, v42
  v_dot2_f32_bf16 v42, v110, v22, v42
  v_dot2_f32_bf16 v42, v111, v23, v42
  s_cbranch_vccnz L_ts273
L_th273:
  buffer_load_dwordx4 v[108:111], v5, s[44:47], s8 offen offset:128 nt
  s_waitcnt vmcnt(5)
  v_dot2_f32_bf16 v42, v112, v24, v42
  v_dot2_f32_bf16 v42, v113, v25, v42
  v_dot2_f32_bf16 v42, v114, v26, v42
  v_dot2_f32_bf16 v42, v115, v27, v42
  s_cbranch_vccnz L_ts274
L_th274:
  buffer_load_dwordx4 v[112:115], v5, s[44:47], s8 offen offset:256 nt
  s_add_u32 s8, s8, s17
  s_cmp_ge_u32 s8, s27
  s_cselect_b32 s11, 1572864, 0
  s_sub_u32 s8, s8, s11
  s_nop 1
  v_add_f32_dpp v42, v42, v42 quad_perm:[1,0,3,2] row_mask:0xf bank_mask:0xf
  s_nop 1
  v_add_f32_dpp v42, v42, v42 quad_perm:[2,3,0,1] row_mask:0xf bank_mask:0xf
  s_nop 1
  v_add_f32_dpp v42, v42, v42 row_half_mirror row_mask:0xf bank_mask:0xf
  s_add_u32 s11, s95, 1
  s_and_b32 s11, s11, 3
  s_cmp_lg_u32 s11, s3
  s_cbranch_scc1 L_c275
  s_movk_i32 s11, 0x1fe
  s_bitcmp1_b32 s11, s95
  s_cbranch_scc0 L_c275
  s_mov_b64 exec, 255
  buffer_load_dwordx4 v[220:223], v55, s[64:67], 0 offen sc1
  s_mov_b64 exec, -1
L_c275:
  s_waitcnt vmcnt(5)
  v_dot2_f32_bf16 v43, v116, v16, 0
  v_dot2_f32_bf16 v43, v117, v17, v43
  v_dot2_f32_bf16 v43, v118, v18, v43
  v_dot2_f32_bf16 v43, v119, v19, v43
  s_cbranch_vccnz L_ts276
L_th276:
  buffer_load_dwordx4 v[116:119], v5, s[44:47], s8 offen offset:0 nt
  s_waitcnt vmcnt(5)
  v_dot2_f32_bf16 v43, v120, v20, v43
  v_dot2_f32_bf16 v43, v121, v21, v43
  v_dot2_f32_bf16 v43, v122, v22, v43
  v_dot2_f32_bf16 v43, v123, v23, v43
  s_cbranch_vccnz L_ts277
L_th277:
  buffer_load_dwordx4 v[120:123], v5, s[44:47], s8 offen offset:128 nt
  s_waitcnt vmcnt(5)
  v_dot2_f32_bf16 v43, v124, v24, v43
  v_dot2_f32_bf16 v43, v125, v25, v43
  v_dot2_f32_bf16 v43, v126, v26, v43
  v_dot2_f32_bf16 v43, v127, v27, v43
  s_cbranch_vccnz L_ts278
L_th278:
  buffer_load_dwordx4 v[124:127], v5, s[44:47], s8 offen offset:256 nt
  s_add_u32 s8, s8, 12288
  s_cmp_ge_u32 s8, s27
  s_cselect_b32 s11, 1572864, 0
  s_sub_u32 s8, s8, s11
  s_nop 1
  v_add_f32_dpp v43, v43, v43 quad_perm:[1,0,3,2] row_mask:0xf bank_mask:0xf
  s_nop 1
  v_add_f32_dpp v43, v43, v43 quad_perm:[2,3,0,1] row_mask:0xf bank_mask:0xf
  s_nop 1
  v_add_f32_dpp v43, v43, v43 row_half_mirror row_mask:0xf bank_mask:0xf
  s_cmp_lg_u32 s3, 3
  s_cbranch_scc1 L_f279
  v_add_u32 v1, 39040, v7
  ds_read_b64 v[100:101], v1
  s_lshl_b32 s11, s5, 3
  s_add_u32 s11, s11, s7
  s_lshl_b32 s11, s11, 7
  s_add_u32 s11, s11, 2097152
  v_lshlrev_b32 v4, 4, v0
  s_mov_b64 exec, 0xff
  s_waitcnt lgkmcnt(0)
  buffer_store_dwordx4 v[100:103], v4, s[64:67], s11 offen sc1
  s_mov_b64 exec, -1
L_f279:
  s_waitcnt vmcnt(5)
  v_dot2_f32_bf16 v44, v104, v16, 0
  v_dot2_f32_bf16 v44, v105, v17, v44
  v_dot2_f32_bf16 v44, v106, v18, v44
  v_dot2_f32_bf16 v44, v107, v19, v44
  s_cbranch_vccnz L_ts280
L_th280:
  buffer_load_dwordx4 v[104:107], v5, s[44:47], s8 offen offset:0 nt
  s_waitcnt vmcnt(5)
  v_dot2_f32_bf16 v44, v108, v20, v44
  v_dot2_f32_bf16 v44, v109, v21, v44
  v_dot2_f32_bf16 v44, v110, v22, v44
  v_dot2_f32_bf16 v44, v111, v23, v44
  s_cbranch_vccnz L_ts281
L_th281:
  buffer_load_dwordx4 v[108:111], v5, s[44:47], s8 offen offset:128 nt
  s_waitcnt vmcnt(5)
  v_dot2_f32_bf16 v44, v112, v24, v44
  v_dot2_f32_bf16 v44, v113, v25, v44
  v_dot2_f32_bf16 v44, v114, v26, v44
  v_dot2_f32_bf16 v44, v115, v27, v44
  s_cbranch_vccnz L_ts282
L_th282:
  buffer_load_dwordx4 v[112:115], v5, s[44:47], s8 offen offset:256 nt
  s_add_u32 s8, s8, 12288
  s_cmp_ge_u32 s8, s27
  s_cselect_b32 s11, 1572864, 0
  s_sub_u32 s8, s8, s11
  s_nop 1
  v_add_f32_dpp v44, v44, v44 quad_perm:[1,0,3,2] row_mask:0xf bank_mask:0xf
  s_nop 1
  v_add_f32_dpp v44, v44, v44 quad_perm:[2,3,0,1] row_mask:0xf bank_mask:0xf
  s_nop 1
  v_add_f32_dpp v44, v44, v44 row_half_mirror row_mask:0xf bank_mask:0xf
  s_waitcnt vmcnt(5)
  v_dot2_f32_bf16 v45, v116, v16, 0
  v_dot2_f32_bf16 v45, v117, v17, v45
  v_dot2_f32_bf16 v45, v118, v18, v45
  v_dot2_f32_bf16 v45, v119, v19, v45
  s_cbranch_vccnz L_ts283
L_th283:
  buffer_load_dwordx4 v[116:119], v5, s[44:47], s8 offen offset:0 nt
  s_waitcnt vmcnt(5)
  v_dot2_f32_bf16 v45, v120, v20, v45
  v_dot2_f32_bf16 v45, v121, v21, v45
  v_dot2_f32_bf16 v45, v122, v22, v45
  v_dot2_f32_bf16 v45, v123, v23, v45
  s_cbranch_vccnz L_ts284
L_th284:
  buffer_load_dwordx4 v[120:123], v5, s[44:47], s8 offen offset:128 nt
  s_waitcnt vmcnt(5)
  v_dot2_f32_bf16 v45, v124, v24, v45
  v_dot2_f32_bf16 v45, v125, v25, v45
  v_dot2_f32_bf16 v45, v126, v26, v45
  v_dot2_f32_bf16 v45, v127, v27, v45
  s_cbranch_vccnz L_ts285
L_th285:
  buffer_load_dwordx4 v[124:127], v5, s[44:47], s8 offen offset:256 nt
  s_add_u32 s8, s8, 12288
  s_cmp_ge_u32 s8, s27
  s_cselect_b32 s11, 1572864, 0
  s_sub_u32 s8, s8, s11
  s_nop 1
  v_add_f32_dpp v45, v45, v45 quad_perm:[1,0,3,2] row_mask:0xf bank_mask:0xf
  s_nop 1
  v_add_f32_dpp v45, v45, v45 quad_perm:[2,3,0,1] row_mask:0xf bank_mask:0xf
  s_nop 1
  v_add_f32_dpp v45, v45, v45 row_half_mirror row_mask:0xf bank_mask:0xf
  s_add_u32 s11, s95, 1
  s_and_b32 s11, s11, 3
  s_cmp_lg_u32 s11, s3
  s_cbranch_scc1 L_c286
  s_movk_i32 s11, 0x1fe
  s_bitcmp1_b32 s11, s95
  s_cbranch_scc0 L_c286
  s_sub_u32 s12, s95, 1
  v_sub_u32 v220, s24, v220
  v_xor_b32 v221, s12, v221
  v_xor_b32 v222, s92, v222
  v_or_b32 v221, v221, v222
  v_cmp_eq_u32 vcc, 0, v221
  v_mov_b32 v222, -140
  s_nop 0
  v_cndmask_b32 v220, v222, v220, vcc
  s_nop 0
  v_readlane_b32 s14, v220, 0
  v_readlane_b32 s11, v220, 1
  s_nop 0
  s_add_i32 s14, s14, s11
  v_readlane_b32 s11, v220, 2
  s_nop 0
  s_add_i32 s14, s14, s11
  v_readlane_b32 s11, v220, 3
  s_nop 0
  s_add_i32 s14, s14, s11
  v_readlane_b32 s11, v220, 4
  s_nop 0
  s_add_i32 s14, s14, s11
  v_readlane_b32 s11, v220, 5
  s_nop 0
  s_add_i32 s14, s14, s11
  v_readlane_b32 s11, v220, 6
  s_nop 0
  s_add_i32 s14, s14, s11
  v_readlane_b32 s11, v220, 7
  s_nop 0
  s_add_i32 s14, s14, s11
  s_nop 0
  s_ashr_i32 s14, s14, 3
  s_sub_i32 s11, -160, s14
  s_mul_i32 s11, s11, 6
  s_ashr_i32 s11, s11, 8
  s_max_i32 s11, s11, 0
  s_min_i32 s11, s11, 4
  s_sub_i32 s14, 80, s14
  s_mul_i32 s14, s14, 14
  s_ashr_i32 s14, s14, 8
  s_max_i32 s14, s14, 0
  s_min_i32 s22, s14, 8
  s_add_u32 s22, s22, s11
  v_mov_b32 v1, 43328
  v_mov_b32 v4, s22
  ds_write_b32 v1, v4
  s_mov_b32 vcc_lo, s22
  s_mov_b32 vcc_hi, 0
L_c286:
  s_waitcnt vmcnt(5)
  v_dot2_f32_bf16 v46, v104, v16, 0
  v_dot2_f32_bf16 v46, v105, v17, v46
  v_dot2_f32_bf16 v46, v106, v18, v46
  v_dot2_f32_bf16 v46, v107, v19, v46
  s_cbranch_vccnz L_ts287
L_th287:
  s_mov_b32 s15, s43
  buffer_load_dwordx4 v[104:107], v5, s[48:51], s15 offen offset:0 nt
  s_waitcnt vmcnt(5)
  v_dot2_f32_bf16 v46, v108, v20, v46
  v_dot2_f32_bf16 v46, v109, v21, v46
  v_dot2_f32_bf16 v46, v110, v22, v46
  v_dot2_f32_bf16 v46, v111, v23, v46
  s_cbranch_vccnz L_ts288
L_th288:
  buffer_load_dwordx4 v[108:111], v5, s[48:51], s15 offen offset:128 nt
  s_waitcnt vmcnt(5)
  v_dot2_f32_bf16 v46, v112, v24, v46
  v_dot2_f32_bf16 v46, v113, v25, v46
  v_dot2_f32_bf16 v46, v114, v26, v46
  v_dot2_f32_bf16 v46, v115, v27, v46
  s_cbranch_vccnz L_ts289
L_th289:
  buffer_load_dwordx4 v[112:115], v5, s[48:51], s15 offen offset:256 nt
  s_add_u32 s15, s15, 12288
  s_cmp_ge_u32 s15, s27
  s_cselect_b32 s11, 1572864, 0
  s_sub_u32 s15, s15, s11
  s_nop 1
  v_add_f32_dpp v46, v46, v46 quad_perm:[1,0,3,2] row_mask:0xf bank_mask:0xf
  s_nop 1
  v_add_f32_dpp v46, v46, v46 quad_perm:[2,3,0,1] row_mask:0xf bank_mask:0xf
  s_nop 1
  v_add_f32_dpp v46, v46, v46 row_half_mirror row_mask:0xf bank_mask:0xf
  s_waitcnt vmcnt(5)
  v_dot2_f32_bf16 v47, v116, v16, 0
  v_dot2_f32_bf16 v47, v117, v17, v47
  v_dot2_f32_bf16 v47, v118, v18, v47
  v_dot2_f32_bf16 v47, v119, v19, v47
  s_cbranch_vccnz L_ts290
L_th290:
  buffer_load_dwordx4 v[116:119], v5, s[48:51], s15 offen offset:0 nt
  s_waitcnt vmcnt(5)
  v_dot2_f32_bf16 v47, v120, v20, v47
  v_dot2_f32_bf16 v47, v121, v21, v47
  v_dot2_f32_bf16 v47, v122, v22, v47
  v_dot2_f32_bf16 v47, v123, v23, v47
  s_cbranch_vccnz L_ts291
L_th291:
  buffer_load_dwordx4 v[120:123], v5, s[48:51], s15 offen offset:128 nt
  s_waitcnt vmcnt(5)
  v_dot2_f32_bf16 v47, v124, v24, v47
  v_dot2_f32_bf16 v47, v125, v25, v47
  v_dot2_f32_bf16 v47, v126, v26, v47
  v_dot2_f32_bf16 v47, v127, v27, v47
  s_cbranch_vccnz L_ts292
L_th292:
  buffer_load_dwordx4 v[124:127], v5, s[48:51], s15 offen offset:256 nt
  s_add_u32 s15, s15, 12288
  s_cmp_ge_u32 s15, s27
  s_cselect_b32 s11, 1572864, 0
  s_sub_u32 s15, s15, s11
  s_nop 1
  v_add_f32_dpp v47, v47, v47 quad_perm:[1,0,3,2] row_mask:0xf bank_mask:0xf
  s_nop 1
  v_add_f32_dpp v47, v47, v47 quad_perm:[2,3,0,1] row_mask:0xf bank_mask:0xf
  s_nop 1
  v_add_f32_dpp v47, v47, v47 row_half_mirror row_mask:0xf bank_mask:0xf
  v_mov_b32 v1, 43328
  ds_read_b32 v4, v1
  s_waitcnt lgkmcnt(0)
  v_readfirstlane_b32 s22, v4
  s_nop 1
  s_mov_b32 vcc_lo, s22
  s_mov_b32 vcc_hi, 0
  v_max3_f32 v1, v40, v41, v42
  v_max3_f32 v1, v1, v43, v44
  v_max3_f32 v1, v1, v45, v46
  v_max_f32 v1, v1, v47
  s_nop 1
  v_max_f32_dpp v4, v1, v1 row_ror:8 row_mask:0xf bank_mask:0xf
  s_nop 0
  v_readlane_b32 s11, v4, 0
  v_readlane_b32 s12, v4, 16
  v_readlane_b32 s13, v4, 32
  v_readlane_b32 s14, v4, 48
  s_nop 0
  v_mov_b32 v9, s11
  v_max_f32 v9, s12, v9
  v_max_f32 v9, s13, v9
  v_max_f32 v9, s14, v9
  v_mul_f32 v10, s10, v9
  v_fma_f32 v40, v40, s10, -v10
  v_exp_f32 v40, v40
  s_nop 0
  v_cvt_pk_bf16_f32 v59, v40, v40
  v_mov_b32 v11, v40
  v_and_b32 v56, v59, v12
  v_and_b32 v57, v59, v13
  v_and_b32 v58, v59, v14
  v_and_b32 v59, v59, v15
  s_waitcnt vmcnt(5)
  s_nop 0
  v_mfma_f32_16x16x32_bf16 v[28:31], v[56:59], v[104:107], 0
  s_cbranch_vccnz L_ts293
L_th293:
  buffer_load_dwordx4 v[104:107], v5, s[48:51], s15 offen offset:0 nt
  s_waitcnt vmcnt(5)
  v_mfma_f32_16x16x32_bf16 v[32:35], v[56:59], v[108:111], 0
  s_cbranch_vccnz L_ts294
L_th294:
  buffer_load_dwordx4 v[108:111], v5, s[48:51], s15 offen offset:128 nt
  s_waitcnt vmcnt(5)
  v_mfma_f32_16x16x32_bf16 v[36:39], v[56:59], v[112:115], 0
  s_cbranch_vccnz L_ts295
L_th295:
  buffer_load_dwordx4 v[112:115], v5, s[48:51], s15 offen offset:256 nt
  s_add_u32 s15, s15, 12288
  s_cmp_ge_u32 s15, s27
  s_cselect_b32 s11, 1572864, 0
  s_sub_u32 s15, s15, s11
  v_fma_f32 v41, v41, s10, -v10
  v_exp_f32 v41, v41
  s_nop 0
  v_cvt_pk_bf16_f32 v63, v41, v41
  v_add_f32 v11, v11, v41
  v_and_b32 v60, v63, v12
  v_and_b32 v61, v63, v13
  v_and_b32 v62, v63, v14
  v_and_b32 v63, v63, v15
  s_waitcnt vmcnt(5)
  s_nop 0
  v_mfma_f32_16x16x32_bf16 v[28:31], v[60:63], v[116:119], v[28:31]
  s_cbranch_vccnz L_ts296
L_th296:
  buffer_load_dwordx4 v[116:119], v5, s[48:51], s15 offen offset:0 nt
  s_waitcnt vmcnt(5)
  v_mfma_f32_16x16x32_bf16 v[32:35], v[60:63], v[120:123], v[32:35]
  s_cbranch_vccnz L_ts297
L_th297:
  buffer_load_dwordx4 v[120:123], v5, s[48:51], s15 offen offset:128 nt
  s_waitcnt vmcnt(5)
  v_mfma_f32_16x16x32_bf16 v[36:39], v[60:63], v[124:127], v[36:39]
  s_cbranch_vccnz L_ts298
L_th298:
  buffer_load_dwordx4 v[124:127], v5, s[48:51], s15 offen offset:256 nt
  s_add_u32 s15, s15, 12288
  s_cmp_ge_u32 s15, s27
  s_cselect_b32 s11, 1572864, 0
  s_sub_u32 s15, s15, s11
  v_fma_f32 v42, v42, s10, -v10
  v_exp_f32 v42, v42
  s_nop 0
  v_cvt_pk_bf16_f32 v59, v42, v42
  v_add_f32 v11, v11, v42
  v_and_b32 v56, v59, v12
  v_and_b32 v57, v59, v13
  v_and_b32 v58, v59, v14
  v_and_b32 v59, v59, v15
  s_waitcnt vmcnt(5)
  s_nop 0
  v_mfma_f32_16x16x32_bf16 v[28:31], v[56:59], v[104:107], v[28:31]
  s_cbranch_vccnz L_ts299
L_th299:
  buffer_load_dwordx4 v[104:107], v5, s[48:51], s15 offen offset:0 nt
  s_waitcnt vmcnt(5)
  v_mfma_f32_16x16x32_bf16 v[32:35], v[56:59], v[108:111], v[32:35]
  s_cbranch_vccnz L_ts300
L_th300:
  buffer_load_dwordx4 v[108:111], v5, s[48:51], s15 offen offset:128 nt
  s_waitcnt vmcnt(5)
  v_mfma_f32_16x16x32_bf16 v[36:39], v[56:59], v[112:115], v[36:39]
  s_cbranch_vccnz L_ts301
L_th301:
  buffer_load_dwordx4 v[112:115], v5, s[48:51], s15 offen offset:256 nt
  s_add_u32 s15, s15, s17
  s_cmp_ge_u32 s15, s27
  s_cselect_b32 s11, 1572864, 0
  s_sub_u32 s15, s15, s11
  v_fma_f32 v43, v43, s10, -v10
  v_exp_f32 v43, v43
  s_nop 0
  v_cvt_pk_bf16_f32 v63, v43, v43
  v_add_f32 v11, v11, v43
  v_and_b32 v60, v63, v12
  v_and_b32 v61, v63, v13
  v_and_b32 v62, v63, v14
  v_and_b32 v63, v63, v15
  s_waitcnt vmcnt(5)
  s_nop 0
  v_mfma_f32_16x16x32_bf16 v[28:31], v[60:63], v[116:119], v[28:31]
  s_cbranch_vccnz L_ts302
L_th302:
  buffer_load_dwordx4 v[116:119], v5, s[48:51], s15 offen offset:0 nt
  s_waitcnt vmcnt(5)
  v_mfma_f32_16x16x32_bf16 v[32:35], v[60:63], v[120:123], v[32:35]
  s_cbranch_vccnz L_ts303
L_th303:
  buffer_load_dwordx4 v[120:123], v5, s[48:51], s15 offen offset:128 nt
  s_waitcnt vmcnt(5)
  v_mfma_f32_16x16x32_bf16 v[36:39], v[60:63], v[124:127], v[36:39]
  s_cbranch_vccnz L_ts304
L_th304:
  buffer_load_dwordx4 v[124:127], v5, s[48:51], s15 offen offset:256 nt
  s_add_u32 s15, s15, 12288
  s_cmp_ge_u32 s15, s27
  s_cselect_b32 s11, 1572864, 0
  s_sub_u32 s15, s15, s11
  s_barrier
  s_lshl_b32 s11, s5, 10
  s_lshl_b32 s12, s7, 4
  s_add_u32 s11, s11, s12
  s_add_u32 s11, s11, 2097152
  v_add_u32 v1, s7, v3
  v_and_b32 v1, 7, v1
  v_lshlrev_b32 v1, 7, v1
  buffer_load_dwordx4 v[204:207], v1, s[64:67], s11 offen sc1
  v_fma_f32 v44, v44, s10, -v10
  v_exp_f32 v44, v44
  s_nop 0
  v_cvt_pk_bf16_f32 v59, v44, v44
  v_add_f32 v11, v11, v44
  v_and_b32 v56, v59, v12
  v_and_b32 v57, v59, v13
  v_and_b32 v58, v59, v14
  v_and_b32 v59, v59, v15
  s_waitcnt vmcnt(6)
  s_nop 0
  v_mfma_f32_16x16x32_bf16 v[28:31], v[56:59], v[104:107], v[28:31]
  s_cbranch_vccnz L_ts305
L_th305:
  buffer_load_dwordx4 v[104:107], v5, s[48:51], s15 offen offset:0 nt
  s_waitcnt vmcnt(6)
  v_mfma_f32_16x16x32_bf16 v[32:35], v[56:59], v[108:111], v[32:35]
  s_cbranch_vccnz L_ts306
L_th306:
  buffer_load_dwordx4 v[108:111], v5, s[48:51], s15 offen offset:128 nt
  s_waitcnt vmcnt(6)
  v_mfma_f32_16x16x32_bf16 v[36:39], v[56:59], v[112:115], v[36:39]
  s_cbranch_vccnz L_ts307
L_th307:
  buffer_load_dwordx4 v[112:115], v5, s[48:51], s15 offen offset:256 nt
  s_add_u32 s15, s15, 12288
  s_cmp_ge_u32 s15, s27
  s_cselect_b32 s11, 1572864, 0
  s_sub_u32 s15, s15, s11
  v_fma_f32 v45, v45, s10, -v10
  v_exp_f32 v45, v45
  s_nop 0
  v_cvt_pk_bf16_f32 v63, v45, v45
  v_add_f32 v11, v11, v45
  v_and_b32 v60, v63, v12
  v_and_b32 v61, v63, v13
  v_and_b32 v62, v63, v14
  v_and_b32 v63, v63, v15
  s_waitcnt vmcnt(6)
  s_nop 0
  v_mfma_f32_16x16x32_bf16 v[28:31], v[60:63], v[116:119], v[28:31]
  s_cbranch_vccnz L_ts308
L_th308:
  buffer_load_dwordx4 v[116:119], v5, s[48:51], s15 offen offset:0 nt
  s_waitcnt vmcnt(6)
  v_mfma_f32_16x16x32_bf16 v[32:35], v[60:63], v[120:123], v[32:35]
  s_cbranch_vccnz L_ts309
L_th309:
  buffer_load_dwordx4 v[120:123], v5, s[48:51], s15 offen offset:128 nt
  s_waitcnt vmcnt(6)
  v_mfma_f32_16x16x32_bf16 v[36:39], v[60:63], v[124:127], v[36:39]
  s_cbranch_vccnz L_ts310
L_th310:
  buffer_load_dwordx4 v[124:127], v5, s[48:51], s15 offen offset:256 nt
  s_add_u32 s15, s15, 12288
  s_cmp_ge_u32 s15, s27
  s_cselect_b32 s11, 1572864, 0
  s_sub_u32 s15, s15, s11
  s_waitcnt vmcnt(6)
  v_xor_b32 v206, s92, v206
  v_xor_b32 v207, s93, v207
  v_or_b32 v4, v206, v207
  v_cmp_ne_u32 vcc, 0, v4
  s_nop 1
  s_cmp_lg_u64 vcc, 0
  s_cselect_b32 s100, 1, 0
  s_mov_b32 vcc_lo, s22
  s_mov_b32 vcc_hi, 0
  s_mul_i32 s11, s5, 24576
  s_mul_i32 s12, s7, 384
  s_add_u32 s11, s11, s12
  s_add_u32 s11, s11, 1310720
  s_mov_b32 exec_hi, 0xffff
  s_add_u32 s12, s7, 1
  s_and_b32 s12, s12, 7
  s_mul_i32 s12, s12, 3072
  s_add_u32 s12, s12, s11
  buffer_load_dwordx2 v[190:191], v7, s[64:67], s12 offen sc1
  s_add_u32 s12, s7, 2
  s_and_b32 s12, s12, 7
  s_mul_i32 s12, s12, 3072
  s_add_u32 s12, s12, s11
  buffer_load_dwordx2 v[192:193], v7, s[64:67], s12 offen sc1
  s_add_u32 s12, s7, 3
  s_and_b32 s12, s12, 7
  s_mul_i32 s12, s12, 3072
  s_add_u32 s12, s12, s11
  buffer_load_dwordx2 v[194:195], v7, s[64:67], s12 offen sc1
  s_add_u32 s12, s7, 4
  s_and_b32 s12, s12, 7
  s_mul_i32 s12, s12, 3072
  s_add_u32 s12, s12, s11
  buffer_load_dwordx2 v[196:197], v7, s[64:67], s12 offen sc1
  s_add_u32 s12, s7, 5
  s_and_b32 s12, s12, 7
  s_mul_i32 s12, s12, 3072
  s_add_u32 s12, s12, s11
  buffer_load_dwordx2 v[198:199], v7, s[64:67], s12 offen sc1
  s_add_u32 s12, s7, 6
  s_and_b32 s12, s12, 7
  s_mul_i32 s12, s12, 3072
  s_add_u32 s12, s12, s11
  buffer_load_dwordx2 v[200:201], v7, s[64:67], s12 offen sc1
  s_add_u32 s12, s7, 7
  s_and_b32 s12, s12, 7
  s_mul_i32 s12, s12, 3072
  s_add_u32 s12, s12, s11
  buffer_load_dwordx2 v[202:203], v7, s[64:67], s12 offen sc1
  s_mov_b32 exec_hi, -1
  buffer_load_dwordx4 a[240:243], v8, s[56:59], s79 offen offset:0
  buffer_load_dwordx4 a[244:247], v8, s[56:59], s79 offen offset:128
  buffer_load_dwordx4 a[248:251], v8, s[96:99], s79 offen offset:256
  s_add_u32 s79, s79, 10240
  buffer_load_dwordx4 a[252:255], v8, s[56:59], s79 offen offset:0
  buffer_load_dwordx4 v[224:227], v8, s[56:59], s79 offen offset:128
  buffer_load_dwordx4 v[228:231], v8, s[96:99], s79 offen offset:256
  s_add_u32 s79, s79, 10240
  buffer_load_dwordx4 v[232:235], v8, s[56:59], s79 offen offset:0
  buffer_load_dwordx4 v[236:239], v8, s[56:59], s79 offen offset:128
  buffer_load_dwordx4 v[240:243], v8, s[96:99], s79 offen offset:256
  s_add_u32 s79, s79, 10240
  buffer_load_dwordx4 v[244:247], v8, s[56:59], s79 offen offset:0
  buffer_load_dwordx4 v[248:251], v8, s[56:59], s79 offen offset:128
  buffer_load_dwordx4 v[252:255], v8, s[96:99], s79 offen offset:256
  s_add_u32 s79, s79, 10240
  v_fma_f32 v46, v46, s10, -v10
  v_exp_f32 v46, v46
  s_nop 0
  v_cvt_pk_bf16_f32 v59, v46, v46
  v_add_f32 v11, v11, v46
  v_and_b32 v56, v59, v12
  v_and_b32 v57, v59, v13
  v_and_b32 v58, v59, v14
  v_and_b32 v59, v59, v15
  s_waitcnt vmcnt(24)
  s_nop 0
  v_mfma_f32_16x16x32_bf16 v[28:31], v[56:59], v[104:107], v[28:31]
  s_waitcnt vmcnt(23)
  v_mfma_f32_16x16x32_bf16 v[32:35], v[56:59], v[108:111], v[32:35]
  s_waitcnt vmcnt(22)
  v_mfma_f32_16x16x32_bf16 v[36:39], v[56:59], v[112:115], v[36:39]
  v_fma_f32 v47, v47, s10, -v10
  v_exp_f32 v47, v47
  s_nop 0
  v_cvt_pk_bf16_f32 v63, v47, v47
  v_add_f32 v11, v11, v47
  v_and_b32 v60, v63, v12
  v_and_b32 v61, v63, v13
  v_and_b32 v62, v63, v14
  v_and_b32 v63, v63, v15
  s_waitcnt vmcnt(21)
  s_nop 0
  v_mfma_f32_16x16x32_bf16 v[28:31], v[60:63], v[116:119], v[28:31]
  s_waitcnt vmcnt(20)
  v_mfma_f32_16x16x32_bf16 v[32:35], v[60:63], v[120:123], v[32:35]
  s_waitcnt vmcnt(19)
  v_mfma_f32_16x16x32_bf16 v[36:39], v[60:63], v[124:127], v[36:39]
  s_waitcnt vmcnt(12)
  v_lshlrev_b32 v4, 4, v0
  ds_read_b128 v[208:211], v4 offset:39104
  v_mov_b32 v212, v204
  s_nop 1
  v_max_f32_dpp v212, v212, v212 quad_perm:[1,0,3,2] row_mask:0xf bank_mask:0xf
  s_nop 1
  v_max_f32_dpp v212, v212, v212 quad_perm:[2,3,0,1] row_mask:0xf bank_mask:0xf
  s_nop 1
  v_max_f32_dpp v212, v212, v212 row_half_mirror row_mask:0xf bank_mask:0xf
  s_nop 1
  v_sub_f32 v204, v204, v212
  v_mul_f32 v204, s10, v204
  v_exp_f32 v204, v204
  s_nop 0
  v_mul_f32 v213, v204, v205
  v_readlane_b32 s52, v204, 0
  v_readlane_b32 s53, v204, 1
  v_readlane_b32 s54, v204, 2
  v_readlane_b32 s55, v204, 3
  v_readlane_b32 s60, v204, 4
  v_readlane_b32 s61, v204, 5
  v_readlane_b32 s62, v204, 6
  v_readlane_b32 s63, v204, 7
  v_add_f32_dpp v213, v213, v213 quad_perm:[1,0,3,2] row_mask:0xf bank_mask:0xf
  s_nop 1
  v_add_f32_dpp v213, v213, v213 quad_perm:[2,3,0,1] row_mask:0xf bank_mask:0xf
  s_nop 1
  v_add_f32_dpp v213, v213, v213 row_half_mirror row_mask:0xf bank_mask:0xf
  s_nop 1
  s_waitcnt lgkmcnt(0)
  v_mul_f32 v208, s52, v208
  v_mul_f32 v209, s52, v209
  v_mul_f32 v210, s52, v210
  v_mul_f32 v211, s52, v211
  v_lshlrev_b32 v4, 16, v190
  v_and_b32 v190, 0xffff0000, v190
  v_fmac_f32 v208, s53, v4
  v_fmac_f32 v209, s53, v190
  v_lshlrev_b32 v4, 16, v191
  v_and_b32 v191, 0xffff0000, v191
  v_fmac_f32 v210, s53, v4
  v_fmac_f32 v211, s53, v191
  v_lshlrev_b32 v4, 16, v192
  v_and_b32 v192, 0xffff0000, v192
  v_fmac_f32 v208, s54, v4
  v_fmac_f32 v209, s54, v192
  v_lshlrev_b32 v4, 16, v193
  v_and_b32 v193, 0xffff0000, v193
  v_fmac_f32 v210, s54, v4
  v_fmac_f32 v211, s54, v193
  v_lshlrev_b32 v4, 16, v194
  v_and_b32 v194, 0xffff0000, v194
  v_fmac_f32 v208, s55, v4
  v_fmac_f32 v209, s55, v194
  v_lshlrev_b32 v4, 16, v195
  v_and_b32 v195, 0xffff0000, v195
  v_fmac_f32 v210, s55, v4
  v_fmac_f32 v211, s55, v195
  v_lshlrev_b32 v4, 16, v196
  v_and_b32 v196, 0xffff0000, v196
  v_fmac_f32 v208, s60, v4
  v_fmac_f32 v209, s60, v196
  v_lshlrev_b32 v4, 16, v197
  v_and_b32 v197, 0xffff0000, v197
  v_fmac_f32 v210, s60, v4
  v_fmac_f32 v211, s60, v197
  v_lshlrev_b32 v4, 16, v198
  v_and_b32 v198, 0xffff0000, v198
  v_fmac_f32 v208, s61, v4
  v_fmac_f32 v209, s61, v198
  v_lshlrev_b32 v4, 16, v199
  v_and_b32 v199, 0xffff0000, v199
  v_fmac_f32 v210, s61, v4
  v_fmac_f32 v211, s61, v199
  v_lshlrev_b32 v4, 16, v200
  v_and_b32 v200, 0xffff0000, v200
  v_fmac_f32 v208, s62, v4
  v_fmac_f32 v209, s62, v200
  v_lshlrev_b32 v4, 16, v201
  v_and_b32 v201, 0xffff0000, v201
  v_fmac_f32 v210, s62, v4
  v_fmac_f32 v211, s62, v201
  v_lshlrev_b32 v4, 16, v202
  v_and_b32 v202, 0xffff0000, v202
  v_fmac_f32 v208, s63, v4
  v_fmac_f32 v209, s63, v202
  v_lshlrev_b32 v4, 16, v203
  v_and_b32 v203, 0xffff0000, v203
  v_fmac_f32 v210, s63, v4
  v_fmac_f32 v211, s63, v203
  s_cmp_eq_u32 s100, 0
  s_cbranch_scc1 L_pmok
L_pmspin:
  s_add_u32 s9, s9, 1
  s_cmp_gt_u32 s9, 100000
  s_cbranch_scc1 L_pmgo
  s_lshl_b32 s11, s5, 10
  s_lshl_b32 s12, s7, 4
  s_add_u32 s11, s11, s12
  s_add_u32 s11, s11, 2097152
  v_add_u32 v1, s7, v3
  v_and_b32 v1, 7, v1
  v_lshlrev_b32 v1, 7, v1
  buffer_load_dwordx4 v[204:207], v1, s[64:67], s11 offen sc1
  s_waitcnt vmcnt(0)
  v_xor_b32 v206, s92, v206
  v_xor_b32 v207, s93, v207
  v_or_b32 v4, v206, v207
  v_cmp_ne_u32 vcc, 0, v4
  s_nop 1
  s_cbranch_vccnz L_pmspin
L_pmgo:
  s_mul_i32 s11, s5, 24576
  s_mul_i32 s12, s7, 384
  s_add_u32 s11, s11, s12
  s_add_u32 s11, s11, 1310720
  s_mov_b32 exec_hi, 0xffff
  s_add_u32 s12, s7, 1
  s_and_b32 s12, s12, 7
  s_mul_i32 s12, s12, 3072
  s_add_u32 s12, s12, s11
  buffer_load_dwordx2 v[190:191], v7, s[64:67], s12 offen sc1
  s_add_u32 s12, s7, 2
  s_and_b32 s12, s12, 7
  s_mul_i32 s12, s12, 3072
  s_add_u32 s12, s12, s11
  buffer_load_dwordx2 v[192:193], v7, s[64:67], s12 offen sc1
  s_add_u32 s12, s7, 3
  s_and_b32 s12, s12, 7
  s_mul_i32 s12, s12, 3072
  s_add_u32 s12, s12, s11
  buffer_load_dwordx2 v[194:195], v7, s[64:67], s12 offen sc1
  s_add_u32 s12, s7, 4
  s_and_b32 s12, s12, 7
  s_mul_i32 s12, s12, 3072
  s_add_u32 s12, s12, s11
  buffer_load_dwordx2 v[196:197], v7, s[64:67], s12 offen sc1
  s_add_u32 s12, s7, 5
  s_and_b32 s12, s12, 7
  s_mul_i32 s12, s12, 3072
  s_add_u32 s12, s12, s11
  buffer_load_dwordx2 v[198:199], v7, s[64:67], s12 offen sc1
  s_add_u32 s12, s7, 6
  s_and_b32 s12, s12, 7
  s_mul_i32 s12, s12, 3072
  s_add_u32 s12, s12, s11
  buffer_load_dwordx2 v[200:201], v7, s[64:67], s12 offen sc1
  s_add_u32 s12, s7, 7
  s_and_b32 s12, s12, 7
  s_mul_i32 s12, s12, 3072
  s_add_u32 s12, s12, s11
  buffer_load_dwordx2 v[202:203], v7, s[64:67], s12 offen sc1
  s_mov_b32 exec_hi, -1
  s_waitcnt vmcnt(0)
  v_lshlrev_b32 v4, 4, v0
  ds_read_b128 v[208:211], v4 offset:39104
  v_mov_b32 v212, v204
  s_nop 1
  v_max_f32_dpp v212, v212, v212 quad_perm:[1,0,3,2] row_mask:0xf bank_mask:0xf
  s_nop 1
  v_max_f32_dpp v212, v212, v212 quad_perm:[2,3,0,1] row_mask:0xf bank_mask:0xf
  s_nop 1
  v_max_f32_dpp v212, v212, v212 row_half_mirror row_mask:0xf bank_mask:0xf
  s_nop 1
  v_sub_f32 v204, v204, v212
  v_mul_f32 v204, s10, v204
  v_exp_f32 v204, v204
  s_nop 0
  v_mul_f32 v213, v204, v205
  v_readlane_b32 s52, v204, 0
  v_readlane_b32 s53, v204, 1
  v_readlane_b32 s54, v204, 2
  v_readlane_b32 s55, v204, 3
  v_readlane_b32 s60, v204, 4
  v_readlane_b32 s61, v204, 5
  v_readlane_b32 s62, v204, 6
  v_readlane_b32 s63, v204, 7
  v_add_f32_dpp v213, v213, v213 quad_perm:[1,0,3,2] row_mask:0xf bank_mask:0xf
  s_nop 1
  v_add_f32_dpp v213, v213, v213 quad_perm:[2,3,0,1] row_mask:0xf bank_mask:0xf
  s_nop 1
  v_add_f32_dpp v213, v213, v213 row_half_mirror row_mask:0xf bank_mask:0xf
  s_nop 1
  s_waitcnt lgkmcnt(0)
  v_mul_f32 v208, s52, v208
  v_mul_f32 v209, s52, v209
  v_mul_f32 v210, s52, v210
  v_mul_f32 v211, s52, v211
  v_lshlrev_b32 v4, 16, v190
  v_and_b32 v190, 0xffff0000, v190
  v_fmac_f32 v208, s53, v4
  v_fmac_f32 v209, s53, v190
  v_lshlrev_b32 v4, 16, v191
  v_and_b32 v191, 0xffff0000, v191
  v_fmac_f32 v210, s53, v4
  v_fmac_f32 v211, s53, v191
  v_lshlrev_b32 v4, 16, v192
  v_and_b32 v192, 0xffff0000, v192
  v_fmac_f32 v208, s54, v4
  v_fmac_f32 v209, s54, v192
  v_lshlrev_b32 v4, 16, v193
  v_and_b32 v193, 0xffff0000, v193
  v_fmac_f32 v210, s54, v4
  v_fmac_f32 v211, s54, v193
  v_lshlrev_b32 v4, 16, v194
  v_and_b32 v194, 0xffff0000, v194
  v_fmac_f32 v208, s55, v4
  v_fmac_f32 v209, s55, v194
  v_lshlrev_b32 v4, 16, v195
  v_and_b32 v195, 0xffff0000, v195
  v_fmac_f32 v210, s55, v4
  v_fmac_f32 v211, s55, v195
  v_lshlrev_b32 v4, 16, v196
  v_and_b32 v196, 0xffff0000, v196
  v_fmac_f32 v208, s60, v4
  v_fmac_f32 v209, s60, v196
  v_lshlrev_b32 v4, 16, v197
  v_and_b32 v197, 0xffff0000, v197
  v_fmac_f32 v210, s60, v4
  v_fmac_f32 v211, s60, v197
  v_lshlrev_b32 v4, 16, v198
  v_and_b32 v198, 0xffff0000, v198
  v_fmac_f32 v208, s61, v4
  v_fmac_f32 v209, s61, v198
  v_lshlrev_b32 v4, 16, v199
  v_and_b32 v199, 0xffff0000, v199
  v_fmac_f32 v210, s61, v4
  v_fmac_f32 v211, s61, v199
  v_lshlrev_b32 v4, 16, v200
  v_and_b32 v200, 0xffff0000, v200
  v_fmac_f32 v208, s62, v4
  v_fmac_f32 v209, s62, v200
  v_lshlrev_b32 v4, 16, v201
  v_and_b32 v201, 0xffff0000, v201
  v_fmac_f32 v210, s62, v4
  v_fmac_f32 v211, s62, v201
  v_lshlrev_b32 v4, 16, v202
  v_and_b32 v202, 0xffff0000, v202
  v_fmac_f32 v208, s63, v4
  v_fmac_f32 v209, s63, v202
  v_lshlrev_b32 v4, 16, v203
  v_and_b32 v203, 0xffff0000, v203
  v_fmac_f32 v210, s63, v4
  v_fmac_f32 v211, s63, v203
L_pmok:
  v_add_f32_dpp v11, v11, v11 row_ror:8 row_mask:0xf bank_mask:0xf
  v_add_u32 v1, s101, v97
  v_readlane_b32 s11, v11, 0
  v_readlane_b32 s12, v11, 16
  v_readlane_b32 s13, v11, 32
  v_readlane_b32 s14, v11, 48
  s_nop 1
  ds_write_b128 v1, v[28:31] offset:0
  ds_write_b128 v1, v[32:35] offset:1024
  ds_write_b128 v1, v[36:39] offset:2048
  v_mov_b32 v10, s11
  v_add_f32 v10, s12, v10
  v_add_f32 v10, s13, v10
  v_add_f32 v10, s14, v10
  s_lshl_b32 s11, s3, 3
  s_add_u32 s11, s11, s101
  v_mov_b32 v1, s11
  v_mov_b32 v180, v9
  v_mov_b32 v181, v10
  ds_write_b64 v1, v[180:181] offset:16384
  s_waitcnt lgkmcnt(0)
  s_barrier
  v_mov_b32 v1, s101
  v_add_u32 v4, s101, v96
  ds_read_b128 v[180:183], v1 offset:16384
  ds_read_b128 v[184:187], v1 offset:16400
  ds_read_b128 v[64:67], v4 offset:0
  ds_read_b128 v[68:71], v4 offset:640
  ds_read_b128 v[72:75], v4 offset:4096
  ds_read_b128 v[76:79], v4 offset:4736
  ds_read_b128 v[80:83], v4 offset:8192
  ds_read_b128 v[84:87], v4 offset:8832
  ds_read_b128 v[88:91], v4 offset:12288
  ds_read_b128 v[92:95], v4 offset:12928
  s_waitcnt lgkmcnt(8)
  v_max3_f32 v9, v180, v182, v184
  v_max3_f32 v9, v9, v186, v212
  v_sub_f32 v40, v180, v9
  v_sub_f32 v41, v182, v9
  v_sub_f32 v42, v184, v9
  v_sub_f32 v43, v186, v9
  v_sub_f32 v44, v212, v9
  v_mul_f32 v40, s10, v40
  v_mul_f32 v41, s10, v41
  v_mul_f32 v42, s10, v42
  v_mul_f32 v43, s10, v43
  v_mul_f32 v44, s10, v44
  v_exp_f32 v40, v40
  v_exp_f32 v41, v41
  v_exp_f32 v42, v42
  v_exp_f32 v43, v43
  v_exp_f32 v44, v44
  s_nop 0
  v_mul_f32 v11, v44, v213
  v_fmac_f32 v11, v40, v181
  v_fmac_f32 v11, v41, v183
  v_fmac_f32 v11, v42, v185
  v_fmac_f32 v11, v43, v187
  v_rcp_f32 v11, v11
  s_nop 0
  v_mul_f32 v40, v40, v11
  v_mul_f32 v41, v41, v11
  v_mul_f32 v42, v42, v11
  v_mul_f32 v43, v43, v11
  v_mul_f32 v44, v44, v11
  s_waitcnt lgkmcnt(6)
  v_add_f32 v64, v64, v68
  v_add_f32 v65, v65, v69
  v_add_f32 v66, v66, v70
  v_add_f32 v67, v67, v71
  v_mul_f32 v56, v40, v64
  v_mul_f32 v57, v40, v65
  v_mul_f32 v58, v40, v66
  v_mul_f32 v59, v40, v67
  s_waitcnt lgkmcnt(4)
  v_add_f32 v72, v72, v76
  v_add_f32 v73, v73, v77
  v_add_f32 v74, v74, v78
  v_add_f32 v75, v75, v79
  v_fmac_f32 v56, v41, v72
  v_fmac_f32 v57, v41, v73
  v_fmac_f32 v58, v41, v74
  v_fmac_f32 v59, v41, v75
  s_waitcnt lgkmcnt(2)
  v_add_f32 v80, v80, v84
  v_add_f32 v81, v81, v85
  v_add_f32 v82, v82, v86
  v_add_f32 v83, v83, v87
  v_fmac_f32 v56, v42, v80
  v_fmac_f32 v57, v42, v81
  v_fmac_f32 v58, v42, v82
  v_fmac_f32 v59, v42, v83
  s_waitcnt lgkmcnt(0)
  v_add_f32 v88, v88, v92
  v_add_f32 v89, v89, v93
  v_add_f32 v90, v90, v94
  v_add_f32 v91, v91, v95
  v_fmac_f32 v56, v43, v88
  v_fmac_f32 v57, v43, v89
  v_fmac_f32 v58, v43, v90
  v_fmac_f32 v59, v43, v91
  v_fmac_f32 v56, v44, v208
  v_fmac_f32 v57, v44, v209
  v_fmac_f32 v58, v44, v210
  v_fmac_f32 v59, v44, v211
  v_cvt_pk_bf16_f32 v56, v56, v57
  v_cvt_pk_bf16_f32 v57, v58, v59
  s_lshl_b32 s11, s3, 9
  s_add_u32 s11, s11, 36992
  v_and_b32 v1, 1, v0
  v_mul_u32_u24 v1, 192, v1
  v_and_b32 v4, 62, v0
  v_add3_u32 v1, v1, v4, s11
  s_mov_b32 exec_hi, 0xffff
  ds_write_b16 v1, v56
  ds_write_b16_d16_hi v1, v56 offset:48
  ds_write_b16 v1, v57 offset:96
  ds_write_b16_d16_hi v1, v57 offset:144
  s_mov_b32 exec_hi, -1
  v_mul_u32_u24 v1, 48, v2
  v_add_u32 v1, s11, v1
  s_waitcnt lgkmcnt(0)
  ds_read_b128 v[64:67], v1 offset:0
  ds_read_b128 v[68:71], v1 offset:16
  ds_read_b128 v[72:75], v1 offset:32
  s_lshl_b32 s13, s7, 2
  s_add_u32 s13, s13, s3
  s_mul_i32 s14, s13, 24576
  s_add_u32 s14, s14, 65536
  s_mul_i32 s12, s5, 768
  s_add_u32 s12, s12, s14
  v_lshrrev_b32 v1, 5, v0
  v_lshlrev_b32 v1, 8, v1
  v_lshl_add_u32 v1, v3, 5, v1
  v_and_b32 v4, 16, v0
  v_add_u32 v1, v1, v4
  s_lshl_b32 s13, s13, 8
  s_add_u32 s13, s13, 2228224
  v_mov_b32 v41, s13
  v_mov_b32 v42, 1
  v_lshlrev_b32 v40, 4, v0
  s_waitcnt lgkmcnt(0)
  v_perm_b32 v59, v64, v64, s76
  v_and_b32 v56, v59, v12
  v_and_b32 v57, v59, v13
  v_and_b32 v58, v59, v14
  v_and_b32 v59, v59, v15
  s_nop 1
  v_mfma_f32_16x16x32_bf16 v[76:79], v[56:59], a[0:3], 0
  v_perm_b32 v63, v64, v64, s77
  v_and_b32 v60, v63, v12
  v_and_b32 v61, v63, v13
  v_and_b32 v62, v63, v14
  v_and_b32 v63, v63, v15
  v_mfma_f32_16x16x32_bf16 v[80:83], v[56:59], a[4:7], 0
  v_mfma_f32_16x16x32_bf16 v[84:87], v[56:59], a[8:11], 0
  v_mfma_f32_16x16x32_bf16 v[76:79], v[60:63], a[12:15], v[76:79]
  v_perm_b32 v59, v65, v65, s76
  v_and_b32 v56, v59, v12
  v_and_b32 v57, v59, v13
  v_and_b32 v58, v59, v14
  v_and_b32 v59, v59, v15
  v_mfma_f32_16x16x32_bf16 v[80:83], v[60:63], a[16:19], v[80:83]
  v_mfma_f32_16x16x32_bf16 v[84:87], v[60:63], a[20:23], v[84:87]
  v_mfma_f32_16x16x32_bf16 v[76:79], v[56:59], a[24:27], v[76:79]
  v_perm_b32 v63, v65, v65, s77
  v_and_b32 v60, v63, v12
  v_and_b32 v61, v63, v13
  v_and_b32 v62, v63, v14
  v_and_b32 v63, v63, v15
  v_mfma_f32_16x16x32_bf16 v[80:83], v[56:59], a[28:31], v[80:83]
  v_mfma_f32_16x16x32_bf16 v[84:87], v[56:59], a[32:35], v[84:87]
  v_mfma_f32_16x16x32_bf16 v[76:79], v[60:63], a[36:39], v[76:79]
  v_perm_b32 v59, v66, v66, s76
  v_and_b32 v56, v59, v12
  v_and_b32 v57, v59, v13
  v_and_b32 v58, v59, v14
  v_and_b32 v59, v59, v15
  v_mfma_f32_16x16x32_bf16 v[80:83], v[60:63], a[40:43], v[80:83]
  v_mfma_f32_16x16x32_bf16 v[84:87], v[60:63], a[44:47], v[84:87]
  v_mfma_f32_16x16x32_bf16 v[76:79], v[56:59], a[48:51], v[76:79]
  v_perm_b32 v63, v66, v66, s77
  v_and_b32 v60, v63, v12
  v_and_b32 v61, v63, v13
  v_and_b32 v62, v63, v14
  v_and_b32 v63, v63, v15
  v_mfma_f32_16x16x32_bf16 v[80:83], v[56:59], a[52:55], v[80:83]
  v_mfma_f32_16x16x32_bf16 v[84:87], v[56:59], a[56:59], v[84:87]
  v_mfma_f32_16x16x32_bf16 v[76:79], v[60:63], a[60:63], v[76:79]
  v_perm_b32 v59, v67, v67, s76
  v_and_b32 v56, v59, v12
  v_and_b32 v57, v59, v13
  v_and_b32 v58, v59, v14
  v_and_b32 v59, v59, v15
  v_mfma_f32_16x16x32_bf16 v[80:83], v[60:63], a[64:67], v[80:83]
  v_mfma_f32_16x16x32_bf16 v[84:87], v[60:63], a[68:71], v[84:87]
  v_mfma_f32_16x16x32_bf16 v[76:79], v[56:59], a[72:75], v[76:79]
  v_perm_b32 v63, v67, v67, s77
  v_and_b32 v60, v63, v12
  v_and_b32 v61, v63, v13
  v_and_b32 v62, v63, v14
  v_and_b32 v63, v63, v15
  v_mfma_f32_16x16x32_bf16 v[80:83], v[56:59], a[76:79], v[80:83]
  v_mfma_f32_16x16x32_bf16 v[84:87], v[56:59], a[80:83], v[84:87]
  v_mfma_f32_16x16x32_bf16 v[76:79], v[60:63], a[84:87], v[76:79]
  v_perm_b32 v59, v68, v68, s76
  v_and_b32 v56, v59, v12
  v_and_b32 v57, v59, v13
  v_and_b32 v58, v59, v14
  v_and_b32 v59, v59, v15
  v_mfma_f32_16x16x32_bf16 v[80:83], v[60:63], a[88:91], v[80:83]
  v_mfma_f32_16x16x32_bf16 v[84:87], v[60:63], a[92:95], v[84:87]
  v_mfma_f32_16x16x32_bf16 v[76:79], v[56:59], a[96:99], v[76:79]
  v_perm_b32 v63, v68, v68, s77
  v_and_b32 v60, v63, v12
  v_and_b32 v61, v63, v13
  v_and_b32 v62, v63, v14
  v_and_b32 v63, v63, v15
  v_mfma_f32_16x16x32_bf16 v[80:83], v[56:59], a[100:103], v[80:83]
  v_mfma_f32_16x16x32_bf16 v[84:87], v[56:59], a[104:107], v[84:87]
  v_mfma_f32_16x16x32_bf16 v[76:79], v[60:63], a[108:111], v[76:79]
  v_perm_b32 v59, v69, v69, s76
  v_and_b32 v56, v59, v12
  v_and_b32 v57, v59, v13
  v_and_b32 v58, v59, v14
  v_and_b32 v59, v59, v15
  v_mfma_f32_16x16x32_bf16 v[80:83], v[60:63], a[112:115], v[80:83]
  v_mfma_f32_16x16x32_bf16 v[84:87], v[60:63], a[116:119], v[84:87]
  v_mfma_f32_16x16x32_bf16 v[76:79], v[56:59], a[120:123], v[76:79]
  v_perm_b32 v63, v69, v69, s77
  v_and_b32 v60, v63, v12
  v_and_b32 v61, v63, v13
  v_and_b32 v62, v63, v14
  v_and_b32 v63, v63, v15
  v_mfma_f32_16x16x32_bf16 v[80:83], v[56:59], a[124:127], v[80:83]
  v_mfma_f32_16x16x32_bf16 v[84:87], v[56:59], a[128:131], v[84:87]
  v_mfma_f32_16x16x32_bf16 v[76:79], v[60:63], a[132:135], v[76:79]
  v_perm_b32 v59, v70, v70, s76
  v_and_b32 v56, v59, v12
  v_and_b32 v57, v59, v13
  v_and_b32 v58, v59, v14
  v_and_b32 v59, v59, v15
  v_mfma_f32_16x16x32_bf16 v[80:83], v[60:63], a[136:139], v[80:83]
  v_mfma_f32_16x16x32_bf16 v[84:87], v[60:63], a[140:143], v[84:87]
  v_mfma_f32_16x16x32_bf16 v[76:79], v[56:59], a[144:147], v[76:79]
  v_perm_b32 v63, v70, v70, s77
  v_and_b32 v60, v63, v12
  v_and_b32 v61, v63, v13
  v_and_b32 v62, v63, v14
  v_and_b32 v63, v63, v15
  v_mfma_f32_16x16x32_bf16 v[80:83], v[56:59], a[148:151], v[80:83]
  v_mfma_f32_16x16x32_bf16 v[84:87], v[56:59], a[152:155], v[84:87]
  v_mfma_f32_16x16x32_bf16 v[76:79], v[60:63], a[156:159], v[76:79]
  v_perm_b32 v59, v71, v71, s76
  v_and_b32 v56, v59, v12
  v_and_b32 v57, v59, v13
  v_and_b32 v58, v59, v14
  v_and_b32 v59, v59, v15
  v_mfma_f32_16x16x32_bf16 v[80:83], v[60:63], a[160:163], v[80:83]
  v_mfma_f32_16x16x32_bf16 v[84:87], v[60:63], a[164:167], v[84:87]
  v_mfma_f32_16x16x32_bf16 v[76:79], v[56:59], a[168:171], v[76:79]
  v_perm_b32 v63, v71, v71, s77
  v_and_b32 v60, v63, v12
  v_and_b32 v61, v63, v13
  v_and_b32 v62, v63, v14
  v_and_b32 v63, v63, v15
  v_mfma_f32_16x16x32_bf16 v[80:83], v[56:59], a[172:175], v[80:83]
  v_mfma_f32_16x16x32_bf16 v[84:87], v[56:59], a[176:179], v[84:87]
  v_mfma_f32_16x16x32_bf16 v[76:79], v[60:63], a[180:183], v[76:79]
  v_perm_b32 v59, v72, v72, s76
  v_and_b32 v56, v59, v12
  v_and_b32 v57, v59, v13
  v_and_b32 v58, v59, v14
  v_and_b32 v59, v59, v15
  v_mfma_f32_16x16x32_bf16 v[80:83], v[60:63], a[184:187], v[80:83]
  v_mfma_f32_16x16x32_bf16 v[84:87], v[60:63], a[188:191], v[84:87]
  v_mfma_f32_16x16x32_bf16 v[76:79], v[56:59], a[192:195], v[76:79]
  v_perm_b32 v63, v72, v72, s77
  v_and_b32 v60, v63, v12
  v_and_b32 v61, v63, v13
  v_and_b32 v62, v63, v14
  v_and_b32 v63, v63, v15
  v_mfma_f32_16x16x32_bf16 v[80:83], v[56:59], a[196:199], v[80:83]
  v_mfma_f32_16x16x32_bf16 v[84:87], v[56:59], a[200:203], v[84:87]
  v_mfma_f32_16x16x32_bf16 v[76:79], v[60:63], a[204:207], v[76:79]
  v_perm_b32 v59, v73, v73, s76
  v_and_b32 v56, v59, v12
  v_and_b32 v57, v59, v13
  v_and_b32 v58, v59, v14
  v_and_b32 v59, v59, v15
  v_mfma_f32_16x16x32_bf16 v[80:83], v[60:63], a[208:211], v[80:83]
  v_mfma_f32_16x16x32_bf16 v[84:87], v[60:63], a[212:215], v[84:87]
  v_mfma_f32_16x16x32_bf16 v[76:79], v[56:59], a[216:219], v[76:79]
  v_perm_b32 v63, v73, v73, s77
  v_and_b32 v60, v63, v12
  v_and_b32 v61, v63, v13
  v_and_b32 v62, v63, v14
  v_and_b32 v63, v63, v15
  v_mfma_f32_16x16x32_bf16 v[80:83], v[56:59], a[220:223], v[80:83]
  v_mfma_f32_16x16x32_bf16 v[84:87], v[56:59], a[224:227], v[84:87]
  v_mfma_f32_16x16x32_bf16 v[76:79], v[60:63], a[228:231], v[76:79]
  v_perm_b32 v59, v74, v74, s76
  v_and_b32 v56, v59, v12
  v_and_b32 v57, v59, v13
  v_and_b32 v58, v59, v14
  v_and_b32 v59, v59, v15
  v_mfma_f32_16x16x32_bf16 v[80:83], v[60:63], a[232:235], v[80:83]
  v_mfma_f32_16x16x32_bf16 v[84:87], v[60:63], a[236:239], v[84:87]
  s_waitcnt vmcnt(9)
  v_mfma_f32_16x16x32_bf16 v[76:79], v[56:59], a[240:243], v[76:79]
  v_perm_b32 v63, v74, v74, s77
  v_and_b32 v60, v63, v12
  v_and_b32 v61, v63, v13
  v_and_b32 v62, v63, v14
  v_and_b32 v63, v63, v15
  v_mfma_f32_16x16x32_bf16 v[80:83], v[56:59], a[244:247], v[80:83]
  v_mfma_f32_16x16x32_bf16 v[84:87], v[56:59], a[248:251], v[84:87]
  s_waitcnt vmcnt(6)
  v_mfma_f32_16x16x32_bf16 v[76:79], v[60:63], a[252:255], v[76:79]
  v_perm_b32 v59, v75, v75, s76
  v_and_b32 v56, v59, v12
  v_and_b32 v57, v59, v13
  v_and_b32 v58, v59, v14
  v_and_b32 v59, v59, v15
  v_mfma_f32_16x16x32_bf16 v[80:83], v[60:63], v[224:227], v[80:83]
  v_mfma_f32_16x16x32_bf16 v[84:87], v[60:63], v[228:231], v[84:87]
  s_waitcnt vmcnt(3)
  v_mfma_f32_16x16x32_bf16 v[76:79], v[56:59], v[232:235], v[76:79]
  v_perm_b32 v63, v75, v75, s77
  v_and_b32 v60, v63, v12
  v_and_b32 v61, v63, v13
  v_and_b32 v62, v63, v14
  v_and_b32 v63, v63, v15
  v_mfma_f32_16x16x32_bf16 v[80:83], v[56:59], v[236:239], v[80:83]
  v_mfma_f32_16x16x32_bf16 v[84:87], v[56:59], v[240:243], v[84:87]
  s_waitcnt vmcnt(0)
  v_mfma_f32_16x16x32_bf16 v[76:79], v[60:63], v[244:247], v[76:79]
  v_mfma_f32_16x16x32_bf16 v[80:83], v[60:63], v[248:251], v[80:83]
  v_mfma_f32_16x16x32_bf16 v[84:87], v[60:63], v[252:255], v[84:87]
  s_nop 7
  v_permlane32_swap_b32 v76, v80
  v_permlane32_swap_b32 v77, v81
  v_permlane32_swap_b32 v78, v82
  v_permlane32_swap_b32 v79, v83
  v_permlane32_swap_b32 v84, v88
  v_permlane32_swap_b32 v85, v89
  v_permlane32_swap_b32 v86, v90
  v_permlane32_swap_b32 v87, v91
  v_add_f32_dpp v76, v80, v76 row_ror:8 row_mask:0xf bank_mask:0xf
  v_add_f32_dpp v77, v81, v77 row_ror:8 row_mask:0xf bank_mask:0xf
  v_add_f32_dpp v78, v82, v78 row_ror:8 row_mask:0xf bank_mask:0xf
  v_add_f32_dpp v79, v83, v79 row_ror:8 row_mask:0xf bank_mask:0xf
  v_add_f32_dpp v84, v88, v84 row_ror:8 row_mask:0xf bank_mask:0xf
  v_add_f32_dpp v85, v89, v85 row_ror:8 row_mask:0xf bank_mask:0xf
  v_add_f32_dpp v86, v90, v86 row_ror:8 row_mask:0xf bank_mask:0xf
  v_add_f32_dpp v87, v91, v87 row_ror:8 row_mask:0xf bank_mask:0xf
  s_mov_b32 exec_lo, 0x00ff00ff
  s_mov_b32 exec_hi, 0x00ff00ff
  buffer_store_dwordx4 v[76:79], v1, s[64:67], s12 offen sc1
  s_mov_b32 exec_hi, 0
  s_cmp_ge_u32 s3, 2
  s_cbranch_scc1 L_no3
  buffer_store_dwordx4 v[84:87], v1, s[64:67], s12 offen offset:512 sc1
L_no3:
  s_mov_b32 exec_lo, 1
  s_waitcnt vmcnt(0)
  buffer_atomic_add v42, v41, s[64:67], 0 offen sc0 sc1
  s_waitcnt vmcnt(0)
  v_readfirstlane_b32 s11, v42
  s_mov_b64 exec, -1
  s_cmp_lg_u32 s11, 31
  s_cbranch_scc1 L_done
  s_cmp_lt_u32 s3, 2
  s_cselect_b32 exec_hi, 0xffff, 0
  buffer_load_dwordx4 v[96:99], v40, s[64:67], s14 offen offset:0 sc1
  buffer_load_dwordx4 v[100:103], v40, s[64:67], s14 offen offset:768 sc1
  buffer_load_dwordx4 v[104:107], v40, s[64:67], s14 offen offset:1536 sc1
  buffer_load_dwordx4 v[108:111], v40, s[64:67], s14 offen offset:2304 sc1
  s_add_u32 s14, s14, 3072
  buffer_load_dwordx4 v[112:115], v40, s[64:67], s14 offen offset:0 sc1
  buffer_load_dwordx4 v[116:119], v40, s[64:67], s14 offen offset:768 sc1
  buffer_load_dwordx4 v[120:123], v40, s[64:67], s14 offen offset:1536 sc1
  buffer_load_dwordx4 v[124:127], v40, s[64:67], s14 offen offset:2304 sc1
  s_add_u32 s14, s14, 3072
  buffer_load_dwordx4 v[128:131], v40, s[64:67], s14 offen offset:0 sc1
  buffer_load_dwordx4 v[132:135], v40, s[64:67], s14 offen offset:768 sc1
  buffer_load_dwordx4 v[136:139], v40, s[64:67], s14 offen offset:1536 sc1
  buffer_load_dwordx4 v[140:143], v40, s[64:67], s14 offen offset:2304 sc1
  s_add_u32 s14, s14, 3072
  buffer_load_dwordx4 v[144:147], v40, s[64:67], s14 offen offset:0 sc1
  buffer_load_dwordx4 v[148:151], v40, s[64:67], s14 offen offset:768 sc1
  buffer_load_dwordx4 v[152:155], v40, s[64:67], s14 offen offset:1536 sc1
  buffer_load_dwordx4 v[156:159], v40, s[64:67], s14 offen offset:2304 sc1
  s_add_u32 s14, s14, 3072
  buffer_load_dwordx4 v[160:163], v40, s[64:67], s14 offen offset:0 sc1
  buffer_load_dwordx4 v[164:167], v40, s[64:67], s14 offen offset:768 sc1
  buffer_load_dwordx4 v[168:171], v40, s[64:67], s14 offen offset:1536 sc1
  buffer_load_dwordx4 v[172:175], v40, s[64:67], s14 offen offset:2304 sc1
  s_add_u32 s14, s14, 3072
  buffer_load_dwordx4 v[176:179], v40, s[64:67], s14 offen offset:0 sc1
  buffer_load_dwordx4 v[180:183], v40, s[64:67], s14 offen offset:768 sc1
  buffer_load_dwordx4 v[184:187], v40, s[64:67], s14 offen offset:1536 sc1
  buffer_load_dwordx4 v[188:191], v40, s[64:67], s14 offen offset:2304 sc1
  s_add_u32 s14, s14, 3072
  buffer_load_dwordx4 v[192:195], v40, s[64:67], s14 offen offset:0 sc1
  buffer_load_dwordx4 v[196:199], v40, s[64:67], s14 offen offset:768 sc1
  buffer_load_dwordx4 v[200:203], v40, s[64:67], s14 offen offset:1536 sc1
  buffer_load_dwordx4 v[204:207], v40, s[64:67], s14 offen offset:2304 sc1
  s_add_u32 s14, s14, 3072
  buffer_load_dwordx4 v[208:211], v40, s[64:67], s14 offen offset:0 sc1
  buffer_load_dwordx4 v[212:215], v40, s[64:67], s14 offen offset:768 sc1
  buffer_load_dwordx4 v[216:219], v40, s[64:67], s14 offen offset:1536 sc1
  buffer_load_dwordx4 v[220:223], v40, s[64:67], s14 offen offset:2304 sc1
  s_add_u32 s14, s14, 3072
  s_mul_i32 s11, s4, 2560
  s_mul_i32 s12, s6, 1280
  s_add_u32 s11, s11, s12
  s_lshl_b32 s12, s42, 7
  s_add_u32 s11, s11, s12
  s_waitcnt vmcnt(24)
  v_pk_add_f32 v[96:97], v[96:97], v[112:113]
  v_pk_add_f32 v[98:99], v[98:99], v[114:115]
  v_pk_add_f32 v[100:101], v[100:101], v[116:117]
  v_pk_add_f32 v[102:103], v[102:103], v[118:119]
  v_pk_add_f32 v[104:105], v[104:105], v[120:121]
  v_pk_add_f32 v[106:107], v[106:107], v[122:123]
  v_pk_add_f32 v[108:109], v[108:109], v[124:125]
  v_pk_add_f32 v[110:111], v[110:111], v[126:127]
  s_waitcnt vmcnt(20)
  v_pk_add_f32 v[96:97], v[96:97], v[128:129]
  v_pk_add_f32 v[98:99], v[98:99], v[130:131]
  v_pk_add_f32 v[100:101], v[100:101], v[132:133]
  v_pk_add_f32 v[102:103], v[102:103], v[134:135]
  v_pk_add_f32 v[104:105], v[104:105], v[136:137]
  v_pk_add_f32 v[106:107], v[106:107], v[138:139]
  v_pk_add_f32 v[108:109], v[108:109], v[140:141]
  v_pk_add_f32 v[110:111], v[110:111], v[142:143]
  s_waitcnt vmcnt(16)
  v_pk_add_f32 v[96:97], v[96:97], v[144:145]
  v_pk_add_f32 v[98:99], v[98:99], v[146:147]
  v_pk_add_f32 v[100:101], v[100:101], v[148:149]
  v_pk_add_f32 v[102:103], v[102:103], v[150:151]
  v_pk_add_f32 v[104:105], v[104:105], v[152:153]
  v_pk_add_f32 v[106:107], v[106:107], v[154:155]
  v_pk_add_f32 v[108:109], v[108:109], v[156:157]
  v_pk_add_f32 v[110:111], v[110:111], v[158:159]
  s_waitcnt vmcnt(12)
  v_pk_add_f32 v[96:97], v[96:97], v[160:161]
  v_pk_add_f32 v[98:99], v[98:99], v[162:163]
  v_pk_add_f32 v[100:101], v[100:101], v[164:165]
  v_pk_add_f32 v[102:103], v[102:103], v[166:167]
  v_pk_add_f32 v[104:105], v[104:105], v[168:169]
  v_pk_add_f32 v[106:107], v[106:107], v[170:171]
  v_pk_add_f32 v[108:109], v[108:109], v[172:173]
  v_pk_add_f32 v[110:111], v[110:111], v[174:175]
  s_waitcnt vmcnt(8)
  v_pk_add_f32 v[96:97], v[96:97], v[176:177]
  v_pk_add_f32 v[98:99], v[98:99], v[178:179]
  v_pk_add_f32 v[100:101], v[100:101], v[180:181]
  v_pk_add_f32 v[102:103], v[102:103], v[182:183]
  v_pk_add_f32 v[104:105], v[104:105], v[184:185]
  v_pk_add_f32 v[106:107], v[106:107], v[186:187]
  v_pk_add_f32 v[108:109], v[108:109], v[188:189]
  v_pk_add_f32 v[110:111], v[110:111], v[190:191]
  s_waitcnt vmcnt(4)
  v_pk_add_f32 v[96:97], v[96:97], v[192:193]
  v_pk_add_f32 v[98:99], v[98:99], v[194:195]
  v_pk_add_f32 v[100:101], v[100:101], v[196:197]
  v_pk_add_f32 v[102:103], v[102:103], v[198:199]
  v_pk_add_f32 v[104:105], v[104:105], v[200:201]
  v_pk_add_f32 v[106:107], v[106:107], v[202:203]
  v_pk_add_f32 v[108:109], v[108:109], v[204:205]
  v_pk_add_f32 v[110:111], v[110:111], v[206:207]
  s_waitcnt vmcnt(0)
  v_pk_add_f32 v[96:97], v[96:97], v[208:209]
  v_pk_add_f32 v[98:99], v[98:99], v[210:211]
  v_pk_add_f32 v[100:101], v[100:101], v[212:213]
  v_pk_add_f32 v[102:103], v[102:103], v[214:215]
  v_pk_add_f32 v[104:105], v[104:105], v[216:217]
  v_pk_add_f32 v[106:107], v[106:107], v[218:219]
  v_pk_add_f32 v[108:109], v[108:109], v[220:221]
  v_pk_add_f32 v[110:111], v[110:111], v[222:223]
  v_pk_add_f32 v[96:97], v[96:97], v[100:101]
  v_pk_add_f32 v[98:99], v[98:99], v[102:103]
  v_pk_add_f32 v[104:105], v[104:105], v[108:109]
  v_pk_add_f32 v[106:107], v[106:107], v[110:111]
  v_pk_add_f32 v[96:97], v[96:97], v[104:105]
  v_pk_add_f32 v[98:99], v[98:99], v[106:107]
  v_cvt_pk_bf16_f32 v96, v96, v97
  v_cvt_pk_bf16_f32 v97, v98, v99
  buffer_store_dwordx2 v[96:97], v7, s[68:71], s11 offen
L_done:
L_end:
  s_endpgm
L_ts4:
  s_waitcnt vmcnt(4)
  s_cmp_gt_u32 s22, 8
  s_cbranch_scc0 L_th4
  s_waitcnt vmcnt(3)
  s_branch L_th4
L_ts5:
  s_cmp_gt_u32 s22, 4
  s_cbranch_scc0 L_th5
  s_waitcnt vmcnt(4)
  s_branch L_th5
L_ts6:
  s_cmp_gt_u32 s22, 2
  s_cbranch_scc0 L_th6
  s_waitcnt vmcnt(4)
  s_cmp_gt_u32 s22, 10
  s_cbranch_scc0 L_th6
  s_waitcnt vmcnt(3)
  s_branch L_th6
L_ts7:
  s_cmp_gt_u32 s22, 6
  s_cbranch_scc0 L_th7
  s_waitcnt vmcnt(4)
  s_branch L_th7
L_ts8:
  s_cmp_gt_u32 s22, 1
  s_cbranch_scc0 L_th8
  s_waitcnt vmcnt(4)
  s_cmp_gt_u32 s22, 9
  s_cbranch_scc0 L_th8
  s_waitcnt vmcnt(3)
  s_branch L_th8
L_ts9:
  s_cmp_gt_u32 s22, 5
  s_cbranch_scc0 L_th9
  s_waitcnt vmcnt(4)
  s_branch L_th9
L_ts10:
  s_cmp_gt_u32 s22, 3
  s_cbranch_scc0 L_th10
  s_waitcnt vmcnt(12)
  s_cmp_gt_u32 s22, 11
  s_cbranch_scc0 L_th10
  s_waitcnt vmcnt(11)
  s_branch L_th10
L_ts11:
  s_cmp_gt_u32 s22, 7
  s_cbranch_scc0 L_th11
  s_waitcnt vmcnt(12)
  s_branch L_th11
L_ts12:
  s_waitcnt vmcnt(12)
  s_cmp_gt_u32 s22, 8
  s_cbranch_scc0 L_th12
  s_waitcnt vmcnt(11)
  s_branch L_th12
L_ts13:
  s_cmp_gt_u32 s22, 4
  s_cbranch_scc0 L_th13
  s_waitcnt vmcnt(14)
  s_branch L_th13
L_ts14:
  s_cmp_gt_u32 s22, 2
  s_cbranch_scc0 L_th14
  s_waitcnt vmcnt(14)
  s_cmp_gt_u32 s22, 10
  s_cbranch_scc0 L_th14
  s_waitcnt vmcnt(5)
  s_branch L_th14
L_ts15:
  s_cmp_gt_u32 s22, 6
  s_cbranch_scc0 L_th15
  s_waitcnt vmcnt(6)
  s_branch L_th15
L_ts16:
  s_cmp_gt_u32 s22, 1
  s_cbranch_scc0 L_th16
  s_waitcnt vmcnt(8)
  s_cmp_gt_u32 s22, 9
  s_cbranch_scc0 L_th16
  s_waitcnt vmcnt(7)
  s_branch L_th16
L_ts17:
  s_cmp_gt_u32 s22, 5
  s_cbranch_scc0 L_th17
  s_waitcnt vmcnt(8)
  s_branch L_th17
L_ts18:
  s_cmp_gt_u32 s22, 3
  s_cbranch_scc0 L_th18
  s_waitcnt vmcnt(6)
  s_cmp_gt_u32 s22, 11
  s_cbranch_scc0 L_th18
  s_waitcnt vmcnt(5)
  s_branch L_th18
L_ts19:
  s_cmp_gt_u32 s22, 7
  s_cbranch_scc0 L_th19
  s_waitcnt vmcnt(8)
  s_branch L_th19
L_ts20:
  s_waitcnt vmcnt(8)
  s_cmp_gt_u32 s22, 8
  s_cbranch_scc0 L_th20
  s_waitcnt vmcnt(5)
  s_branch L_th20
L_ts21:
  s_cmp_gt_u32 s22, 4
  s_cbranch_scc0 L_th21
  s_waitcnt vmcnt(6)
  s_branch L_th21
L_ts22:
  s_cmp_gt_u32 s22, 2
  s_cbranch_scc0 L_th22
  s_waitcnt vmcnt(8)
  s_cmp_gt_u32 s22, 10
  s_cbranch_scc0 L_th22
  s_waitcnt vmcnt(7)
  s_branch L_th22
L_ts23:
  s_cmp_gt_u32 s22, 6
  s_cbranch_scc0 L_th23
  s_waitcnt vmcnt(8)
  s_branch L_th23
L_ts24:
  s_cmp_gt_u32 s22, 1
  s_cbranch_scc0 L_th24
  s_waitcnt vmcnt(6)
  s_cmp_gt_u32 s22, 9
  s_cbranch_scc0 L_th24
  s_waitcnt vmcnt(5)
  s_branch L_th24
L_ts25:
  s_cmp_gt_u32 s22, 5
  s_cbranch_scc0 L_th25
  s_waitcnt vmcnt(8)
  s_branch L_th25
L_ts26:
  s_cmp_gt_u32 s22, 3
  s_cbranch_scc0 L_th26
  s_waitcnt vmcnt(8)
  s_cmp_gt_u32 s22, 11
  s_cbranch_scc0 L_th26
  s_waitcnt vmcnt(5)
  s_branch L_th26
L_ts27:
  s_cmp_gt_u32 s22, 7
  s_cbranch_scc0 L_th27
  s_waitcnt vmcnt(6)
  s_branch L_th27
L_ts28:
  s_waitcnt vmcnt(8)
  s_cmp_gt_u32 s22, 8
  s_cbranch_scc0 L_th28
  s_waitcnt vmcnt(7)
  s_branch L_th28
L_ts29:
  s_cmp_gt_u32 s22, 4
  s_cbranch_scc0 L_th29
  s_waitcnt vmcnt(8)
  s_branch L_th29
L_ts30:
  s_cmp_gt_u32 s22, 2
  s_cbranch_scc0 L_th30
  s_waitcnt vmcnt(6)
  s_cmp_gt_u32 s22, 10
  s_cbranch_scc0 L_th30
  s_waitcnt vmcnt(5)
  s_branch L_th30
L_ts31:
  s_cmp_gt_u32 s22, 6
  s_cbranch_scc0 L_th31
  s_waitcnt vmcnt(8)
  s_branch L_th31
L_ts32:
  s_cmp_gt_u32 s22, 1
  s_cbranch_scc0 L_th32
  s_waitcnt vmcnt(8)
  s_cmp_gt_u32 s22, 9
  s_cbranch_scc0 L_th32
  s_waitcnt vmcnt(5)
  s_branch L_th32
L_ts33:
  s_cmp_gt_u32 s22, 5
  s_cbranch_scc0 L_th33
  s_waitcnt vmcnt(6)
  s_branch L_th33
L_ts34:
  s_cmp_gt_u32 s22, 3
  s_cbranch_scc0 L_th34
  s_waitcnt vmcnt(8)
  s_cmp_gt_u32 s22, 11
  s_cbranch_scc0 L_th34
  s_waitcnt vmcnt(7)
  s_branch L_th34
L_ts35:
  s_cmp_gt_u32 s22, 7
  s_cbranch_scc0 L_th35
  s_waitcnt vmcnt(8)
  s_branch L_th35
L_ts36:
  s_waitcnt vmcnt(6)
  s_cmp_gt_u32 s22, 8
  s_cbranch_scc0 L_th36
  s_waitcnt vmcnt(5)
  s_branch L_th36
L_ts37:
  s_cmp_gt_u32 s22, 4
  s_cbranch_scc0 L_th37
  s_waitcnt vmcnt(8)
  s_branch L_th37
L_ts38:
  s_cmp_gt_u32 s22, 2
  s_cbranch_scc0 L_th38
  s_waitcnt vmcnt(8)
  s_cmp_gt_u32 s22, 10
  s_cbranch_scc0 L_th38
  s_waitcnt vmcnt(5)
  s_branch L_th38
L_ts39:
  s_cmp_gt_u32 s22, 6
  s_cbranch_scc0 L_th39
  s_waitcnt vmcnt(6)
  s_branch L_th39
L_ts40:
  s_cmp_gt_u32 s22, 1
  s_cbranch_scc0 L_th40
  s_waitcnt vmcnt(14)
  s_cmp_gt_u32 s22, 9
  s_cbranch_scc0 L_th40
  s_waitcnt vmcnt(13)
  s_branch L_th40
L_ts41:
  s_cmp_gt_u32 s22, 5
  s_cbranch_scc0 L_th41
  s_waitcnt vmcnt(14)
  s_branch L_th41
L_ts42:
  s_cmp_gt_u32 s22, 3
  s_cbranch_scc0 L_th42
  s_waitcnt vmcnt(12)
  s_cmp_gt_u32 s22, 11
  s_cbranch_scc0 L_th42
  s_waitcnt vmcnt(11)
  s_branch L_th42
L_ts43:
  s_cmp_gt_u32 s22, 7
  s_cbranch_scc0 L_th43
  s_waitcnt vmcnt(14)
  s_branch L_th43
L_ts44:
  s_waitcnt vmcnt(14)
  s_cmp_gt_u32 s22, 8
  s_cbranch_scc0 L_th44
  s_waitcnt vmcnt(5)
  s_branch L_th44
L_ts45:
  s_cmp_gt_u32 s22, 4
  s_cbranch_scc0 L_th45
  s_waitcnt vmcnt(6)
  s_branch L_th45
L_ts46:
  s_cmp_gt_u32 s22, 2
  s_cbranch_scc0 L_th46
  s_waitcnt vmcnt(8)
  s_cmp_gt_u32 s22, 10
  s_cbranch_scc0 L_th46
  s_waitcnt vmcnt(7)
  s_branch L_th46
L_ts47:
  s_cmp_gt_u32 s22, 6
  s_cbranch_scc0 L_th47
  s_waitcnt vmcnt(8)
  s_branch L_th47
L_ts48:
  s_cmp_gt_u32 s22, 1
  s_cbranch_scc0 L_th48
  s_waitcnt vmcnt(6)
  s_cmp_gt_u32 s22, 9
  s_cbranch_scc0 L_th48
  s_waitcnt vmcnt(5)
  s_branch L_th48
L_ts49:
  s_cmp_gt_u32 s22, 5
  s_cbranch_scc0 L_th49
  s_waitcnt vmcnt(8)
  s_branch L_th49
L_ts50:
  s_cmp_gt_u32 s22, 3
  s_cbranch_scc0 L_th50
  s_waitcnt vmcnt(8)
  s_cmp_gt_u32 s22, 11
  s_cbranch_scc0 L_th50
  s_waitcnt vmcnt(5)
  s_branch L_th50
L_ts51:
  s_cmp_gt_u32 s22, 7
  s_cbranch_scc0 L_th51
  s_waitcnt vmcnt(6)
  s_branch L_th51
L_ts52:
  s_waitcnt vmcnt(8)
  s_cmp_gt_u32 s22, 8
  s_cbranch_scc0 L_th52
  s_waitcnt vmcnt(7)
  s_branch L_th52
L_ts53:
  s_cmp_gt_u32 s22, 4
  s_cbranch_scc0 L_th53
  s_waitcnt vmcnt(8)
  s_branch L_th53
L_ts54:
  s_cmp_gt_u32 s22, 2
  s_cbranch_scc0 L_th54
  s_waitcnt vmcnt(6)
  s_cmp_gt_u32 s22, 10
  s_cbranch_scc0 L_th54
  s_waitcnt vmcnt(5)
  s_branch L_th54
L_ts55:
  s_cmp_gt_u32 s22, 6
  s_cbranch_scc0 L_th55
  s_waitcnt vmcnt(8)
  s_branch L_th55
L_ts56:
  s_cmp_gt_u32 s22, 1
  s_cbranch_scc0 L_th56
  s_waitcnt vmcnt(8)
  s_cmp_gt_u32 s22, 9
  s_cbranch_scc0 L_th56
  s_waitcnt vmcnt(5)
  s_branch L_th56
L_ts57:
  s_cmp_gt_u32 s22, 5
  s_cbranch_scc0 L_th57
  s_waitcnt vmcnt(6)
  s_branch L_th57
L_ts58:
  s_cmp_gt_u32 s22, 3
  s_cbranch_scc0 L_th58
  s_waitcnt vmcnt(8)
  s_cmp_gt_u32 s22, 11
  s_cbranch_scc0 L_th58
  s_waitcnt vmcnt(7)
  s_branch L_th58
L_ts59:
  s_cmp_gt_u32 s22, 7
  s_cbranch_scc0 L_th59
  s_waitcnt vmcnt(8)
  s_branch L_th59
L_ts60:
  s_waitcnt vmcnt(6)
  s_cmp_gt_u32 s22, 8
  s_cbranch_scc0 L_th60
  s_waitcnt vmcnt(5)
  s_branch L_th60
L_ts61:
  s_cmp_gt_u32 s22, 4
  s_cbranch_scc0 L_th61
  s_waitcnt vmcnt(8)
  s_branch L_th61
L_ts62:
  s_cmp_gt_u32 s22, 2
  s_cbranch_scc0 L_th62
  s_waitcnt vmcnt(8)
  s_cmp_gt_u32 s22, 10
  s_cbranch_scc0 L_th62
  s_waitcnt vmcnt(5)
  s_branch L_th62
L_ts63:
  s_cmp_gt_u32 s22, 6
  s_cbranch_scc0 L_th63
  s_waitcnt vmcnt(6)
  s_branch L_th63
L_ts64:
  s_cmp_gt_u32 s22, 1
  s_cbranch_scc0 L_th64
  s_waitcnt vmcnt(8)
  s_cmp_gt_u32 s22, 9
  s_cbranch_scc0 L_th64
  s_waitcnt vmcnt(7)
  s_branch L_th64
L_ts66:
  s_cmp_gt_u32 s22, 5
  s_cbranch_scc0 L_th66
  s_waitcnt vmcnt(8)
  s_branch L_th66
L_ts67:
  s_cmp_gt_u32 s22, 3
  s_cbranch_scc0 L_th67
  s_waitcnt vmcnt(6)
  s_cmp_gt_u32 s22, 11
  s_cbranch_scc0 L_th67
  s_waitcnt vmcnt(5)
  s_branch L_th67
L_ts68:
  s_cmp_gt_u32 s22, 7
  s_cbranch_scc0 L_th68
  s_waitcnt vmcnt(8)
  s_branch L_th68
L_ts69:
  s_waitcnt vmcnt(8)
  s_cmp_gt_u32 s22, 8
  s_cbranch_scc0 L_th69
  s_waitcnt vmcnt(5)
  s_branch L_th69
L_ts70:
  s_cmp_gt_u32 s22, 4
  s_cbranch_scc0 L_th70
  s_waitcnt vmcnt(6)
  s_branch L_th70
L_ts74:
  s_cmp_gt_u32 s22, 2
  s_cbranch_scc0 L_th74
  s_waitcnt vmcnt(8)
  s_cmp_gt_u32 s22, 10
  s_cbranch_scc0 L_th74
  s_waitcnt vmcnt(7)
  s_branch L_th74
L_ts75:
  s_cmp_gt_u32 s22, 6
  s_cbranch_scc0 L_th75
  s_waitcnt vmcnt(8)
  s_branch L_th75
L_ts76:
  s_cmp_gt_u32 s22, 1
  s_cbranch_scc0 L_th76
  s_waitcnt vmcnt(6)
  s_cmp_gt_u32 s22, 9
  s_cbranch_scc0 L_th76
  s_waitcnt vmcnt(5)
  s_branch L_th76
L_ts77:
  s_cmp_gt_u32 s22, 5
  s_cbranch_scc0 L_th77
  s_waitcnt vmcnt(8)
  s_branch L_th77
L_ts78:
  s_cmp_gt_u32 s22, 3
  s_cbranch_scc0 L_th78
  s_waitcnt vmcnt(8)
  s_cmp_gt_u32 s22, 11
  s_cbranch_scc0 L_th78
  s_waitcnt vmcnt(5)
  s_branch L_th78
L_ts79:
  s_cmp_gt_u32 s22, 7
  s_cbranch_scc0 L_th79
  s_waitcnt vmcnt(6)
  s_branch L_th79
L_ts80:
  s_waitcnt vmcnt(8)
  s_cmp_gt_u32 s22, 8
  s_cbranch_scc0 L_th80
  s_waitcnt vmcnt(7)
  s_branch L_th80
L_ts81:
  s_cmp_gt_u32 s22, 4
  s_cbranch_scc0 L_th81
  s_waitcnt vmcnt(8)
  s_branch L_th81
L_ts82:
  s_cmp_gt_u32 s22, 2
  s_cbranch_scc0 L_th82
  s_waitcnt vmcnt(6)
  s_cmp_gt_u32 s22, 10
  s_cbranch_scc0 L_th82
  s_waitcnt vmcnt(5)
  s_branch L_th82
L_ts83:
  s_cmp_gt_u32 s22, 6
  s_cbranch_scc0 L_th83
  s_waitcnt vmcnt(8)
  s_branch L_th83
L_ts84:
  s_cmp_gt_u32 s22, 1
  s_cbranch_scc0 L_th84
  s_waitcnt vmcnt(8)
  s_cmp_gt_u32 s22, 9
  s_cbranch_scc0 L_th84
  s_waitcnt vmcnt(5)
  s_branch L_th84
L_ts85:
  s_cmp_gt_u32 s22, 5
  s_cbranch_scc0 L_th85
  s_waitcnt vmcnt(6)
  s_branch L_th85
L_ts86:
  s_cmp_gt_u32 s22, 3
  s_cbranch_scc0 L_th86
  s_waitcnt vmcnt(8)
  s_cmp_gt_u32 s22, 11
  s_cbranch_scc0 L_th86
  s_waitcnt vmcnt(7)
  s_branch L_th86
L_ts87:
  s_cmp_gt_u32 s22, 7
  s_cbranch_scc0 L_th87
  s_waitcnt vmcnt(8)
  s_branch L_th87
L_ts88:
  s_waitcnt vmcnt(6)
  s_cmp_gt_u32 s22, 8
  s_cbranch_scc0 L_th88
  s_waitcnt vmcnt(5)
  s_branch L_th88
L_ts89:
  s_cmp_gt_u32 s22, 4
  s_cbranch_scc0 L_th89
  s_waitcnt vmcnt(8)
  s_branch L_th89
L_ts90:
  s_cmp_gt_u32 s22, 2
  s_cbranch_scc0 L_th90
  s_waitcnt vmcnt(8)
  s_cmp_gt_u32 s22, 10
  s_cbranch_scc0 L_th90
  s_waitcnt vmcnt(5)
  s_branch L_th90
L_ts91:
  s_cmp_gt_u32 s22, 6
  s_cbranch_scc0 L_th91
  s_waitcnt vmcnt(6)
  s_branch L_th91
L_ts92:
  s_cmp_gt_u32 s22, 1
  s_cbranch_scc0 L_th92
  s_waitcnt vmcnt(8)
  s_cmp_gt_u32 s22, 9
  s_cbranch_scc0 L_th92
  s_waitcnt vmcnt(7)
  s_branch L_th92
L_ts93:
  s_cmp_gt_u32 s22, 5
  s_cbranch_scc0 L_th93
  s_waitcnt vmcnt(8)
  s_branch L_th93
L_ts94:
  s_cmp_gt_u32 s22, 3
  s_cbranch_scc0 L_th94
  s_waitcnt vmcnt(6)
  s_cmp_gt_u32 s22, 11
  s_cbranch_scc0 L_th94
  s_waitcnt vmcnt(5)
  s_branch L_th94
L_ts95:
  s_cmp_gt_u32 s22, 7
  s_cbranch_scc0 L_th95
  s_waitcnt vmcnt(6)
  s_branch L_th95
L_ts96:
  s_waitcnt vmcnt(6)
  s_cmp_gt_u32 s22, 8
  s_cbranch_scc0 L_th96
  s_waitcnt vmcnt(3)
  s_branch L_th96
L_ts97:
  s_cmp_gt_u32 s22, 4
  s_cbranch_scc0 L_th97
  s_waitcnt vmcnt(4)
  s_branch L_th97
L_ts98:
  s_cmp_gt_u32 s22, 2
  s_cbranch_scc0 L_th98
  s_waitcnt vmcnt(4)
  s_cmp_gt_u32 s22, 10
  s_cbranch_scc0 L_th98
  s_waitcnt vmcnt(3)
  s_branch L_th98
L_ts99:
  s_cmp_gt_u32 s22, 6
  s_cbranch_scc0 L_th99
  s_waitcnt vmcnt(4)
  s_branch L_th99
L_ts100:
  s_cmp_gt_u32 s22, 1
  s_cbranch_scc0 L_th100
  s_waitcnt vmcnt(4)
  s_cmp_gt_u32 s22, 9
  s_cbranch_scc0 L_th100
  s_waitcnt vmcnt(3)
  s_branch L_th100
L_ts102:
  s_cmp_gt_u32 s22, 5
  s_cbranch_scc0 L_th102
  s_waitcnt vmcnt(4)
  s_branch L_th102
L_ts103:
  s_cmp_gt_u32 s22, 3
  s_cbranch_scc0 L_th103
  s_waitcnt vmcnt(4)
  s_cmp_gt_u32 s22, 11
  s_cbranch_scc0 L_th103
  s_waitcnt vmcnt(3)
  s_branch L_th103
L_ts104:
  s_cmp_gt_u32 s22, 7
  s_cbranch_scc0 L_th104
  s_waitcnt vmcnt(4)
  s_branch L_th104
L_ts105:
  s_waitcnt vmcnt(4)
  s_cmp_gt_u32 s22, 8
  s_cbranch_scc0 L_th105
  s_waitcnt vmcnt(3)
  s_branch L_th105
L_ts106:
  s_cmp_gt_u32 s22, 4
  s_cbranch_scc0 L_th106
  s_waitcnt vmcnt(4)
  s_branch L_th106
L_ts107:
  s_cmp_gt_u32 s22, 2
  s_cbranch_scc0 L_th107
  s_waitcnt vmcnt(4)
  s_cmp_gt_u32 s22, 10
  s_cbranch_scc0 L_th107
  s_waitcnt vmcnt(3)
  s_branch L_th107
L_ts108:
  s_cmp_gt_u32 s22, 6
  s_cbranch_scc0 L_th108
  s_waitcnt vmcnt(4)
  s_branch L_th108
L_ts109:
  s_cmp_gt_u32 s22, 1
  s_cbranch_scc0 L_th109
  s_waitcnt vmcnt(4)
  s_cmp_gt_u32 s22, 9
  s_cbranch_scc0 L_th109
  s_waitcnt vmcnt(3)
  s_branch L_th109
L_ts110:
  s_cmp_gt_u32 s22, 5
  s_cbranch_scc0 L_th110
  s_waitcnt vmcnt(4)
  s_branch L_th110
L_ts111:
  s_cmp_gt_u32 s22, 3
  s_cbranch_scc0 L_th111
  s_waitcnt vmcnt(4)
  s_cmp_gt_u32 s22, 11
  s_cbranch_scc0 L_th111
  s_waitcnt vmcnt(3)
  s_branch L_th111
L_ts112:
  s_cmp_gt_u32 s22, 7
  s_cbranch_scc0 L_th112
  s_waitcnt vmcnt(4)
  s_branch L_th112
L_ts113:
  s_waitcnt vmcnt(4)
  s_cmp_gt_u32 s22, 8
  s_cbranch_scc0 L_th113
  s_waitcnt vmcnt(3)
  s_branch L_th113
L_ts115:
  s_cmp_gt_u32 s22, 4
  s_cbranch_scc0 L_th115
  s_waitcnt vmcnt(4)
  s_branch L_th115
L_ts116:
  s_cmp_gt_u32 s22, 2
  s_cbranch_scc0 L_th116
  s_waitcnt vmcnt(4)
  s_cmp_gt_u32 s22, 10
  s_cbranch_scc0 L_th116
  s_waitcnt vmcnt(3)
  s_branch L_th116
L_ts117:
  s_cmp_gt_u32 s22, 6
  s_cbranch_scc0 L_th117
  s_waitcnt vmcnt(4)
  s_branch L_th117
L_ts118:
  s_cmp_gt_u32 s22, 1
  s_cbranch_scc0 L_th118
  s_waitcnt vmcnt(4)
  s_cmp_gt_u32 s22, 9
  s_cbranch_scc0 L_th118
  s_waitcnt vmcnt(3)
  s_branch L_th118
L_ts119:
  s_cmp_gt_u32 s22, 5
  s_cbranch_scc0 L_th119
  s_waitcnt vmcnt(4)
  s_branch L_th119
L_ts120:
  s_cmp_gt_u32 s22, 3
  s_cbranch_scc0 L_th120
  s_waitcnt vmcnt(4)
  s_cmp_gt_u32 s22, 11
  s_cbranch_scc0 L_th120
  s_waitcnt vmcnt(3)
  s_branch L_th120
L_ts121:
  s_cmp_gt_u32 s22, 7
  s_cbranch_scc0 L_th121
  s_waitcnt vmcnt(4)
  s_branch L_th121
L_ts122:
  s_waitcnt vmcnt(4)
  s_cmp_gt_u32 s22, 8
  s_cbranch_scc0 L_th122
  s_waitcnt vmcnt(3)
  s_branch L_th122
L_ts123:
  s_cmp_gt_u32 s22, 4
  s_cbranch_scc0 L_th123
  s_waitcnt vmcnt(4)
  s_branch L_th123
L_ts124:
  s_cmp_gt_u32 s22, 2
  s_cbranch_scc0 L_th124
  s_waitcnt vmcnt(4)
  s_cmp_gt_u32 s22, 10
  s_cbranch_scc0 L_th124
  s_waitcnt vmcnt(3)
  s_branch L_th124
L_ts125:
  s_cmp_gt_u32 s22, 6
  s_cbranch_scc0 L_th125
  s_waitcnt vmcnt(4)
  s_branch L_th125
L_ts126:
  s_cmp_gt_u32 s22, 1
  s_cbranch_scc0 L_th126
  s_waitcnt vmcnt(4)
  s_cmp_gt_u32 s22, 9
  s_cbranch_scc0 L_th126
  s_waitcnt vmcnt(3)
  s_branch L_th126
L_ts127:
  s_cmp_gt_u32 s22, 5
  s_cbranch_scc0 L_th127
  s_waitcnt vmcnt(4)
  s_branch L_th127
L_ts128:
  s_cmp_gt_u32 s22, 3
  s_cbranch_scc0 L_th128
  s_waitcnt vmcnt(4)
  s_cmp_gt_u32 s22, 11
  s_cbranch_scc0 L_th128
  s_waitcnt vmcnt(3)
  s_branch L_th128
L_ts129:
  s_cmp_gt_u32 s22, 7
  s_cbranch_scc0 L_th129
  s_waitcnt vmcnt(4)
  s_branch L_th129
L_ts130:
  s_waitcnt vmcnt(4)
  s_cmp_gt_u32 s22, 8
  s_cbranch_scc0 L_th130
  s_waitcnt vmcnt(3)
  s_branch L_th130
L_ts131:
  s_cmp_gt_u32 s22, 4
  s_cbranch_scc0 L_th131
  s_waitcnt vmcnt(4)
  s_branch L_th131
L_ts132:
  s_cmp_gt_u32 s22, 2
  s_cbranch_scc0 L_th132
  s_waitcnt vmcnt(4)
  s_cmp_gt_u32 s22, 10
  s_cbranch_scc0 L_th132
  s_waitcnt vmcnt(3)
  s_branch L_th132
L_ts133:
  s_cmp_gt_u32 s22, 6
  s_cbranch_scc0 L_th133
  s_waitcnt vmcnt(4)
  s_branch L_th133
L_ts134:
  s_cmp_gt_u32 s22, 1
  s_cbranch_scc0 L_th134
  s_waitcnt vmcnt(4)
  s_cmp_gt_u32 s22, 9
  s_cbranch_scc0 L_th134
  s_waitcnt vmcnt(3)
  s_branch L_th134
L_ts135:
  s_cmp_gt_u32 s22, 5
  s_cbranch_scc0 L_th135
  s_waitcnt vmcnt(4)
  s_branch L_th135
L_ts136:
  s_cmp_gt_u32 s22, 3
  s_cbranch_scc0 L_th136
  s_waitcnt vmcnt(10)
  s_cmp_gt_u32 s22, 11
  s_cbranch_scc0 L_th136
  s_waitcnt vmcnt(9)
  s_branch L_th136
L_ts137:
  s_cmp_gt_u32 s22, 7
  s_cbranch_scc0 L_th137
  s_waitcnt vmcnt(10)
  s_branch L_th137
L_ts138:
  s_waitcnt vmcnt(10)
  s_cmp_gt_u32 s22, 8
  s_cbranch_scc0 L_th138
  s_waitcnt vmcnt(9)
  s_branch L_th138
L_ts139:
  s_cmp_gt_u32 s22, 4
  s_cbranch_scc0 L_th139
  s_waitcnt vmcnt(10)
  s_branch L_th139
L_ts140:
  s_cmp_gt_u32 s22, 2
  s_cbranch_scc0 L_th140
  s_waitcnt vmcnt(10)
  s_cmp_gt_u32 s22, 10
  s_cbranch_scc0 L_th140
  s_waitcnt vmcnt(3)
  s_branch L_th140
L_ts141:
  s_cmp_gt_u32 s22, 6
  s_cbranch_scc0 L_th141
  s_waitcnt vmcnt(4)
  s_branch L_th141
L_ts142:
  s_cmp_gt_u32 s22, 1
  s_cbranch_scc0 L_th142
  s_waitcnt vmcnt(4)
  s_cmp_gt_u32 s22, 9
  s_cbranch_scc0 L_th142
  s_waitcnt vmcnt(3)
  s_branch L_th142
L_ts143:
  s_cmp_gt_u32 s22, 5
  s_cbranch_scc0 L_th143
  s_waitcnt vmcnt(4)
  s_branch L_th143
L_ts144:
  s_cmp_gt_u32 s22, 3
  s_cbranch_scc0 L_th144
  s_waitcnt vmcnt(4)
  s_cmp_gt_u32 s22, 11
  s_cbranch_scc0 L_th144
  s_waitcnt vmcnt(3)
  s_branch L_th144
L_ts145:
  s_cmp_gt_u32 s22, 7
  s_cbranch_scc0 L_th145
  s_waitcnt vmcnt(4)
  s_branch L_th145
L_ts146:
  s_waitcnt vmcnt(4)
  s_cmp_gt_u32 s22, 8
  s_cbranch_scc0 L_th146
  s_waitcnt vmcnt(3)
  s_branch L_th146
L_ts147:
  s_cmp_gt_u32 s22, 4
  s_cbranch_scc0 L_th147
  s_waitcnt vmcnt(4)
  s_branch L_th147
L_ts148:
  s_cmp_gt_u32 s22, 2
  s_cbranch_scc0 L_th148
  s_waitcnt vmcnt(4)
  s_cmp_gt_u32 s22, 10
  s_cbranch_scc0 L_th148
  s_waitcnt vmcnt(3)
  s_branch L_th148
L_ts149:
  s_cmp_gt_u32 s22, 6
  s_cbranch_scc0 L_th149
  s_waitcnt vmcnt(4)
  s_branch L_th149
L_ts150:
  s_cmp_gt_u32 s22, 1
  s_cbranch_scc0 L_th150
  s_waitcnt vmcnt(4)
  s_cmp_gt_u32 s22, 9
  s_cbranch_scc0 L_th150
  s_waitcnt vmcnt(3)
  s_branch L_th150
L_ts151:
  s_cmp_gt_u32 s22, 5
  s_cbranch_scc0 L_th151
  s_waitcnt vmcnt(4)
  s_branch L_th151
L_ts152:
  s_cmp_gt_u32 s22, 3
  s_cbranch_scc0 L_th152
  s_waitcnt vmcnt(4)
  s_cmp_gt_u32 s22, 11
  s_cbranch_scc0 L_th152
  s_waitcnt vmcnt(3)
  s_branch L_th152
L_ts153:
  s_cmp_gt_u32 s22, 7
  s_cbranch_scc0 L_th153
  s_waitcnt vmcnt(4)
  s_branch L_th153
L_ts154:
  s_waitcnt vmcnt(4)
  s_cmp_gt_u32 s22, 8
  s_cbranch_scc0 L_th154
  s_waitcnt vmcnt(3)
  s_branch L_th154
L_ts155:
  s_cmp_gt_u32 s22, 4
  s_cbranch_scc0 L_th155
  s_waitcnt vmcnt(4)
  s_branch L_th155
L_ts156:
  s_cmp_gt_u32 s22, 2
  s_cbranch_scc0 L_th156
  s_waitcnt vmcnt(4)
  s_cmp_gt_u32 s22, 10
  s_cbranch_scc0 L_th156
  s_waitcnt vmcnt(3)
  s_branch L_th156
L_ts157:
  s_cmp_gt_u32 s22, 6
  s_cbranch_scc0 L_th157
  s_waitcnt vmcnt(4)
  s_branch L_th157
L_ts158:
  s_cmp_gt_u32 s22, 1
  s_cbranch_scc0 L_th158
  s_waitcnt vmcnt(4)
  s_cmp_gt_u32 s22, 9
  s_cbranch_scc0 L_th158
  s_waitcnt vmcnt(3)
  s_branch L_th158
L_ts159:
  s_cmp_gt_u32 s22, 5
  s_cbranch_scc0 L_th159
  s_waitcnt vmcnt(4)
  s_branch L_th159
L_ts160:
  s_cmp_gt_u32 s22, 3
  s_cbranch_scc0 L_th160
  s_waitcnt vmcnt(4)
  s_cmp_gt_u32 s22, 11
  s_cbranch_scc0 L_th160
  s_waitcnt vmcnt(3)
  s_branch L_th160
L_ts162:
  s_cmp_gt_u32 s22, 7
  s_cbranch_scc0 L_th162
  s_waitcnt vmcnt(4)
  s_branch L_th162
L_ts163:
  s_waitcnt vmcnt(4)
  s_cmp_gt_u32 s22, 8
  s_cbranch_scc0 L_th163
  s_waitcnt vmcnt(3)
  s_branch L_th163
L_ts164:
  s_cmp_gt_u32 s22, 4
  s_cbranch_scc0 L_th164
  s_waitcnt vmcnt(4)
  s_branch L_th164
L_ts165:
  s_cmp_gt_u32 s22, 2
  s_cbranch_scc0 L_th165
  s_waitcnt vmcnt(4)
  s_cmp_gt_u32 s22, 10
  s_cbranch_scc0 L_th165
  s_waitcnt vmcnt(3)
  s_branch L_th165
L_ts166:
  s_cmp_gt_u32 s22, 6
  s_cbranch_scc0 L_th166
  s_waitcnt vmcnt(4)
  s_branch L_th166
L_ts170:
  s_cmp_gt_u32 s22, 1
  s_cbranch_scc0 L_th170
  s_waitcnt vmcnt(4)
  s_cmp_gt_u32 s22, 9
  s_cbranch_scc0 L_th170
  s_waitcnt vmcnt(3)
  s_branch L_th170
L_ts171:
  s_cmp_gt_u32 s22, 5
  s_cbranch_scc0 L_th171
  s_waitcnt vmcnt(4)
  s_branch L_th171
L_ts172:
  s_cmp_gt_u32 s22, 3
  s_cbranch_scc0 L_th172
  s_waitcnt vmcnt(4)
  s_cmp_gt_u32 s22, 11
  s_cbranch_scc0 L_th172
  s_waitcnt vmcnt(3)
  s_branch L_th172
L_ts173:
  s_cmp_gt_u32 s22, 7
  s_cbranch_scc0 L_th173
  s_waitcnt vmcnt(4)
  s_branch L_th173
L_ts174:
  s_waitcnt vmcnt(4)
  s_cmp_gt_u32 s22, 8
  s_cbranch_scc0 L_th174
  s_waitcnt vmcnt(3)
  s_branch L_th174
L_ts175:
  s_cmp_gt_u32 s22, 4
  s_cbranch_scc0 L_th175
  s_waitcnt vmcnt(4)
  s_branch L_th175
L_ts176:
  s_cmp_gt_u32 s22, 2
  s_cbranch_scc0 L_th176
  s_waitcnt vmcnt(4)
  s_cmp_gt_u32 s22, 10
  s_cbranch_scc0 L_th176
  s_waitcnt vmcnt(3)
  s_branch L_th176
L_ts177:
  s_cmp_gt_u32 s22, 6
  s_cbranch_scc0 L_th177
  s_waitcnt vmcnt(4)
  s_branch L_th177
L_ts178:
  s_cmp_gt_u32 s22, 1
  s_cbranch_scc0 L_th178
  s_waitcnt vmcnt(4)
  s_cmp_gt_u32 s22, 9
  s_cbranch_scc0 L_th178
  s_waitcnt vmcnt(3)
  s_branch L_th178
L_ts179:
  s_cmp_gt_u32 s22, 5
  s_cbranch_scc0 L_th179
  s_waitcnt vmcnt(4)
  s_branch L_th179
L_ts180:
  s_cmp_gt_u32 s22, 3
  s_cbranch_scc0 L_th180
  s_waitcnt vmcnt(4)
  s_cmp_gt_u32 s22, 11
  s_cbranch_scc0 L_th180
  s_waitcnt vmcnt(3)
  s_branch L_th180
L_ts181:
  s_cmp_gt_u32 s22, 7
  s_cbranch_scc0 L_th181
  s_waitcnt vmcnt(4)
  s_branch L_th181
L_ts182:
  s_waitcnt vmcnt(4)
  s_cmp_gt_u32 s22, 8
  s_cbranch_scc0 L_th182
  s_waitcnt vmcnt(3)
  s_branch L_th182
L_ts183:
  s_cmp_gt_u32 s22, 4
  s_cbranch_scc0 L_th183
  s_waitcnt vmcnt(4)
  s_branch L_th183
L_ts184:
  s_cmp_gt_u32 s22, 2
  s_cbranch_scc0 L_th184
  s_waitcnt vmcnt(4)
  s_cmp_gt_u32 s22, 10
  s_cbranch_scc0 L_th184
  s_waitcnt vmcnt(3)
  s_branch L_th184
L_ts185:
  s_cmp_gt_u32 s22, 6
  s_cbranch_scc0 L_th185
  s_waitcnt vmcnt(4)
  s_branch L_th185
L_ts186:
  s_cmp_gt_u32 s22, 1
  s_cbranch_scc0 L_th186
  s_waitcnt vmcnt(4)
  s_cmp_gt_u32 s22, 9
  s_cbranch_scc0 L_th186
  s_waitcnt vmcnt(3)
  s_branch L_th186
L_ts187:
  s_cmp_gt_u32 s22, 5
  s_cbranch_scc0 L_th187
  s_waitcnt vmcnt(4)
  s_branch L_th187
L_ts188:
  s_cmp_gt_u32 s22, 3
  s_cbranch_scc0 L_th188
  s_waitcnt vmcnt(4)
  s_cmp_gt_u32 s22, 11
  s_cbranch_scc0 L_th188
  s_waitcnt vmcnt(3)
  s_branch L_th188
L_ts189:
  s_cmp_gt_u32 s22, 7
  s_cbranch_scc0 L_th189
  s_waitcnt vmcnt(4)
  s_branch L_th189
L_ts190:
  s_waitcnt vmcnt(4)
  s_cmp_gt_u32 s22, 8
  s_cbranch_scc0 L_th190
  s_waitcnt vmcnt(3)
  s_branch L_th190
L_ts191:
  s_cmp_gt_u32 s22, 4
  s_cbranch_scc0 L_th191
  s_waitcnt vmcnt(4)
  s_branch L_th191
L_ts192:
  s_cmp_gt_u32 s22, 2
  s_cbranch_scc0 L_th192
  s_waitcnt vmcnt(4)
  s_cmp_gt_u32 s22, 10
  s_cbranch_scc0 L_th192
  s_waitcnt vmcnt(3)
  s_branch L_th192
L_ts193:
  s_cmp_gt_u32 s22, 6
  s_cbranch_scc0 L_th193
  s_waitcnt vmcnt(4)
  s_branch L_th193
L_ts194:
  s_cmp_gt_u32 s22, 1
  s_cbranch_scc0 L_th194
  s_waitcnt vmcnt(4)
  s_cmp_gt_u32 s22, 9
  s_cbranch_scc0 L_th194
  s_waitcnt vmcnt(3)
  s_branch L_th194
L_ts195:
  s_cmp_gt_u32 s22, 5
  s_cbranch_scc0 L_th195
  s_waitcnt vmcnt(4)
  s_branch L_th195
L_ts196:
  s_cmp_gt_u32 s22, 3
  s_cbranch_scc0 L_th196
  s_waitcnt vmcnt(4)
  s_cmp_gt_u32 s22, 11
  s_cbranch_scc0 L_th196
  s_waitcnt vmcnt(3)
  s_branch L_th196
L_ts198:
  s_cmp_gt_u32 s22, 7
  s_cbranch_scc0 L_th198
  s_waitcnt vmcnt(4)
  s_branch L_th198
L_ts199:
  s_waitcnt vmcnt(4)
  s_cmp_gt_u32 s22, 8
  s_cbranch_scc0 L_th199
  s_waitcnt vmcnt(3)
  s_branch L_th199
L_ts200:
  s_cmp_gt_u32 s22, 4
  s_cbranch_scc0 L_th200
  s_waitcnt vmcnt(4)
  s_branch L_th200
L_ts201:
  s_cmp_gt_u32 s22, 2
  s_cbranch_scc0 L_th201
  s_waitcnt vmcnt(4)
  s_cmp_gt_u32 s22, 10
  s_cbranch_scc0 L_th201
  s_waitcnt vmcnt(3)
  s_branch L_th201
L_ts202:
  s_cmp_gt_u32 s22, 6
  s_cbranch_scc0 L_th202
  s_waitcnt vmcnt(4)
  s_branch L_th202
L_ts203:
  s_cmp_gt_u32 s22, 1
  s_cbranch_scc0 L_th203
  s_waitcnt vmcnt(4)
  s_cmp_gt_u32 s22, 9
  s_cbranch_scc0 L_th203
  s_waitcnt vmcnt(3)
  s_branch L_th203
L_ts204:
  s_cmp_gt_u32 s22, 5
  s_cbranch_scc0 L_th204
  s_waitcnt vmcnt(4)
  s_branch L_th204
L_ts205:
  s_cmp_gt_u32 s22, 3
  s_cbranch_scc0 L_th205
  s_waitcnt vmcnt(4)
  s_cmp_gt_u32 s22, 11
  s_cbranch_scc0 L_th205
  s_waitcnt vmcnt(3)
  s_branch L_th205
L_ts206:
  s_cmp_gt_u32 s22, 7
  s_cbranch_scc0 L_th206
  s_waitcnt vmcnt(4)
  s_branch L_th206
L_ts207:
  s_waitcnt vmcnt(4)
  s_cmp_gt_u32 s22, 8
  s_cbranch_scc0 L_th207
  s_waitcnt vmcnt(3)
  s_branch L_th207
L_ts208:
  s_cmp_gt_u32 s22, 4
  s_cbranch_scc0 L_th208
  s_waitcnt vmcnt(4)
  s_branch L_th208
L_ts209:
  s_cmp_gt_u32 s22, 2
  s_cbranch_scc0 L_th209
  s_waitcnt vmcnt(4)
  s_cmp_gt_u32 s22, 10
  s_cbranch_scc0 L_th209
  s_waitcnt vmcnt(3)
  s_branch L_th209
L_ts211:
  s_cmp_gt_u32 s22, 6
  s_cbranch_scc0 L_th211
  s_waitcnt vmcnt(4)
  s_branch L_th211
L_ts212:
  s_cmp_gt_u32 s22, 1
  s_cbranch_scc0 L_th212
  s_waitcnt vmcnt(4)
  s_cmp_gt_u32 s22, 9
  s_cbranch_scc0 L_th212
  s_waitcnt vmcnt(3)
  s_branch L_th212
L_ts213:
  s_cmp_gt_u32 s22, 5
  s_cbranch_scc0 L_th213
  s_waitcnt vmcnt(4)
  s_branch L_th213
L_ts214:
  s_cmp_gt_u32 s22, 3
  s_cbranch_scc0 L_th214
  s_waitcnt vmcnt(4)
  s_cmp_gt_u32 s22, 11
  s_cbranch_scc0 L_th214
  s_waitcnt vmcnt(3)
  s_branch L_th214
L_ts215:
  s_cmp_gt_u32 s22, 7
  s_cbranch_scc0 L_th215
  s_waitcnt vmcnt(4)
  s_branch L_th215
L_ts216:
  s_waitcnt vmcnt(4)
  s_cmp_gt_u32 s22, 8
  s_cbranch_scc0 L_th216
  s_waitcnt vmcnt(3)
  s_branch L_th216
L_ts217:
  s_cmp_gt_u32 s22, 4
  s_cbranch_scc0 L_th217
  s_waitcnt vmcnt(4)
  s_branch L_th217
L_ts218:
  s_cmp_gt_u32 s22, 2
  s_cbranch_scc0 L_th218
  s_waitcnt vmcnt(4)
  s_cmp_gt_u32 s22, 10
  s_cbranch_scc0 L_th218
  s_waitcnt vmcnt(3)
  s_branch L_th218
L_ts219:
  s_cmp_gt_u32 s22, 6
  s_cbranch_scc0 L_th219
  s_waitcnt vmcnt(4)
  s_branch L_th219
L_ts220:
  s_cmp_gt_u32 s22, 1
  s_cbranch_scc0 L_th220
  s_waitcnt vmcnt(4)
  s_cmp_gt_u32 s22, 9
  s_cbranch_scc0 L_th220
  s_waitcnt vmcnt(3)
  s_branch L_th220
L_ts221:
  s_cmp_gt_u32 s22, 5
  s_cbranch_scc0 L_th221
  s_waitcnt vmcnt(4)
  s_branch L_th221
L_ts222:
  s_cmp_gt_u32 s22, 3
  s_cbranch_scc0 L_th222
  s_waitcnt vmcnt(4)
  s_cmp_gt_u32 s22, 11
  s_cbranch_scc0 L_th222
  s_waitcnt vmcnt(3)
  s_branch L_th222
L_ts223:
  s_cmp_gt_u32 s22, 7
  s_cbranch_scc0 L_th223
  s_waitcnt vmcnt(4)
  s_branch L_th223
L_ts224:
  s_waitcnt vmcnt(4)
  s_cmp_gt_u32 s22, 8
  s_cbranch_scc0 L_th224
  s_waitcnt vmcnt(3)
  s_branch L_th224
L_ts225:
  s_cmp_gt_u32 s22, 4
  s_cbranch_scc0 L_th225
  s_waitcnt vmcnt(4)
  s_branch L_th225
L_ts226:
  s_cmp_gt_u32 s22, 2
  s_cbranch_scc0 L_th226
  s_waitcnt vmcnt(4)
  s_cmp_gt_u32 s22, 10
  s_cbranch_scc0 L_th226
  s_waitcnt vmcnt(3)
  s_branch L_th226
L_ts227:
  s_cmp_gt_u32 s22, 6
  s_cbranch_scc0 L_th227
  s_waitcnt vmcnt(4)
  s_branch L_th227
L_ts228:
  s_cmp_gt_u32 s22, 1
  s_cbranch_scc0 L_th228
  s_waitcnt vmcnt(4)
  s_cmp_gt_u32 s22, 9
  s_cbranch_scc0 L_th228
  s_waitcnt vmcnt(3)
  s_branch L_th228
L_ts229:
  s_cmp_gt_u32 s22, 5
  s_cbranch_scc0 L_th229
  s_waitcnt vmcnt(4)
  s_branch L_th229
L_ts230:
  s_cmp_gt_u32 s22, 3
  s_cbranch_scc0 L_th230
  s_waitcnt vmcnt(4)
  s_cmp_gt_u32 s22, 11
  s_cbranch_scc0 L_th230
  s_waitcnt vmcnt(3)
  s_branch L_th230
L_ts231:
  s_cmp_gt_u32 s22, 7
  s_cbranch_scc0 L_th231
  s_waitcnt vmcnt(4)
  s_branch L_th231
L_ts232:
  s_waitcnt vmcnt(10)
  s_cmp_gt_u32 s22, 8
  s_cbranch_scc0 L_th232
  s_waitcnt vmcnt(9)
  s_branch L_th232
L_ts233:
  s_cmp_gt_u32 s22, 4
  s_cbranch_scc0 L_th233
  s_waitcnt vmcnt(10)
  s_branch L_th233
L_ts234:
  s_cmp_gt_u32 s22, 2
  s_cbranch_scc0 L_th234
  s_waitcnt vmcnt(10)
  s_cmp_gt_u32 s22, 10
  s_cbranch_scc0 L_th234
  s_waitcnt vmcnt(9)
  s_branch L_th234
L_ts235:
  s_cmp_gt_u32 s22, 6
  s_cbranch_scc0 L_th235
  s_waitcnt vmcnt(10)
  s_branch L_th235
L_ts236:
  s_cmp_gt_u32 s22, 1
  s_cbranch_scc0 L_th236
  s_waitcnt vmcnt(10)
  s_cmp_gt_u32 s22, 9
  s_cbranch_scc0 L_th236
  s_waitcnt vmcnt(3)
  s_branch L_th236
L_ts237:
  s_cmp_gt_u32 s22, 5
  s_cbranch_scc0 L_th237
  s_waitcnt vmcnt(4)
  s_branch L_th237
L_ts238:
  s_cmp_gt_u32 s22, 3
  s_cbranch_scc0 L_th238
  s_waitcnt vmcnt(4)
  s_cmp_gt_u32 s22, 11
  s_cbranch_scc0 L_th238
  s_waitcnt vmcnt(3)
  s_branch L_th238
L_ts239:
  s_cmp_gt_u32 s22, 7
  s_cbranch_scc0 L_th239
  s_waitcnt vmcnt(4)
  s_branch L_th239
L_ts240:
  s_waitcnt vmcnt(4)
  s_cmp_gt_u32 s22, 8
  s_cbranch_scc0 L_th240
  s_waitcnt vmcnt(3)
  s_branch L_th240
L_ts241:
  s_cmp_gt_u32 s22, 4
  s_cbranch_scc0 L_th241
  s_waitcnt vmcnt(4)
  s_branch L_th241
L_ts242:
  s_cmp_gt_u32 s22, 2
  s_cbranch_scc0 L_th242
  s_waitcnt vmcnt(4)
  s_cmp_gt_u32 s22, 10
  s_cbranch_scc0 L_th242
  s_waitcnt vmcnt(3)
  s_branch L_th242
L_ts243:
  s_cmp_gt_u32 s22, 6
  s_cbranch_scc0 L_th243
  s_waitcnt vmcnt(4)
  s_branch L_th243
L_ts244:
  s_cmp_gt_u32 s22, 1
  s_cbranch_scc0 L_th244
  s_waitcnt vmcnt(4)
  s_cmp_gt_u32 s22, 9
  s_cbranch_scc0 L_th244
  s_waitcnt vmcnt(3)
  s_branch L_th244
L_ts245:
  s_cmp_gt_u32 s22, 5
  s_cbranch_scc0 L_th245
  s_waitcnt vmcnt(4)
  s_branch L_th245
L_ts246:
  s_cmp_gt_u32 s22, 3
  s_cbranch_scc0 L_th246
  s_waitcnt vmcnt(4)
  s_cmp_gt_u32 s22, 11
  s_cbranch_scc0 L_th246
  s_waitcnt vmcnt(3)
  s_branch L_th246
L_ts247:
  s_cmp_gt_u32 s22, 7
  s_cbranch_scc0 L_th247
  s_waitcnt vmcnt(4)
  s_branch L_th247
L_ts248:
  s_waitcnt vmcnt(4)
  s_cmp_gt_u32 s22, 8
  s_cbranch_scc0 L_th248
  s_waitcnt vmcnt(3)
  s_branch L_th248
L_ts249:
  s_cmp_gt_u32 s22, 4
  s_cbranch_scc0 L_th249
  s_waitcnt vmcnt(4)
  s_branch L_th249
L_ts250:
  s_cmp_gt_u32 s22, 2
  s_cbranch_scc0 L_th250
  s_waitcnt vmcnt(4)
  s_cmp_gt_u32 s22, 10
  s_cbranch_scc0 L_th250
  s_waitcnt vmcnt(3)
  s_branch L_th250
L_ts251:
  s_cmp_gt_u32 s22, 6
  s_cbranch_scc0 L_th251
  s_waitcnt vmcnt(4)
  s_branch L_th251
L_ts252:
  s_cmp_gt_u32 s22, 1
  s_cbranch_scc0 L_th252
  s_waitcnt vmcnt(4)
  s_cmp_gt_u32 s22, 9
  s_cbranch_scc0 L_th252
  s_waitcnt vmcnt(3)
  s_branch L_th252
L_ts253:
  s_cmp_gt_u32 s22, 5
  s_cbranch_scc0 L_th253
  s_waitcnt vmcnt(4)
  s_branch L_th253
L_ts254:
  s_cmp_gt_u32 s22, 3
  s_cbranch_scc0 L_th254
  s_waitcnt vmcnt(4)
  s_cmp_gt_u32 s22, 11
  s_cbranch_scc0 L_th254
  s_waitcnt vmcnt(3)
  s_branch L_th254
L_ts255:
  s_cmp_gt_u32 s22, 7
  s_cbranch_scc0 L_th255
  s_waitcnt vmcnt(4)
  s_branch L_th255
L_ts256:
  s_waitcnt vmcnt(4)
  s_cmp_gt_u32 s22, 8
  s_cbranch_scc0 L_th256
  s_waitcnt vmcnt(3)
  s_branch L_th256
L_ts258:
  s_cmp_gt_u32 s22, 4
  s_cbranch_scc0 L_th258
  s_waitcnt vmcnt(4)
  s_branch L_th258
L_ts259:
  s_cmp_gt_u32 s22, 2
  s_cbranch_scc0 L_th259
  s_waitcnt vmcnt(4)
  s_cmp_gt_u32 s22, 10
  s_cbranch_scc0 L_th259
  s_waitcnt vmcnt(3)
  s_branch L_th259
L_ts260:
  s_cmp_gt_u32 s22, 6
  s_cbranch_scc0 L_th260
  s_waitcnt vmcnt(4)
  s_branch L_th260
L_ts261:
  s_cmp_gt_u32 s22, 1
  s_cbranch_scc0 L_th261
  s_waitcnt vmcnt(4)
  s_cmp_gt_u32 s22, 9
  s_cbranch_scc0 L_th261
  s_waitcnt vmcnt(3)
  s_branch L_th261
L_ts262:
  s_cmp_gt_u32 s22, 5
  s_cbranch_scc0 L_th262
  s_waitcnt vmcnt(4)
  s_branch L_th262
L_ts266:
  s_waitcnt vmcnt(4)
  s_cmp_gt_u32 s22, 8
  s_cbranch_scc0 L_th266
  s_waitcnt vmcnt(3)
  s_branch L_th266
L_ts267:
  s_cmp_gt_u32 s22, 4
  s_cbranch_scc0 L_th267
  s_waitcnt vmcnt(4)
  s_branch L_th267
L_ts268:
  s_cmp_gt_u32 s22, 2
  s_cbranch_scc0 L_th268
  s_waitcnt vmcnt(4)
  s_cmp_gt_u32 s22, 10
  s_cbranch_scc0 L_th268
  s_waitcnt vmcnt(3)
  s_branch L_th268
L_ts269:
  s_cmp_gt_u32 s22, 6
  s_cbranch_scc0 L_th269
  s_waitcnt vmcnt(4)
  s_branch L_th269
L_ts270:
  s_cmp_gt_u32 s22, 1
  s_cbranch_scc0 L_th270
  s_waitcnt vmcnt(4)
  s_cmp_gt_u32 s22, 9
  s_cbranch_scc0 L_th270
  s_waitcnt vmcnt(3)
  s_branch L_th270
L_ts271:
  s_cmp_gt_u32 s22, 5
  s_cbranch_scc0 L_th271
  s_waitcnt vmcnt(4)
  s_branch L_th271
L_ts272:
  s_cmp_gt_u32 s22, 3
  s_cbranch_scc0 L_th272
  s_waitcnt vmcnt(4)
  s_cmp_gt_u32 s22, 11
  s_cbranch_scc0 L_th272
  s_waitcnt vmcnt(3)
  s_branch L_th272
L_ts273:
  s_cmp_gt_u32 s22, 7
  s_cbranch_scc0 L_th273
  s_waitcnt vmcnt(4)
  s_branch L_th273
L_ts274:
  s_waitcnt vmcnt(4)
  s_cmp_gt_u32 s22, 8
  s_cbranch_scc0 L_th274
  s_waitcnt vmcnt(3)
  s_branch L_th274
L_ts276:
  s_cmp_gt_u32 s22, 4
  s_cbranch_scc0 L_th276
  s_waitcnt vmcnt(4)
  s_branch L_th276
L_ts277:
  s_cmp_gt_u32 s22, 2
  s_cbranch_scc0 L_th277
  s_waitcnt vmcnt(4)
  s_cmp_gt_u32 s22, 10
  s_cbranch_scc0 L_th277
  s_waitcnt vmcnt(3)
  s_branch L_th277
L_ts278:
  s_cmp_gt_u32 s22, 6
  s_cbranch_scc0 L_th278
  s_waitcnt vmcnt(4)
  s_branch L_th278
L_ts280:
  s_cmp_gt_u32 s22, 1
  s_cbranch_scc0 L_th280
  s_waitcnt vmcnt(4)
  s_cmp_gt_u32 s22, 9
  s_cbranch_scc0 L_th280
  s_waitcnt vmcnt(3)
  s_branch L_th280
L_ts281:
  s_cmp_gt_u32 s22, 5
  s_cbranch_scc0 L_th281
  s_waitcnt vmcnt(4)
  s_branch L_th281
L_ts282:
  s_cmp_gt_u32 s22, 3
  s_cbranch_scc0 L_th282
  s_waitcnt vmcnt(4)
  s_cmp_gt_u32 s22, 11
  s_cbranch_scc0 L_th282
  s_waitcnt vmcnt(3)
  s_branch L_th282
L_ts283:
  s_cmp_gt_u32 s22, 7
  s_cbranch_scc0 L_th283
  s_waitcnt vmcnt(4)
  s_branch L_th283
L_ts284:
  s_waitcnt vmcnt(4)
  s_cmp_gt_u32 s22, 8
  s_cbranch_scc0 L_th284
  s_waitcnt vmcnt(3)
  s_branch L_th284
L_ts285:
  s_cmp_gt_u32 s22, 4
  s_cbranch_scc0 L_th285
  s_waitcnt vmcnt(4)
  s_branch L_th285
L_ts287:
  s_cmp_gt_u32 s22, 2
  s_cbranch_scc0 L_th287
  s_waitcnt vmcnt(4)
  s_cmp_gt_u32 s22, 10
  s_cbranch_scc0 L_th287
  s_waitcnt vmcnt(3)
  s_branch L_th287
L_ts288:
  s_cmp_gt_u32 s22, 6
  s_cbranch_scc0 L_th288
  s_waitcnt vmcnt(4)
  s_branch L_th288
L_ts289:
  s_cmp_gt_u32 s22, 1
  s_cbranch_scc0 L_th289
  s_waitcnt vmcnt(4)
  s_cmp_gt_u32 s22, 9
  s_cbranch_scc0 L_th289
  s_waitcnt vmcnt(3)
  s_branch L_th289
L_ts290:
  s_cmp_gt_u32 s22, 5
  s_cbranch_scc0 L_th290
  s_waitcnt vmcnt(4)
  s_branch L_th290
L_ts291:
  s_cmp_gt_u32 s22, 3
  s_cbranch_scc0 L_th291
  s_waitcnt vmcnt(4)
  s_cmp_gt_u32 s22, 11
  s_cbranch_scc0 L_th291
  s_waitcnt vmcnt(3)
  s_branch L_th291
L_ts292:
  s_cmp_gt_u32 s22, 7
  s_cbranch_scc0 L_th292
  s_waitcnt vmcnt(4)
  s_branch L_th292
L_ts293:
  s_waitcnt vmcnt(4)
  s_cmp_gt_u32 s22, 8
  s_cbranch_scc0 L_th293
  s_waitcnt vmcnt(3)
  s_branch L_th293
L_ts294:
  s_cmp_gt_u32 s22, 4
  s_cbranch_scc0 L_th294
  s_waitcnt vmcnt(4)
  s_branch L_th294
L_ts295:
  s_cmp_gt_u32 s22, 2
  s_cbranch_scc0 L_th295
  s_waitcnt vmcnt(4)
  s_cmp_gt_u32 s22, 10
  s_cbranch_scc0 L_th295
  s_waitcnt vmcnt(3)
  s_branch L_th295
L_ts296:
  s_cmp_gt_u32 s22, 6
  s_cbranch_scc0 L_th296
  s_waitcnt vmcnt(4)
  s_branch L_th296
L_ts297:
  s_cmp_gt_u32 s22, 1
  s_cbranch_scc0 L_th297
  s_waitcnt vmcnt(4)
  s_cmp_gt_u32 s22, 9
  s_cbranch_scc0 L_th297
  s_waitcnt vmcnt(3)
  s_branch L_th297
L_ts298:
  s_cmp_gt_u32 s22, 5
  s_cbranch_scc0 L_th298
  s_waitcnt vmcnt(4)
  s_branch L_th298
L_ts299:
  s_cmp_gt_u32 s22, 3
  s_cbranch_scc0 L_th299
  s_waitcnt vmcnt(4)
  s_cmp_gt_u32 s22, 11
  s_cbranch_scc0 L_th299
  s_waitcnt vmcnt(3)
  s_branch L_th299
L_ts300:
  s_cmp_gt_u32 s22, 7
  s_cbranch_scc0 L_th300
  s_waitcnt vmcnt(4)
  s_branch L_th300
L_ts301:
  s_waitcnt vmcnt(4)
  s_cmp_gt_u32 s22, 8
  s_cbranch_scc0 L_th301
  s_waitcnt vmcnt(3)
  s_branch L_th301
L_ts302:
  s_cmp_gt_u32 s22, 4
  s_cbranch_scc0 L_th302
  s_waitcnt vmcnt(4)
  s_branch L_th302
L_ts303:
  s_cmp_gt_u32 s22, 2
  s_cbranch_scc0 L_th303
  s_waitcnt vmcnt(4)
  s_cmp_gt_u32 s22, 10
  s_cbranch_scc0 L_th303
  s_waitcnt vmcnt(3)
  s_branch L_th303
L_ts304:
  s_cmp_gt_u32 s22, 6
  s_cbranch_scc0 L_th304
  s_waitcnt vmcnt(4)
  s_branch L_th304
L_ts305:
  s_cmp_gt_u32 s22, 1
  s_cbranch_scc0 L_th305
  s_waitcnt vmcnt(5)
  s_cmp_gt_u32 s22, 9
  s_cbranch_scc0 L_th305
  s_waitcnt vmcnt(4)
  s_branch L_th305
L_ts306:
  s_cmp_gt_u32 s22, 5
  s_cbranch_scc0 L_th306
  s_waitcnt vmcnt(5)
  s_branch L_th306
L_ts307:
  s_cmp_gt_u32 s22, 3
  s_cbranch_scc0 L_th307
  s_waitcnt vmcnt(5)
  s_cmp_gt_u32 s22, 11
  s_cbranch_scc0 L_th307
  s_waitcnt vmcnt(4)
  s_branch L_th307
L_ts308:
  s_cmp_gt_u32 s22, 7
  s_cbranch_scc0 L_th308
  s_waitcnt vmcnt(5)
  s_branch L_th308
L_ts309:
  s_waitcnt vmcnt(5)
  s_cmp_gt_u32 s22, 8
  s_cbranch_scc0 L_th309
  s_waitcnt vmcnt(3)
  s_branch L_th309
L_ts310:
  s_cmp_gt_u32 s22, 4
  s_cbranch_scc0 L_th310
  s_waitcnt vmcnt(4)
  s_branch L_th310
.section .rodata,"a"
.p2align 6
.amdhsa_kernel concat_heads__gqa_block_cached__mha_block_cached__decode_kernel
  .amdhsa_next_free_vgpr 512
  .amdhsa_next_free_sgpr 102
  .amdhsa_accum_offset 256
  .amdhsa_group_segment_fixed_size 0
  .amdhsa_kernarg_size 104
  .amdhsa_user_sgpr_count 2
  .amdhsa_user_sgpr_kernarg_segment_ptr 1
  .amdhsa_system_sgpr_workgroup_id_x 1
.end_amdhsa_kernel
```
